```python
import torch

def _softmax(x, axis=-1):
    return torch.softmax(x, dim=axis)

def _gelu(x):
    return torch.nn.functional.gelu(x, approximate='tanh')

def _silu(x):
    return torch.nn.functional.silu(x)

def _sigmoid(x):
    return torch.sigmoid(x)

def _layernorm(x, axis=-1, eps=1e-05):
    m = x.mean(dim=axis, keepdim=True)
    v = x.var(dim=axis, keepdim=True, unbiased=False)
    return (x - m) / torch.sqrt(v + eps)

def _scatter_add(tgt, idx, src, axis=0):
    return tgt.clone().index_add_(axis, idx, src)

def _segment_sum(src, seg, n):
    out = torch.zeros((n,) + src.shape[1:], dtype=src.dtype)
    return out.index_add_(0, seg, src)

def _pad(x, pw):
    flat = tuple((v for pair in reversed(pw) for v in pair))
    return torch.nn.functional.pad(x, flat)
kernel_name = 'adaLN_cond__ssm_conv_s4__glu_gated_geglu__prompt'

def setup_inputs():

    _w = lambda a: (lambda t: t.to(torch.bfloat16) if t.is_floating_point() else t)(torch.as_tensor(a))

    def _A_setup():
        B, L, D, N = (1, 2048, 512, 128)
        A_re = -(lambda _x: torch.exp(torch.as_tensor(_x)))((lambda *s: torch.randn(*s, dtype=torch.bfloat16) * 3.2)(D, N))
        A_im = torch.pi * (lambda *s: torch.randn(*s, dtype=torch.bfloat16) * 0.1)(D, N)
        B_re = (lambda *s: torch.randn(*s, dtype=torch.bfloat16) * 0.1)(D, N)
        B_im = (lambda *s: torch.randn(*s, dtype=torch.bfloat16) * 0.1)(D, N)
        C_re = (lambda *s: torch.randn(*s, dtype=torch.bfloat16) * 0.1)(D, N)
        C_im = (lambda *s: torch.randn(*s, dtype=torch.bfloat16) * 0.1)(D, N)
        log_dt = (lambda *s: torch.randn(*s, dtype=torch.bfloat16) * 0.1)(D) * 0.5 - 4.0
        Dskip = (lambda *s: torch.randn(*s, dtype=torch.bfloat16) * 0.1)(D)
        return {'u': _w((lambda *s: torch.randn(*s, dtype=torch.bfloat16) * 0.05)(B, L, D)), 'A_re': _w(A_re), 'A_im': _w(A_im), 'B_re': _w(B_re), 'B_im': _w(B_im), 'C_re': _w(C_re), 'C_im': _w(C_im), 'log_dt': _w(log_dt), 'Dskip': _w(Dskip)}
    _A_in = _A_setup()

    def _B_setup():
        B, S, Dm, Df = (1, 2048, 512, 1792)
        return {'x': _w((lambda *s: torch.randn(*s, dtype=torch.bfloat16) * 0.05)(B, S, Dm)), 'w_gate': _w((lambda *s: torch.randn(*s, dtype=torch.bfloat16) * 1.6)(Dm, Df) * Dm ** (-0.5)), 'w_up': _w((lambda *s: torch.randn(*s, dtype=torch.bfloat16) * 1.6)(Dm, Df) * Dm ** (-0.5)), 'w_down': _w((lambda *s: torch.randn(*s, dtype=torch.bfloat16) * 1.6)(Df, Dm) * Df ** (-0.5))}
    _B_in = _B_setup()
    return {'A_u': _A_in['u'], 'A_A_re': _A_in['A_re'], 'A_A_im': _A_in['A_im'], 'A_B_re': _A_in['B_re'], 'A_B_im': _A_in['B_im'], 'A_C_re': _A_in['C_re'], 'A_C_im': _A_in['C_im'], 'A_log_dt': _A_in['log_dt'], 'A_Dskip': _A_in['Dskip'], 'B_x': _B_in['x'], 'B_w_gate': _B_in['w_gate'], 'B_w_up': _B_in['w_up'], 'B_w_down': _B_in['w_down'], 'c': _w((lambda *s: torch.randn(*s, dtype=torch.bfloat16) * 0.1)(1, 512) * 8.0), 'w_mod': _w((lambda *s: torch.randn(*s, dtype=torch.bfloat16) * 0.1)(512, 6 * 512) * 512 ** (-0.5) * 8.0)}

def reference(A_u, A_A_re, A_A_im, A_B_re, A_B_im, A_C_re, A_C_im, A_log_dt, A_Dskip, B_x, B_w_gate, B_w_up, B_w_down, c, w_mod):

    def _A_ref(u, A_re, A_im, B_re, B_im, C_re, C_im, log_dt, Dskip):
        Bsz, L, D = u.shape
        dt = torch.exp(log_dt)[:, None]
        A = A_re + 1j * A_im
        Bc = B_re + 1j * B_im
        Cc = C_re + 1j * C_im
        logdA = dt * A
        dB = dt * Bc
        l = (lambda x, dt: x.to(dt))(torch.arange(L), A_re.dtype)
        P = torch.exp(logdA[:, :, None] * l[None, None, :])
        K = torch.einsum('dn,dnl,dn->dl', Cc, P, dB).real
        L2 = 2 * L
        Kp = _pad(K, ((0, 0), (0, L)))
        up = (lambda x, *d: x.permute(*d))(u, 0, 2, 1)
        up = _pad(up, ((0, 0), (0, 0), (0, L)))
        Kf = (lambda x, axes=(-2, -1): torch.fft.rfft2(x.float(), dim=axes))(Kp[:, None, :], axes=(-2, -1))
        Uf = (lambda x, axes=(-2, -1): torch.fft.rfft2(x.float(), dim=axes))(up[:, :, None, :], axes=(-2, -1))
        Yf = Uf * Kf[None, :, :, :]
        y = (lambda x, s, axes=(-2, -1): torch.fft.irfft2(x, s=s, dim=axes).to(torch.bfloat16))(Yf, (1, L2), axes=(-2, -1))[:, :, 0, :L]
        y = (lambda x, *d: x.permute(*d))(y, 0, 2, 1) + u * Dskip[None, None, :]
        return y

    def _B_ref(x, w_gate, w_up, w_down):
        g = torch.einsum('bsd,df->bsf', x, w_gate)
        u = torch.einsum('bsd,df->bsf', x, w_up)
        h = _gelu(g) * u
        return torch.einsum('bsf,fd->bsd', h, w_down)
    x = A_u
    mod = (_silu(c) @ w_mod).reshape(c.shape[0], 6, 1, -1)
    sa, ca, ga, sb, cb, gb = (mod[:, 0].clone(), mod[:, 1].clone(), mod[:, 2].clone(), mod[:, 3].clone(), mod[:, 4].clone(), mod[:, 5].clone())
    h = _layernorm(x, axis=-1) * (1 + ca) + sa
    x = x + ga * _A_ref(h, A_A_re, A_A_im, A_B_re, A_B_im, A_C_re, A_C_im, A_log_dt, A_Dskip)
    h = _layernorm(x, axis=-1) * (1 + cb) + sb
    x = x + gb * _B_ref(h, B_w_gate, B_w_up, B_w_down)
    return x
```

```asm
; @launch grid=(256,1,1) block=(256,1,1) lds=163840
.amdgcn_target "amdgcn-amd-amdhsa--gfx950"
.text
.globl adaLN_cond__ssm_conv_s4__glu_gated_geglu__prompt_kernel
.p2align 8
.type adaLN_cond__ssm_conv_s4__glu_gated_geglu__prompt_kernel,@function
adaLN_cond__ssm_conv_s4__glu_gated_geglu__prompt_kernel:
F_first:
    s_cmp_ge_u32 s2, 256
    s_cbranch_scc1 F_end
    s_load_dwordx16 s[16:31], s[0:1], 0
    s_load_dwordx16 s[32:47], s[0:1], 64
    s_load_dwordx4 s[48:51], s[0:1], 128
    s_getpc_b64 s[4:5]
    s_and_b32 s4, s4, 0xffffff00
    s_lshr_b32 s6, s2, 3
    s_mul_i32 s6, s6, 1280
    v_min_u32 v254, 9, v0
    v_lshlrev_b32 v254, 7, v254
    v_add_u32 v254, s6, v254
    global_load_dword v196, v254, s[4:5]
    v_and_b32 v1, 63, v0
    v_lshrrev_b32 v2, 6, v0
    s_and_b32 s80, s2, 7
    v_readfirstlane_b32 s70, v2
    s_lshr_b32 s79, s2, 3
    s_lshl_b32 s71, s80, 5
    s_add_u32 s71, s71, s79
    s_lshl_b32 s71, s71, 1
    s_lshl_b32 s74, s2, 13
    s_lshl_b32 s75, s70, 11
    s_add_u32 s74, s74, s75
    v_lshlrev_b32 v9, 4, v1
    v_lshrrev_b32 v4, 3, v1
    v_and_b32 v5, 7, v1
    v_lshlrev_b32 v5, 4, v5
    v_lshl_add_u32 v3, v4, 10, v5
    s_lshl_b32 s77, s79, 16
    s_lshl_b32 s76, s80, 7
    s_add_u32 s77, s77, s76
    s_lshl_b32 s76, s70, 14
    s_add_u32 s77, s77, s76
    s_add_u32 m0, s75, 155648
    v_add_u32 v6, 7168, v3
    s_lshl_b32 s76, s71, 8
    v_lshl_add_u32 v8, v0, 1, s76
    s_mul_i32 s82, s2, 1366
    s_lshr_b32 s82, s82, 16
    s_mul_i32 s84, s82, 48
    s_sub_u32 s83, s2, s84
    s_and_b32 s84, s82, 3
    s_lshl_b32 s84, s84, 8
    v_lshl_add_u32 v7, v1, 2, s84
    v_mul_u32_u24 v33, 6144, v4
    v_add_u32 v33, v33, v5
    s_mul_i32 s84, s82, 786432
    s_lshl_b32 s85, s83, 7
    s_add_u32 s84, s84, s85
    s_mul_i32 s85, s70, 196608
    s_add_u32 s84, s84, s85
    s_mov_b32 s54, 0x00200000
    s_mov_b32 s55, 0x20000
    s_mov_b32 s58, 0x00300000
    s_mov_b32 s59, 0x20000
    s_waitcnt lgkmcnt(0)
    s_mov_b32 s52, s16
    s_mov_b32 s53, s17
    buffer_load_dwordx4 v[10:13], v9, s[52:55], s74 offen
    buffer_load_dwordx4 v[14:17], v9, s[52:55], s74 offen offset:1024
    buffer_load_dwordx4 v3, s[52:55], s77 offen lds
    buffer_load_dwordx4 v6, s[52:55], s77 offen offset:1024 lds
    global_load_ushort v18, v8, s[18:19]
    global_load_ushort v19, v8, s[20:21]
    global_load_ushort v20, v8, s[22:23]
    global_load_ushort v21, v8, s[24:25]
    global_load_ushort v22, v8, s[26:27]
    global_load_ushort v23, v8, s[28:29]
    s_load_dword s69, s[50:51], 0
    s_lshl_b32 s74, s71, 1
    s_load_dword s72, s[30:31], s74
    s_load_dword s73, s[32:33], s74
    s_mov_b32 s56, s44
    s_mov_b32 s57, s45
    s_cmp_ge_u32 s83, 99
    s_cselect_b32 s86, 1, 0
    s_cmp_ge_u32 s2, 192
    s_cselect_b32 s86, 2, s86
    global_load_dword v186, v7, s[42:43]
    s_cmp_lg_u32 s86, 0
    s_cbranch_scc1 LF_wm_1
    s_lshl_b32 s75, s70, 12
    s_add_u32 m0, s75, 111872
    s_add_u32 s101, s84, 0
    buffer_load_dwordx4 v33, s[56:59], s101 offen lds
    s_add_u32 m0, s75, 112896
    s_add_u32 s101, s84, 49152
    buffer_load_dwordx4 v33, s[56:59], s101 offen lds
    s_add_u32 m0, s75, 113920
    s_add_u32 s101, s84, 98304
    buffer_load_dwordx4 v33, s[56:59], s101 offen lds
    s_add_u32 m0, s75, 114944
    s_add_u32 s101, s84, 147456
    buffer_load_dwordx4 v33, s[56:59], s101 offen lds
LF_wmj_2:
    s_bitcmp1_b32 s70, 0
    s_cselect_b32 s8, s38, s36
    s_cselect_b32 s9, s39, s37
    s_mov_b32 s4, s50
    s_mov_b32 s5, s51
    s_mov_b32 s6, 0x01200000
    s_mov_b32 s7, 0x20000
    s_mov_b32 s60, s40
    s_mov_b32 s61, s41
    s_mov_b32 s62, 0x001c0000
    s_mov_b32 s63, 0x20000
    s_mov_b32 s64, s46
    s_mov_b32 s65, s47
    s_mov_b32 s66, 0x00200000
    s_mov_b32 s67, 0x20000
    s_lshr_b32 s74, s80, 1
    s_mul_i32 s74, s74, 28
    s_add_u32 s74, s74, s79
    s_and_b32 s98, s80, 1
    s_lshl_b32 s98, s98, 3
    s_and_b32 s99, s74, 7
    s_add_u32 s98, s98, s99
    s_lshr_b32 s99, s74, 3
    s_lshl_b32 s15, s80, 2
    s_add_u32 s15, s15, s79
    s_sub_u32 s15, s15, 28
    s_lshr_b32 s14, s15, 1
    s_and_b32 s13, s15, 1
    s_cmp_ge_u32 s79, 28
    s_cselect_b32 s99, s14, s99
    s_cselect_b32 s98, 0, s98
    s_cselect_b32 s100, s13, 0
    s_cselect_b32 s15, s15, 0
    s_cmp_ge_u32 s15, 28
    s_cselect_b32 s10, 0, 0x001c0000
    s_mov_b32 s11, 0x20000
    s_lshl_b32 s99, s99, 7
    s_lshl_b32 s74, s70, 5
    s_add_u32 s99, s99, s74
    v_lshrrev_b32 v241, 4, v1
    v_mul_u32_u24 v240, 3584, v241
    s_and_b32 s13, s70, 1
    v_lshl_add_u32 v241, v241, 1, s13
    v_bfe_u32 v242, v1, 1, 3
    v_xor_b32 v241, v241, v242
    v_lshl_add_u32 v240, v241, 5, v240
    v_and_b32 v241, 1, v1
    v_lshl_add_u32 v240, v241, 4, v240
    s_lshr_b32 s14, s70, 1
    s_mul_i32 s15, s14, 28672
    s_and_b32 s101, s99, 0xffffff80
    s_lshl_b32 s101, s101, 1
    s_add_u32 s15, s15, s101
    v_add_u32 v240, s15, v240
    v_add_u32 v247, 13312, v240
    s_lshl_b32 s12, s13, 12
    s_lshl_b32 s14, s14, 11
    s_add_u32 s12, s12, s14
    v_bfe_u32 v241, v1, 4, 1
    v_bfe_u32 v242, v1, 2, 2
    v_lshl_add_u32 v243, v242, 1, v241
    s_lshl_b32 s13, s70, 1
    v_xor_b32 v243, s13, v243
    v_lshlrev_b32 v243, 5, v243
    v_lshl_add_u32 v243, v241, 12, v243
    v_lshl_add_u32 v243, v242, 8, v243
    v_lshrrev_b32 v241, 5, v1
    v_lshl_add_u32 v243, v241, 11, v243
    v_and_b32 v241, 1, v1
    v_lshl_add_u32 v243, v241, 4, v243
    v_bfe_u32 v241, v1, 1, 1
    v_lshl_add_u32 v241, v241, 3, v243
    v_xor_b32 v242, 32, v241
    v_add_u32 v243, 0x10000, v241
    v_add_u32 v244, 0x10000, v242
    v_add_u32 v245, 0x20000, v241
    v_add_u32 v246, 0x20000, v242
    s_mul_i32 s81, s98, 458752
    s_lshl_b32 s101, s99, 6
    s_add_u32 s81, s81, s101
    s_add_u32 s81, s81, 0x00500000
    s_and_b32 s26, s98, 7
    s_mul_i32 s101, s100, 917504
    s_add_u32 s18, s26, 0
    s_and_b32 s18, s18, 7
    s_mul_i32 s18, s18, 57344
    s_add_u32 s18, s18, s101
    s_add_u32 s19, s26, 1
    s_and_b32 s19, s19, 7
    s_mul_i32 s19, s19, 57344
    s_add_u32 s19, s19, s101
    s_add_u32 s20, s26, 2
    s_and_b32 s20, s20, 7
    s_mul_i32 s20, s20, 57344
    s_add_u32 s20, s20, s101
    s_add_u32 s21, s26, 3
    s_and_b32 s21, s21, 7
    s_mul_i32 s21, s21, 57344
    s_add_u32 s21, s21, s101
    s_add_u32 s22, s26, 4
    s_and_b32 s22, s22, 7
    s_mul_i32 s22, s22, 57344
    s_add_u32 s22, s22, s101
    s_add_u32 s23, s26, 5
    s_and_b32 s23, s23, 7
    s_mul_i32 s23, s23, 57344
    s_add_u32 s23, s23, s101
    s_add_u32 s24, s26, 6
    s_and_b32 s24, s24, 7
    s_mul_i32 s24, s24, 57344
    s_add_u32 s24, s24, s101
    s_add_u32 s25, s26, 7
    s_and_b32 s25, s25, 7
    s_mul_i32 s25, s25, 57344
    s_add_u32 s25, s25, s101
    s_lshr_b32 s16, s70, 1
    s_and_b32 s17, s70, 1
    v_and_b32 v176, 15, v1
    v_lshrrev_b32 v177, 4, v1
    v_lshlrev_b32 v178, 3, v177
    v_sub_u32 v178, v178, v176
    v_add_u32 v178, 2031, v178
    v_lshrrev_b32 v178, 1, v178
    v_and_b32 v179, 1, v1
    v_xor_b32 v179, 1, v179
    v_mul_u32_u24 v179, 4164, v179
    v_lshl_add_u32 v178, v178, 2, v179
    s_mul_i32 s74, s16, 8320
    s_lshl_b32 s75, s17, 8
    s_sub_u32 s74, s74, s75
    s_add_u32 s74, s74, 68928
    v_add_u32 v168, s74, v178
    s_sub_u32 s74, s74, 1024
    v_add_u32 v169, s74, v178
    s_sub_u32 s74, s74, 1024
    v_add_u32 v170, s74, v178
    s_sub_u32 s74, s74, 1024
    v_add_u32 v171, s74, v178
    v_lshlrev_b32 v178, 5, v176
    v_lshl_add_u32 v178, v177, 4, v178
    s_mul_i32 s74, s16, 4608
    s_sub_u32 s74, s74, s75
    s_add_u32 s74, s74, 86560
    v_add_u32 v172, s74, v178
    v_lshl_add_u32 v178, v176, 5, v178
    s_lshl_b32 s74, s16, 13
    s_lshl_b32 s75, s17, 12
    s_add_u32 s74, s74, s75
    s_add_u32 s74, s74, 95488
    v_add_u32 v173, s74, v178
    s_lshl_b32 s74, s70, 12
    s_add_u32 s74, s74, 95488
    v_lshl_add_u32 v180, v1, 4, s74
    s_xor_b32 s75, s70, 1
    s_lshl_b32 s75, s75, 12
    s_add_u32 s75, s75, 95488
    v_lshl_add_u32 v181, v1, 4, s75
    v_and_b32 v176, 15, v1
    v_lshrrev_b32 v177, 4, v1
    v_lshrrev_b32 v182, 1, v176
    v_and_b32 v179, 1, v177
    v_lshl_add_u32 v182, v179, 3, v182
    v_lshlrev_b32 v182, 15, v182
    v_and_b32 v176, 1, v176
    v_lshl_add_u32 v182, v176, 5, v182
    v_lshrrev_b32 v177, 1, v177
    v_lshl_add_u32 v182, v177, 4, v182
    s_add_u32 s27, s71, s16
    s_lshl_b32 s27, s27, 6
    s_lshl_b32 s28, s17, 20
    s_add_u32 s27, s27, s28
    s_add_u32 s28, s27, 0x00300000
    s_add_u32 s27, s27, 0x00100000
    s_add_u32 s29, s27, 0x00080000
    s_add_u32 s30, s28, 0x00080000
    v_lshlrev_b32 v183, 4, v0
    v_add_u32 v183, 86784, v183
    v_lshlrev_b32 v184, 5, v0
    v_add_u32 v184, 95488, v184
    v_mov_b32 v252, 0xfffefffe
    v_lshlrev_b32 v236, 4, v0
    v_mov_b32 v199, 0
    s_lshl_b32 s32, s71, 5
    s_cmp_lg_u32 s70, 0
    s_cselect_b32 s32, 0x7f000000, s32
    v_lshrrev_b32 v187, 2, v1
    v_lshlrev_b32 v187, 7, v187
    v_and_b32 v4, 3, v1
    v_lshl_add_u32 v187, v4, 3, v187
    v_lshrrev_b32 v5, 4, v1
    v_lshlrev_b32 v3, 11, v5
    v_bfe_u32 v4, v1, 1, 1
    v_lshl_add_u32 v3, v4, 10, v3
    v_bfe_u32 v4, v1, 2, 2
    v_lshl_add_u32 v3, v4, 7, v3
    v_and_b32 v4, 1, v1
    v_lshl_add_u32 v3, v4, 3, v3
    s_lshl_b32 s75, s70, 5
    s_add_u32 s75, s75, 155648
    v_add_u32 v188, s75, v3
    v_lshlrev_b32 v4, 10, v4
    v_lshl_add_u32 v4, v5, 5, v4
    v_bfe_u32 v5, v1, 3, 1
    v_lshl_add_u32 v4, v5, 4, v4
    v_bfe_u32 v5, v1, 1, 2
    v_lshl_add_u32 v189, v5, 14, v4
    s_lshl_b32 s74, s80, 19
    s_lshl_b32 s75, s70, 17
    s_add_u32 s74, s74, s75
    s_lshr_b32 s75, s79, 3
    s_lshl_b32 s75, s75, 12
    s_add_u32 s74, s74, s75
    s_and_b32 s75, s79, 7
    s_lshl_b32 s75, s75, 7
    s_add_u32 s74, s74, s75
    s_add_u32 s46, s74, 0x00c00000
    s_add_u32 s47, s46, 0x10000
    s_lshl_b32 s74, s70, 12
    v_lshl_add_u32 v190, v1, 4, s74
    v_and_b32 v191, 3, v1
    v_mul_u32_u24 v191, 24576, v191
    v_lshrrev_b32 v5, 3, v1
    v_min_u32 v5, 5, v5
    v_lshl_add_u32 v191, v5, 12, v191
    v_bfe_u32 v5, v1, 2, 1
    v_lshl_add_u32 v191, v5, 3, v191
    s_lshl_b32 s33, s71, 3
    s_add_u32 s33, s33, 32768
    s_mov_b32 s34, 4096
    s_lshl_b32 s35, s71, 13
    s_add_u32 s35, s35, 0x00c00000
    s_mov_b32 s78, 200000
    s_waitcnt lgkmcnt(0)
    s_mul_i32 s68, s69, 0x9E3779B1
    s_add_u32 s68, s68, 0x7F4A7C15
    s_and_b32 s31, s69, 1
    s_and_b32 s3, s69, 2
    s_lshl_b32 s3, s3, 15
    s_or_b32 s3, s3, s31
    s_xor_b32 s3, s3, 1
    s_xor_b32 s31, s3, 0x00010001
    v_mov_b32 v36, 0
    v_mov_b32 v37, 0
    v_mov_b32 v38, 0
    v_mov_b32 v39, 0
    v_lshrrev_b32 v3, 5, v0
    v_mul_u32_u24 v3, 4608, v3
    v_and_b32 v4, 31, v0
    v_lshl_add_u32 v3, v4, 4, v3
    v_add_u32 v3, 86272, v3
    v_bfe_u32 v4, v0, 2, 2
    v_mul_u32_u24 v4, 4160, v4
    v_and_b32 v5, 3, v0
    v_lshl_add_u32 v4, v5, 4, v4
    v_add_u32 v4, 73728, v4
    v_cmp_gt_u32 vcc, 64, v0
    s_nop 1
    v_cndmask_b32 v3, v4, v3, vcc
    v_cmp_gt_u32 vcc, 80, v0
    s_nop 0
    s_and_saveexec_b64 s[94:95], vcc
    s_cbranch_execz LF_z_3
    ds_write_b128 v3, v[36:39]
LF_z_3:
    s_mov_b64 exec, s[94:95]
    s_lshr_b32 s74, s70, 1
    s_lshl_b32 s74, s74, 4
    s_lshr_b32 s75, s72, s74
    s_lshl_b32 s75, s75, 16
    v_mov_b32 v3, 0x3fb8aa3b
    v_mul_f32 v3, s75, v3
    v_exp_f32 v3, v3
    s_nop 0
    v_cvt_pk_bf16_f32 v3, v3, v3
    v_and_b32 v35, 0xffff0000, v3
    v_mov_b32 v3, 0x3f803f80
    s_waitcnt vmcnt(13)
    v_dot2_f32_bf16 v4, v10, v3, 0
    v_dot2_f32_bf16 v5, v10, v10, 0
    v_dot2_f32_bf16 v6, v14, v3, 0
    v_dot2_f32_bf16 v7, v14, v14, 0
    v_dot2_f32_bf16 v4, v11, v3, v4
    v_dot2_f32_bf16 v5, v11, v11, v5
    v_dot2_f32_bf16 v6, v15, v3, v6
    v_dot2_f32_bf16 v7, v15, v15, v7
    v_dot2_f32_bf16 v4, v12, v3, v4
    v_dot2_f32_bf16 v5, v12, v12, v5
    v_dot2_f32_bf16 v6, v16, v3, v6
    v_dot2_f32_bf16 v7, v16, v16, v7
    v_dot2_f32_bf16 v4, v13, v3, v4
    v_dot2_f32_bf16 v5, v13, v13, v5
    v_dot2_f32_bf16 v6, v17, v3, v6
    v_dot2_f32_bf16 v7, v17, v17, v7
    v_add_f32_dpp v4, v4, v4 quad_perm:[1,0,3,2] row_mask:0xf bank_mask:0xf
    v_add_f32_dpp v5, v5, v5 quad_perm:[1,0,3,2] row_mask:0xf bank_mask:0xf
    v_add_f32_dpp v6, v6, v6 quad_perm:[1,0,3,2] row_mask:0xf bank_mask:0xf
    v_add_f32_dpp v7, v7, v7 quad_perm:[1,0,3,2] row_mask:0xf bank_mask:0xf
    v_add_f32_dpp v4, v4, v4 quad_perm:[2,3,0,1] row_mask:0xf bank_mask:0xf
    v_add_f32_dpp v5, v5, v5 quad_perm:[2,3,0,1] row_mask:0xf bank_mask:0xf
    v_add_f32_dpp v6, v6, v6 quad_perm:[2,3,0,1] row_mask:0xf bank_mask:0xf
    v_add_f32_dpp v7, v7, v7 quad_perm:[2,3,0,1] row_mask:0xf bank_mask:0xf
    v_add_f32_dpp v4, v4, v4 row_half_mirror row_mask:0xf bank_mask:0xf
    v_add_f32_dpp v5, v5, v5 row_half_mirror row_mask:0xf bank_mask:0xf
    v_add_f32_dpp v6, v6, v6 row_half_mirror row_mask:0xf bank_mask:0xf
    v_add_f32_dpp v7, v7, v7 row_half_mirror row_mask:0xf bank_mask:0xf
    v_add_f32_dpp v4, v4, v4 row_mirror row_mask:0xf bank_mask:0xf
    v_add_f32_dpp v5, v5, v5 row_mirror row_mask:0xf bank_mask:0xf
    v_add_f32_dpp v6, v6, v6 row_mirror row_mask:0xf bank_mask:0xf
    v_add_f32_dpp v7, v7, v7 row_mirror row_mask:0xf bank_mask:0xf
    v_permlane16_swap_b32 v4, v5
    s_nop 0
    v_permlane16_swap_b32 v6, v7
    v_add_f32 v4, v4, v5
    v_add_f32 v6, v6, v7
    s_nop 1
    v_permlane32_swap_b32 v4, v6
    v_add_f32 v4, v4, v6
    v_mov_b32 v5, v4
    s_nop 1
    v_permlane16_swap_b32 v4, v5
    v_mul_f32 v4, 0x3b000000, v4
    v_mul_f32 v6, v4, v4
    v_mul_f32 v5, 0x3b000000, v5
    v_sub_f32 v5, v5, v6
    v_max_f32 v5, 0, v5
    v_cvt_pk_bf16_f32 v6, v5, v5
    v_and_b32 v6, 0xffff0000, v6
    v_add_f32 v6, 0x3727c5ac, v6
    v_cvt_pk_bf16_f32 v6, v6, v6
    v_and_b32 v6, 0xffff0000, v6
    v_sqrt_f32 v6, v6
    s_nop 0
    v_cvt_pk_bf16_f32 v4, v6, v4
    v_mov_b32 v5, s68
    v_lshrrev_b32 v6, 2, v1
    s_lshr_b32 s74, s2, 6
    s_lshl_b32 s74, s74, 2
    s_add_u32 s74, s74, s70
    s_lshl_b32 s74, s74, 10
    s_and_b32 s75, s2, 63
    s_lshl_b32 s75, s75, 4
    s_add_u32 s74, s74, s75
    s_add_u32 s74, s74, 4096
    s_mov_b32 exec_lo, 1
    s_mov_b32 exec_hi, 1
    buffer_store_dwordx2 v[4:5], v6, s[4:7], s74 offen sc1
    s_mov_b64 exec, -1
    v_mov_b32 v39, s68
    v_mov_b32 v43, s68
    v_mov_b32 v47, s68
    v_mov_b32 v51, s68
    s_waitcnt vmcnt(12)
    s_barrier
    ds_read_b64_tr_b16 v[36:37], v188 offset:0
    ds_read_b64_tr_b16 v[40:41], v188 offset:512
    ds_read_b64_tr_b16 v[44:45], v188 offset:16
    ds_read_b64_tr_b16 v[48:49], v188 offset:528
    s_waitcnt lgkmcnt(3)
    v_mov_b32 v38, v37
    v_mov_b32 v37, s68
    buffer_store_dwordx4 v[36:39], v189, s[4:7], s46 offen offset:0 sc1
    s_waitcnt lgkmcnt(2)
    v_mov_b32 v42, v41
    v_mov_b32 v41, s68
    buffer_store_dwordx4 v[40:43], v189, s[4:7], s46 offen offset:2048 sc1
    s_waitcnt lgkmcnt(1)
    v_mov_b32 v46, v45
    v_mov_b32 v45, s68
    buffer_store_dwordx4 v[44:47], v189, s[4:7], s47 offen offset:0 sc1
    s_waitcnt lgkmcnt(0)
    v_mov_b32 v50, v49
    v_mov_b32 v49, s68
    buffer_store_dwordx4 v[48:51], v189, s[4:7], s47 offen offset:2048 sc1
    s_lshr_b32 s74, s70, 1
    s_lshl_b32 s75, s2, 1
    s_add_u32 s74, s74, s75
    s_mul_i32 s74, s74, 3584
    v_min_u32 v3, 27, v1
    v_lshlrev_b32 v3, 7, v3
    v_add_u32 v3, s74, v3
    global_load_dword v198, v3, s[8:9]
    s_waitcnt vmcnt(10)
    s_getreg_b32 s13, hwreg(HW_REG_IB_STS, 0, 4)
    s_cmp_le_u32 s13, 6
    s_cselect_b32 s13, 3, 0
    s_add_u32 s15, s86, s13
    s_mov_b32 s86, s15
    s_cmp_lg_u32 s86, 3
    s_cbranch_scc1 LF_nomod2_4
    v_lshlrev_b32 v56, 16, v186
    v_and_b32 v57, 0xffff0000, v186
    v_mul_f32 v58, 0xbfb8aa3b, v56
    v_mul_f32 v59, 0xbfb8aa3b, v57
    v_exp_f32 v58, v58
    v_exp_f32 v59, v59
    v_add_f32 v58, 1.0, v58
    v_add_f32 v59, 1.0, v59
    v_rcp_f32 v58, v58
    v_rcp_f32 v59, v59
    v_mul_f32 v56, v56, v58
    v_mul_f32 v57, v57, v59
    v_cvt_pk_bf16_f32 v56, v56, v57
    s_lshl_b32 s44, s70, 8
    s_add_u32 s44, s44, 128256
    v_lshl_add_u32 v57, v1, 2, s44
    ds_write_b32 v57, v56
    v_lshrrev_b32 v58, 4, v1
    v_lshl_add_u32 v57, v58, 4, s44
    v_lshl_add_u32 v59, v58, 9, v187
    s_lshl_b32 s45, s70, 5
    s_add_u32 s45, s45, 111872
    v_add_u32 v59, s45, v59
    s_waitcnt vmcnt(6)
    s_waitcnt lgkmcnt(0)
    s_barrier
    ds_read_b128 v[60:63], v57 offset:0
    ds_read_b64_tr_b16 v[64:65], v59 offset:0
    ds_read_b64_tr_b16 v[66:67], v59 offset:512
    ds_read_b128 v[68:71], v57 offset:64
    ds_read_b64_tr_b16 v[72:73], v59 offset:4096
    ds_read_b64_tr_b16 v[74:75], v59 offset:4608
    ds_read_b128 v[76:79], v57 offset:128
    ds_read_b64_tr_b16 v[80:81], v59 offset:8192
    ds_read_b64_tr_b16 v[82:83], v59 offset:8704
    ds_read_b128 v[84:87], v57 offset:192
    ds_read_b64_tr_b16 v[88:89], v59 offset:12288
    ds_read_b64_tr_b16 v[90:91], v59 offset:12800
    s_mul_i32 s44, s82, 24576
    s_lshl_b32 s45, s83, 9
    s_add_u32 s44, s44, s45
    s_lshl_b32 s45, s70, 7
    s_add_u32 s44, s44, s45
    s_add_u32 s44, s44, 32768
    v_lshlrev_b32 v59, 3, v1
    s_waitcnt lgkmcnt(9)
    v_mfma_f32_16x16x32_bf16 v[92:95], v[60:63], v[64:67], 0
    s_waitcnt lgkmcnt(6)
    v_mfma_f32_16x16x32_bf16 v[92:95], v[68:71], v[72:75], v[92:95]
    s_waitcnt lgkmcnt(3)
    v_mfma_f32_16x16x32_bf16 v[92:95], v[76:79], v[80:83], v[92:95]
    s_waitcnt lgkmcnt(0)
    v_mfma_f32_16x16x32_bf16 v[92:95], v[84:87], v[88:91], v[92:95]
    s_barrier
    s_nop 6
    v_mov_b32 v93, s68
    s_mov_b64 exec, 0xffff
    buffer_store_dwordx2 v[92:93], v59, s[4:7], s44 offen sc1
    s_mov_b64 exec, -1
LF_nomod2_4:
    v_lshlrev_b32 v26, 16, v18
    v_lshlrev_b32 v27, 16, v19
    v_lshlrev_b32 v28, 16, v20
    v_lshlrev_b32 v29, 16, v21
    v_lshlrev_b32 v30, 16, v22
    v_lshlrev_b32 v31, 16, v23
    v_mul_f32 v26, v26, v35
    v_mul_f32 v27, v27, v35
    v_mul_f32 v28, v28, v35
    v_mul_f32 v29, v29, v35
    v_mul_f32 v26, 0x3fb8aa3b, v26
    v_mul_f32 v27, 0.15915494, v27
    s_mul_i32 s77, s70, 17408
    s_mov_b32 m0, s77
    v_exp_f32 v120, v26
    v_fract_f32 v121, v27
    v_cos_f32 v122, v121
    v_sin_f32 v121, v121
    s_nop 0
    v_mul_f32 v42, v120, v122
    v_mul_f32 v43, v120, v121
    v_mov_b32 v128, 0x3f80
    v_cvt_pk_bf16_f32 v129, v42, v43
    v_mul_f32 v123, 0x41800000, v26
    v_mul_f32 v124, 0x41800000, v27
    v_exp_f32 v123, v123
    v_fract_f32 v124, v124
    v_cos_f32 v125, v124
    v_sin_f32 v124, v124
    s_nop 0
    v_mul_f32 v72, v123, v125
    v_mul_f32 v73, v123, v124
    v_pk_mul_f32 v[44:45], v[42:43], v[42:43] op_sel:[0,0] op_sel_hi:[0,1]
    v_pk_mul_f32 v[88:89], v[30:31], v[28:29] op_sel:[0,0] op_sel_hi:[0,1]
    v_pk_fma_f32 v[44:45], v[42:43], v[42:43], v[44:45] op_sel:[1,1,0] op_sel_hi:[1,0,1] neg_lo:[0,1,0]
    v_pk_fma_f32 v[88:89], v[30:31], v[28:29], v[88:89] op_sel:[1,1,0] op_sel_hi:[1,0,1] neg_lo:[0,1,0]
    v_pk_mul_f32 v[46:47], v[44:45], v[42:43] op_sel:[0,0] op_sel_hi:[0,1]
    v_pk_fma_f32 v[46:47], v[44:45], v[42:43], v[46:47] op_sel:[1,1,0] op_sel_hi:[1,0,1] neg_lo:[0,1,0]
    v_cvt_pk_bf16_f32 v130, v44, v45
    v_cvt_pk_bf16_f32 v131, v46, v47
    v_mul_f32 v120, 0x43800000, v26
    v_mul_f32 v121, 0x43800000, v27
    v_exp_f32 v120, v120
    v_fract_f32 v121, v121
    v_cos_f32 v122, v121
    v_sin_f32 v121, v121
    s_nop 0
    v_mul_f32 v74, v120, v122
    v_mul_f32 v75, v120, v121
    v_pk_mul_f32 v[90:91], v[88:89], v[72:73] op_sel:[0,0] op_sel_hi:[0,1]
    v_pk_mul_f32 v[138:139], v[72:73], v[72:73] op_sel:[0,0] op_sel_hi:[0,1]
    v_pk_fma_f32 v[90:91], v[88:89], v[72:73], v[90:91] op_sel:[1,1,0] op_sel_hi:[1,0,1] neg_lo:[0,1,0]
    v_pk_fma_f32 v[138:139], v[72:73], v[72:73], v[138:139] op_sel:[1,1,0] op_sel_hi:[1,0,1] neg_lo:[0,1,0]
    v_cvt_pk_bf16_f32 v132, v88, -v89
    v_cvt_pk_bf16_f32 v133, v90, -v91
    v_pk_mul_f32 v[48:49], v[44:45], v[44:45] op_sel:[0,0] op_sel_hi:[0,1]
    v_pk_mul_f32 v[50:51], v[46:47], v[44:45] op_sel:[0,0] op_sel_hi:[0,1]
    v_pk_fma_f32 v[48:49], v[44:45], v[44:45], v[48:49] op_sel:[1,1,0] op_sel_hi:[1,0,1] neg_lo:[0,1,0]
    v_pk_fma_f32 v[50:51], v[46:47], v[44:45], v[50:51] op_sel:[1,1,0] op_sel_hi:[1,0,1] neg_lo:[0,1,0]
    v_cvt_pk_bf16_f32 v134, v48, v49
    v_cvt_pk_bf16_f32 v135, v50, v51
    ds_write_addtid_b32 v128 offset:0
    ds_write_addtid_b32 v129 offset:272
    ds_write_addtid_b32 v130 offset:544
    ds_write_addtid_b32 v131 offset:816
    ds_write_addtid_b32 v132 offset:13056
    ds_write_addtid_b32 v133 offset:13328
    ds_write_addtid_b32 v134 offset:1088
    ds_write_addtid_b32 v135 offset:1360
    v_pk_mul_f32 v[52:53], v[48:49], v[44:45] op_sel:[0,0] op_sel_hi:[0,1]
    v_pk_mul_f32 v[54:55], v[48:49], v[46:47] op_sel:[0,0] op_sel_hi:[0,1]
    v_pk_fma_f32 v[52:53], v[48:49], v[44:45], v[52:53] op_sel:[1,1,0] op_sel_hi:[1,0,1] neg_lo:[0,1,0]
    v_pk_fma_f32 v[54:55], v[48:49], v[46:47], v[54:55] op_sel:[1,1,0] op_sel_hi:[1,0,1] neg_lo:[0,1,0]
    v_cvt_pk_bf16_f32 v128, v52, v53
    v_cvt_pk_bf16_f32 v129, v54, v55
    v_pk_mul_f32 v[92:93], v[88:89], v[138:139] op_sel:[0,0] op_sel_hi:[0,1]
    v_pk_mul_f32 v[94:95], v[90:91], v[138:139] op_sel:[0,0] op_sel_hi:[0,1]
    v_pk_fma_f32 v[92:93], v[88:89], v[138:139], v[92:93] op_sel:[1,1,0] op_sel_hi:[1,0,1] neg_lo:[0,1,0]
    v_pk_fma_f32 v[94:95], v[90:91], v[138:139], v[94:95] op_sel:[1,1,0] op_sel_hi:[1,0,1] neg_lo:[0,1,0]
    v_pk_mul_f32 v[140:141], v[138:139], v[138:139] op_sel:[0,0] op_sel_hi:[0,1]
    v_pk_fma_f32 v[140:141], v[138:139], v[138:139], v[140:141] op_sel:[1,1,0] op_sel_hi:[1,0,1] neg_lo:[0,1,0]
    v_cvt_pk_bf16_f32 v130, v92, -v93
    v_cvt_pk_bf16_f32 v131, v94, -v95
    v_pk_mul_f32 v[56:57], v[48:49], v[48:49] op_sel:[0,0] op_sel_hi:[0,1]
    v_pk_mul_f32 v[58:59], v[50:51], v[48:49] op_sel:[0,0] op_sel_hi:[0,1]
    v_pk_fma_f32 v[56:57], v[48:49], v[48:49], v[56:57] op_sel:[1,1,0] op_sel_hi:[1,0,1] neg_lo:[0,1,0]
    v_pk_fma_f32 v[58:59], v[50:51], v[48:49], v[58:59] op_sel:[1,1,0] op_sel_hi:[1,0,1] neg_lo:[0,1,0]
    v_cvt_pk_bf16_f32 v132, v56, v57
    v_cvt_pk_bf16_f32 v133, v58, v59
    v_pk_mul_f32 v[60:61], v[56:57], v[44:45] op_sel:[0,0] op_sel_hi:[0,1]
    v_pk_mul_f32 v[62:63], v[56:57], v[46:47] op_sel:[0,0] op_sel_hi:[0,1]
    v_pk_fma_f32 v[60:61], v[56:57], v[44:45], v[60:61] op_sel:[1,1,0] op_sel_hi:[1,0,1] neg_lo:[0,1,0]
    v_pk_fma_f32 v[62:63], v[56:57], v[46:47], v[62:63] op_sel:[1,1,0] op_sel_hi:[1,0,1] neg_lo:[0,1,0]
    v_cvt_pk_bf16_f32 v134, v60, v61
    v_cvt_pk_bf16_f32 v135, v62, v63
    ds_write_addtid_b32 v128 offset:1632
    ds_write_addtid_b32 v129 offset:1904
    ds_write_addtid_b32 v130 offset:13600
    ds_write_addtid_b32 v131 offset:13872
    ds_write_addtid_b32 v132 offset:2176
    ds_write_addtid_b32 v133 offset:2448
    ds_write_addtid_b32 v134 offset:2720
    ds_write_addtid_b32 v135 offset:2992
    v_pk_mul_f32 v[96:97], v[88:89], v[140:141] op_sel:[0,0] op_sel_hi:[0,1]
    v_pk_mul_f32 v[98:99], v[90:91], v[140:141] op_sel:[0,0] op_sel_hi:[0,1]
    v_pk_fma_f32 v[96:97], v[88:89], v[140:141], v[96:97] op_sel:[1,1,0] op_sel_hi:[1,0,1] neg_lo:[0,1,0]
    v_pk_fma_f32 v[98:99], v[90:91], v[140:141], v[98:99] op_sel:[1,1,0] op_sel_hi:[1,0,1] neg_lo:[0,1,0]
    v_cvt_pk_bf16_f32 v128, v96, -v97
    v_cvt_pk_bf16_f32 v129, v98, -v99
    v_pk_mul_f32 v[100:101], v[92:93], v[140:141] op_sel:[0,0] op_sel_hi:[0,1]
    v_pk_mul_f32 v[102:103], v[94:95], v[140:141] op_sel:[0,0] op_sel_hi:[0,1]
    v_pk_fma_f32 v[100:101], v[92:93], v[140:141], v[100:101] op_sel:[1,1,0] op_sel_hi:[1,0,1] neg_lo:[0,1,0]
    v_pk_fma_f32 v[102:103], v[94:95], v[140:141], v[102:103] op_sel:[1,1,0] op_sel_hi:[1,0,1] neg_lo:[0,1,0]
    v_pk_mul_f32 v[142:143], v[140:141], v[140:141] op_sel:[0,0] op_sel_hi:[0,1]
    v_pk_fma_f32 v[142:143], v[140:141], v[140:141], v[142:143] op_sel:[1,1,0] op_sel_hi:[1,0,1] neg_lo:[0,1,0]
    v_cvt_pk_bf16_f32 v130, v100, -v101
    v_cvt_pk_bf16_f32 v131, v102, -v103
    v_pk_mul_f32 v[64:65], v[56:57], v[48:49] op_sel:[0,0] op_sel_hi:[0,1]
    v_pk_mul_f32 v[66:67], v[56:57], v[50:51] op_sel:[0,0] op_sel_hi:[0,1]
    v_pk_fma_f32 v[64:65], v[56:57], v[48:49], v[64:65] op_sel:[1,1,0] op_sel_hi:[1,0,1] neg_lo:[0,1,0]
    v_pk_fma_f32 v[66:67], v[56:57], v[50:51], v[66:67] op_sel:[1,1,0] op_sel_hi:[1,0,1] neg_lo:[0,1,0]
    v_cvt_pk_bf16_f32 v132, v64, v65
    v_cvt_pk_bf16_f32 v133, v66, v67
    v_pk_mul_f32 v[68:69], v[56:57], v[52:53] op_sel:[0,0] op_sel_hi:[0,1]
    v_pk_mul_f32 v[70:71], v[56:57], v[54:55] op_sel:[0,0] op_sel_hi:[0,1]
    v_pk_fma_f32 v[68:69], v[56:57], v[52:53], v[68:69] op_sel:[1,1,0] op_sel_hi:[1,0,1] neg_lo:[0,1,0]
    v_pk_fma_f32 v[70:71], v[56:57], v[54:55], v[70:71] op_sel:[1,1,0] op_sel_hi:[1,0,1] neg_lo:[0,1,0]
    v_cvt_pk_bf16_f32 v134, v68, v69
    v_cvt_pk_bf16_f32 v135, v70, v71
    ds_write_addtid_b32 v128 offset:14144
    ds_write_addtid_b32 v129 offset:14416
    ds_write_addtid_b32 v130 offset:14688
    ds_write_addtid_b32 v131 offset:14960
    ds_write_addtid_b32 v132 offset:3264
    ds_write_addtid_b32 v133 offset:3536
    ds_write_addtid_b32 v134 offset:3808
    ds_write_addtid_b32 v135 offset:4080
    v_pk_mul_f32 v[104:105], v[88:89], v[142:143] op_sel:[0,0] op_sel_hi:[0,1]
    v_pk_mul_f32 v[106:107], v[90:91], v[142:143] op_sel:[0,0] op_sel_hi:[0,1]
    v_pk_fma_f32 v[104:105], v[88:89], v[142:143], v[104:105] op_sel:[1,1,0] op_sel_hi:[1,0,1] neg_lo:[0,1,0]
    v_pk_fma_f32 v[106:107], v[90:91], v[142:143], v[106:107] op_sel:[1,1,0] op_sel_hi:[1,0,1] neg_lo:[0,1,0]
    v_pk_mul_f32 v[76:77], v[74:75], v[74:75] op_sel:[0,0] op_sel_hi:[0,1]
    v_pk_fma_f32 v[76:77], v[74:75], v[74:75], v[76:77] op_sel:[1,1,0] op_sel_hi:[1,0,1] neg_lo:[0,1,0]
    v_cvt_pk_bf16_f32 v128, v104, -v105
    v_cvt_pk_bf16_f32 v129, v106, -v107
    v_pk_mul_f32 v[108:109], v[92:93], v[142:143] op_sel:[0,0] op_sel_hi:[0,1]
    v_pk_mul_f32 v[110:111], v[94:95], v[142:143] op_sel:[0,0] op_sel_hi:[0,1]
    v_pk_fma_f32 v[108:109], v[92:93], v[142:143], v[108:109] op_sel:[1,1,0] op_sel_hi:[1,0,1] neg_lo:[0,1,0]
    v_pk_fma_f32 v[110:111], v[94:95], v[142:143], v[110:111] op_sel:[1,1,0] op_sel_hi:[1,0,1] neg_lo:[0,1,0]
    v_pk_mul_f32 v[78:79], v[76:77], v[74:75] op_sel:[0,0] op_sel_hi:[0,1]
    v_pk_fma_f32 v[78:79], v[76:77], v[74:75], v[78:79] op_sel:[1,1,0] op_sel_hi:[1,0,1] neg_lo:[0,1,0]
    v_cvt_pk_bf16_f32 v130, v108, -v109
    v_cvt_pk_bf16_f32 v131, v110, -v111
    v_pk_mul_f32 v[112:113], v[96:97], v[142:143] op_sel:[0,0] op_sel_hi:[0,1]
    v_pk_mul_f32 v[114:115], v[98:99], v[142:143] op_sel:[0,0] op_sel_hi:[0,1]
    v_pk_fma_f32 v[112:113], v[96:97], v[142:143], v[112:113] op_sel:[1,1,0] op_sel_hi:[1,0,1] neg_lo:[0,1,0]
    v_pk_fma_f32 v[114:115], v[98:99], v[142:143], v[114:115] op_sel:[1,1,0] op_sel_hi:[1,0,1] neg_lo:[0,1,0]
    v_pk_mul_f32 v[80:81], v[76:77], v[76:77] op_sel:[0,0] op_sel_hi:[0,1]
    v_pk_fma_f32 v[80:81], v[76:77], v[76:77], v[80:81] op_sel:[1,1,0] op_sel_hi:[1,0,1] neg_lo:[0,1,0]
    v_cvt_pk_bf16_f32 v132, v112, -v113
    v_cvt_pk_bf16_f32 v133, v114, -v115
    v_pk_mul_f32 v[116:117], v[100:101], v[142:143] op_sel:[0,0] op_sel_hi:[0,1]
    v_pk_mul_f32 v[118:119], v[102:103], v[142:143] op_sel:[0,0] op_sel_hi:[0,1]
    v_pk_fma_f32 v[116:117], v[100:101], v[142:143], v[116:117] op_sel:[1,1,0] op_sel_hi:[1,0,1] neg_lo:[0,1,0]
    v_pk_fma_f32 v[118:119], v[102:103], v[142:143], v[118:119] op_sel:[1,1,0] op_sel_hi:[1,0,1] neg_lo:[0,1,0]
    v_cvt_pk_bf16_f32 v134, v116, -v117
    v_cvt_pk_bf16_f32 v135, v118, -v119
    ds_write_addtid_b32 v128 offset:15232
    ds_write_addtid_b32 v129 offset:15504
    ds_write_addtid_b32 v130 offset:15776
    ds_write_addtid_b32 v131 offset:16048
    ds_write_addtid_b32 v132 offset:16320
    ds_write_addtid_b32 v133 offset:16592
    ds_write_addtid_b32 v134 offset:16864
    ds_write_addtid_b32 v135 offset:17136
    v_pk_mul_f32 v[90:91], v[74:75], v[44:45] op_sel:[0,0] op_sel_hi:[0,1]
    v_pk_mul_f32 v[82:83], v[80:81], v[74:75] op_sel:[0,0] op_sel_hi:[0,1]
    v_pk_fma_f32 v[90:91], v[74:75], v[44:45], v[90:91] op_sel:[1,1,0] op_sel_hi:[1,0,1] neg_lo:[0,1,0]
    v_pk_fma_f32 v[82:83], v[80:81], v[74:75], v[82:83] op_sel:[1,1,0] op_sel_hi:[1,0,1] neg_lo:[0,1,0]
    v_cvt_pk_bf16_f32 v128, v74, v75
    v_cvt_pk_bf16_f32 v129, v90, v91
    v_pk_mul_f32 v[92:93], v[74:75], v[48:49] op_sel:[0,0] op_sel_hi:[0,1]
    v_pk_mul_f32 v[94:95], v[74:75], v[52:53] op_sel:[0,0] op_sel_hi:[0,1]
    v_pk_fma_f32 v[92:93], v[74:75], v[48:49], v[92:93] op_sel:[1,1,0] op_sel_hi:[1,0,1] neg_lo:[0,1,0]
    v_pk_fma_f32 v[94:95], v[74:75], v[52:53], v[94:95] op_sel:[1,1,0] op_sel_hi:[1,0,1] neg_lo:[0,1,0]
    v_cvt_pk_bf16_f32 v130, v92, v93
    v_cvt_pk_bf16_f32 v131, v94, v95
    v_pk_mul_f32 v[96:97], v[74:75], v[56:57] op_sel:[0,0] op_sel_hi:[0,1]
    v_pk_fma_f32 v[96:97], v[74:75], v[56:57], v[96:97] op_sel:[1,1,0] op_sel_hi:[1,0,1] neg_lo:[0,1,0]
    v_cvt_pk_bf16_f32 v132, v96, v97
    v_cvt_pk_bf16_f32 v133, v80, v81
    v_pk_mul_f32 v[100:101], v[80:81], v[56:57] op_sel:[0,0] op_sel_hi:[0,1]
    v_pk_mul_f32 v[102:103], v[80:81], v[72:73] op_sel:[0,0] op_sel_hi:[0,1]
    v_pk_fma_f32 v[100:101], v[80:81], v[56:57], v[100:101] op_sel:[1,1,0] op_sel_hi:[1,0,1] neg_lo:[0,1,0]
    v_pk_fma_f32 v[102:103], v[80:81], v[72:73], v[102:103] op_sel:[1,1,0] op_sel_hi:[1,0,1] neg_lo:[0,1,0]
    v_cvt_pk_bf16_f32 v134, v100, v101
    v_cvt_pk_bf16_f32 v135, v102, v103
    ds_write_addtid_b32 v128 offset:4352
    ds_write_addtid_b32 v129 offset:4624
    ds_write_addtid_b32 v130 offset:4896
    ds_write_addtid_b32 v131 offset:5168
    ds_write_addtid_b32 v132 offset:8704
    ds_write_addtid_b32 v133 offset:8976
    ds_write_addtid_b32 v134 offset:9248
    ds_write_addtid_b32 v135 offset:9520
    v_pk_mul_f32 v[88:89], v[74:75], v[56:57] op_sel:[0,0] op_sel_hi:[0,1]
    v_pk_mul_f32 v[90:91], v[74:75], v[60:61] op_sel:[0,0] op_sel_hi:[0,1]
    v_pk_fma_f32 v[88:89], v[74:75], v[56:57], v[88:89] op_sel:[1,1,0] op_sel_hi:[1,0,1] neg_lo:[0,1,0]
    v_pk_fma_f32 v[90:91], v[74:75], v[60:61], v[90:91] op_sel:[1,1,0] op_sel_hi:[1,0,1] neg_lo:[0,1,0]
    v_cvt_pk_bf16_f32 v128, v88, v89
    v_cvt_pk_bf16_f32 v129, v90, v91
    v_pk_mul_f32 v[92:93], v[74:75], v[64:65] op_sel:[0,0] op_sel_hi:[0,1]
    v_pk_mul_f32 v[94:95], v[74:75], v[68:69] op_sel:[0,0] op_sel_hi:[0,1]
    v_pk_fma_f32 v[92:93], v[74:75], v[64:65], v[92:93] op_sel:[1,1,0] op_sel_hi:[1,0,1] neg_lo:[0,1,0]
    v_pk_fma_f32 v[94:95], v[74:75], v[68:69], v[94:95] op_sel:[1,1,0] op_sel_hi:[1,0,1] neg_lo:[0,1,0]
    v_cvt_pk_bf16_f32 v130, v92, v93
    v_cvt_pk_bf16_f32 v131, v94, v95
    v_pk_mul_f32 v[96:97], v[74:75], v[72:73] op_sel:[0,0] op_sel_hi:[0,1]
    v_pk_fma_f32 v[96:97], v[74:75], v[72:73], v[96:97] op_sel:[1,1,0] op_sel_hi:[1,0,1] neg_lo:[0,1,0]
    v_cvt_pk_bf16_f32 v132, v96, v97
    v_cvt_pk_bf16_f32 v133, v82, v83
    v_pk_mul_f32 v[100:101], v[82:83], v[56:57] op_sel:[0,0] op_sel_hi:[0,1]
    v_pk_mul_f32 v[102:103], v[82:83], v[72:73] op_sel:[0,0] op_sel_hi:[0,1]
    v_pk_fma_f32 v[100:101], v[82:83], v[56:57], v[100:101] op_sel:[1,1,0] op_sel_hi:[1,0,1] neg_lo:[0,1,0]
    v_pk_fma_f32 v[102:103], v[82:83], v[72:73], v[102:103] op_sel:[1,1,0] op_sel_hi:[1,0,1] neg_lo:[0,1,0]
    v_cvt_pk_bf16_f32 v134, v100, v101
    v_cvt_pk_bf16_f32 v135, v102, v103
    ds_write_addtid_b32 v128 offset:5440
    ds_write_addtid_b32 v129 offset:5712
    ds_write_addtid_b32 v130 offset:5984
    ds_write_addtid_b32 v131 offset:6256
    ds_write_addtid_b32 v132 offset:9792
    ds_write_addtid_b32 v133 offset:10064
    ds_write_addtid_b32 v134 offset:10336
    ds_write_addtid_b32 v135 offset:10608
    v_pk_mul_f32 v[90:91], v[76:77], v[48:49] op_sel:[0,0] op_sel_hi:[0,1]
    v_pk_mul_f32 v[84:85], v[80:81], v[76:77] op_sel:[0,0] op_sel_hi:[0,1]
    v_pk_fma_f32 v[90:91], v[76:77], v[48:49], v[90:91] op_sel:[1,1,0] op_sel_hi:[1,0,1] neg_lo:[0,1,0]
    v_pk_fma_f32 v[84:85], v[80:81], v[76:77], v[84:85] op_sel:[1,1,0] op_sel_hi:[1,0,1] neg_lo:[0,1,0]
    v_cvt_pk_bf16_f32 v128, v76, v77
    v_cvt_pk_bf16_f32 v129, v90, v91
    v_pk_mul_f32 v[92:93], v[76:77], v[56:57] op_sel:[0,0] op_sel_hi:[0,1]
    v_pk_mul_f32 v[94:95], v[76:77], v[64:65] op_sel:[0,0] op_sel_hi:[0,1]
    v_pk_fma_f32 v[92:93], v[76:77], v[56:57], v[92:93] op_sel:[1,1,0] op_sel_hi:[1,0,1] neg_lo:[0,1,0]
    v_pk_fma_f32 v[94:95], v[76:77], v[64:65], v[94:95] op_sel:[1,1,0] op_sel_hi:[1,0,1] neg_lo:[0,1,0]
    v_cvt_pk_bf16_f32 v130, v92, v93
    v_cvt_pk_bf16_f32 v131, v94, v95
    v_pk_mul_f32 v[96:97], v[76:77], v[72:73] op_sel:[0,0] op_sel_hi:[0,1]
    v_pk_fma_f32 v[96:97], v[76:77], v[72:73], v[96:97] op_sel:[1,1,0] op_sel_hi:[1,0,1] neg_lo:[0,1,0]
    v_cvt_pk_bf16_f32 v132, v96, v97
    v_cvt_pk_bf16_f32 v133, v84, v85
    v_pk_mul_f32 v[100:101], v[84:85], v[56:57] op_sel:[0,0] op_sel_hi:[0,1]
    v_pk_mul_f32 v[102:103], v[84:85], v[72:73] op_sel:[0,0] op_sel_hi:[0,1]
    v_pk_fma_f32 v[100:101], v[84:85], v[56:57], v[100:101] op_sel:[1,1,0] op_sel_hi:[1,0,1] neg_lo:[0,1,0]
    v_pk_fma_f32 v[102:103], v[84:85], v[72:73], v[102:103] op_sel:[1,1,0] op_sel_hi:[1,0,1] neg_lo:[0,1,0]
    v_cvt_pk_bf16_f32 v134, v100, v101
    v_cvt_pk_bf16_f32 v135, v102, v103
    ds_write_addtid_b32 v128 offset:6528
    ds_write_addtid_b32 v129 offset:6800
    ds_write_addtid_b32 v130 offset:7072
    ds_write_addtid_b32 v131 offset:7344
    ds_write_addtid_b32 v132 offset:10880
    ds_write_addtid_b32 v133 offset:11152
    ds_write_addtid_b32 v134 offset:11424
    ds_write_addtid_b32 v135 offset:11696
    v_pk_mul_f32 v[90:91], v[78:79], v[48:49] op_sel:[0,0] op_sel_hi:[0,1]
    v_pk_mul_f32 v[86:87], v[80:81], v[78:79] op_sel:[0,0] op_sel_hi:[0,1]
    v_pk_fma_f32 v[90:91], v[78:79], v[48:49], v[90:91] op_sel:[1,1,0] op_sel_hi:[1,0,1] neg_lo:[0,1,0]
    v_pk_fma_f32 v[86:87], v[80:81], v[78:79], v[86:87] op_sel:[1,1,0] op_sel_hi:[1,0,1] neg_lo:[0,1,0]
    v_cvt_pk_bf16_f32 v128, v78, v79
    v_cvt_pk_bf16_f32 v129, v90, v91
    v_pk_mul_f32 v[92:93], v[78:79], v[56:57] op_sel:[0,0] op_sel_hi:[0,1]
    v_pk_mul_f32 v[94:95], v[78:79], v[64:65] op_sel:[0,0] op_sel_hi:[0,1]
    v_pk_fma_f32 v[92:93], v[78:79], v[56:57], v[92:93] op_sel:[1,1,0] op_sel_hi:[1,0,1] neg_lo:[0,1,0]
    v_pk_fma_f32 v[94:95], v[78:79], v[64:65], v[94:95] op_sel:[1,1,0] op_sel_hi:[1,0,1] neg_lo:[0,1,0]
    v_cvt_pk_bf16_f32 v130, v92, v93
    v_cvt_pk_bf16_f32 v131, v94, v95
    v_pk_mul_f32 v[96:97], v[78:79], v[72:73] op_sel:[0,0] op_sel_hi:[0,1]
    v_pk_fma_f32 v[96:97], v[78:79], v[72:73], v[96:97] op_sel:[1,1,0] op_sel_hi:[1,0,1] neg_lo:[0,1,0]
    v_cvt_pk_bf16_f32 v132, v96, v97
    v_cvt_pk_bf16_f32 v133, v86, v87
    v_pk_mul_f32 v[100:101], v[86:87], v[56:57] op_sel:[0,0] op_sel_hi:[0,1]
    v_pk_mul_f32 v[102:103], v[86:87], v[72:73] op_sel:[0,0] op_sel_hi:[0,1]
    v_pk_fma_f32 v[100:101], v[86:87], v[56:57], v[100:101] op_sel:[1,1,0] op_sel_hi:[1,0,1] neg_lo:[0,1,0]
    v_pk_fma_f32 v[102:103], v[86:87], v[72:73], v[102:103] op_sel:[1,1,0] op_sel_hi:[1,0,1] neg_lo:[0,1,0]
    v_cvt_pk_bf16_f32 v134, v100, v101
    v_cvt_pk_bf16_f32 v135, v102, v103
    ds_write_addtid_b32 v128 offset:7616
    ds_write_addtid_b32 v129 offset:7888
    ds_write_addtid_b32 v130 offset:8160
    ds_write_addtid_b32 v131 offset:8432
    ds_write_addtid_b32 v132 offset:11968
    ds_write_addtid_b32 v133 offset:12240
    ds_write_addtid_b32 v134 offset:12512
    ds_write_addtid_b32 v135 offset:12784
    s_cmp_lg_u32 s86, 0
    s_cbranch_scc1 LF_nomod2_5
    v_lshlrev_b32 v56, 16, v186
    v_and_b32 v57, 0xffff0000, v186
    v_mul_f32 v58, 0xbfb8aa3b, v56
    v_mul_f32 v59, 0xbfb8aa3b, v57
    v_exp_f32 v58, v58
    v_exp_f32 v59, v59
    v_add_f32 v58, 1.0, v58
    v_add_f32 v59, 1.0, v59
    v_rcp_f32 v58, v58
    v_rcp_f32 v59, v59
    v_mul_f32 v56, v56, v58
    v_mul_f32 v57, v57, v59
    v_cvt_pk_bf16_f32 v56, v56, v57
    s_lshl_b32 s44, s70, 8
    s_add_u32 s44, s44, 128256
    v_lshl_add_u32 v57, v1, 2, s44
    ds_write_b32 v57, v56
    v_lshrrev_b32 v58, 4, v1
    v_lshl_add_u32 v57, v58, 4, s44
    v_lshl_add_u32 v59, v58, 9, v187
    s_lshl_b32 s45, s70, 5
    s_add_u32 s45, s45, 111872
    v_add_u32 v59, s45, v59
    s_waitcnt vmcnt(6)
    s_waitcnt lgkmcnt(0)
    s_barrier
    ds_read_b128 v[60:63], v57 offset:0
    ds_read_b64_tr_b16 v[64:65], v59 offset:0
    ds_read_b64_tr_b16 v[66:67], v59 offset:512
    ds_read_b128 v[68:71], v57 offset:64
    ds_read_b64_tr_b16 v[72:73], v59 offset:4096
    ds_read_b64_tr_b16 v[74:75], v59 offset:4608
    ds_read_b128 v[76:79], v57 offset:128
    ds_read_b64_tr_b16 v[80:81], v59 offset:8192
    ds_read_b64_tr_b16 v[82:83], v59 offset:8704
    ds_read_b128 v[84:87], v57 offset:192
    ds_read_b64_tr_b16 v[88:89], v59 offset:12288
    ds_read_b64_tr_b16 v[90:91], v59 offset:12800
    s_mul_i32 s44, s82, 24576
    s_lshl_b32 s45, s83, 9
    s_add_u32 s44, s44, s45
    s_lshl_b32 s45, s70, 7
    s_add_u32 s44, s44, s45
    s_add_u32 s44, s44, 32768
    v_lshlrev_b32 v59, 3, v1
    s_waitcnt lgkmcnt(9)
    v_mfma_f32_16x16x32_bf16 v[92:95], v[60:63], v[64:67], 0
    s_waitcnt lgkmcnt(6)
    v_mfma_f32_16x16x32_bf16 v[92:95], v[68:71], v[72:75], v[92:95]
    s_waitcnt lgkmcnt(3)
    v_mfma_f32_16x16x32_bf16 v[92:95], v[76:79], v[80:83], v[92:95]
    s_waitcnt lgkmcnt(0)
    v_mfma_f32_16x16x32_bf16 v[92:95], v[84:87], v[88:91], v[92:95]
    s_barrier
    s_nop 6
    v_mov_b32 v93, s68
    s_mov_b64 exec, 0xffff
    buffer_store_dwordx2 v[92:93], v59, s[4:7], s44 offen sc1
    s_mov_b64 exec, -1
LF_nomod2_5:
    s_cmp_ge_u32 s86, 3
    s_cselect_b32 s13, 3, 0
    s_sub_u32 s86, s86, s13
    s_lshr_b32 s76, s70, 1
    s_mul_i32 s74, s76, 34816
    v_and_b32 v6, 15, v1
    v_mul_u32_u24 v3, 272, v6
    v_lshrrev_b32 v7, 4, v1
    v_lshl_add_u32 v3, v7, 4, v3
    v_add_u32 v3, s74, v3
    s_and_b32 s75, s70, 1
    s_mul_i32 s75, s75, 4352
    v_add_u32 v4, s75, v3
    s_mul_i32 s76, s76, 8320
    s_add_u32 s76, s76, 69632
    v_lshlrev_b32 v6, 5, v6
    v_sub_u32 v6, s76, v6
    v_lshlrev_b32 v9, 9, v7
    v_sub_u32 v9, v6, v9
    s_waitcnt lgkmcnt(0)
    s_barrier
    ds_read_b128 v[48:51], v3 offset:13056
    ds_read_b128 v[40:43], v4 offset:0
    ds_read_b128 v[44:47], v3 offset:8704
    ds_read_b128 v[60:63], v3 offset:13120
    ds_read_b128 v[52:55], v4 offset:64
    ds_read_b128 v[56:59], v3 offset:8768
    ds_read_b128 v[72:75], v3 offset:13184
    ds_read_b128 v[64:67], v4 offset:128
    ds_read_b128 v[68:71], v3 offset:8832
    ds_read_b128 v[84:87], v3 offset:13248
    ds_read_b128 v[76:79], v4 offset:192
    ds_read_b128 v[80:83], v3 offset:8896
    ds_read_b128 v[96:99], v3 offset:30464
    ds_read_b128 v[88:91], v4 offset:17408
    ds_read_b128 v[92:95], v3 offset:26112
    ds_read_b128 v[108:111], v3 offset:30528
    ds_read_b128 v[100:103], v4 offset:17472
    ds_read_b128 v[104:107], v3 offset:26176
    ds_read_b128 v[120:123], v3 offset:30592
    ds_read_b128 v[112:115], v4 offset:17536
    ds_read_b128 v[116:119], v3 offset:26240
    ds_read_b128 v[132:135], v3 offset:30656
    ds_read_b128 v[124:127], v4 offset:17600
    ds_read_b128 v[128:131], v3 offset:26304
    s_waitcnt lgkmcnt(15)
    v_mfma_f32_16x16x32_bf16 v[136:139], v[40:43], v[48:51], 0
    v_mfma_f32_16x16x32_bf16 v[140:143], v[44:47], v[48:51], 0
    v_mfma_f32_16x16x32_bf16 v[136:139], v[52:55], v[60:63], v[136:139]
    v_mfma_f32_16x16x32_bf16 v[140:143], v[56:59], v[60:63], v[140:143]
    v_mfma_f32_16x16x32_bf16 v[136:139], v[64:67], v[72:75], v[136:139]
    v_mfma_f32_16x16x32_bf16 v[140:143], v[68:71], v[72:75], v[140:143]
    s_waitcnt lgkmcnt(13)
    v_mfma_f32_16x16x32_bf16 v[136:139], v[76:79], v[84:87], v[136:139]
    s_waitcnt lgkmcnt(12)
    v_mfma_f32_16x16x32_bf16 v[140:143], v[80:83], v[84:87], v[140:143]
    s_waitcnt lgkmcnt(10)
    v_mfma_f32_16x16x32_bf16 v[136:139], v[88:91], v[96:99], v[136:139]
    s_waitcnt lgkmcnt(9)
    v_mfma_f32_16x16x32_bf16 v[140:143], v[92:95], v[96:99], v[140:143]
    s_waitcnt lgkmcnt(7)
    v_mfma_f32_16x16x32_bf16 v[136:139], v[100:103], v[108:111], v[136:139]
    s_waitcnt lgkmcnt(6)
    v_mfma_f32_16x16x32_bf16 v[140:143], v[104:107], v[108:111], v[140:143]
    s_waitcnt lgkmcnt(4)
    v_mfma_f32_16x16x32_bf16 v[136:139], v[112:115], v[120:123], v[136:139]
    s_waitcnt lgkmcnt(3)
    v_mfma_f32_16x16x32_bf16 v[140:143], v[116:119], v[120:123], v[140:143]
    s_waitcnt lgkmcnt(1)
    v_mfma_f32_16x16x32_bf16 v[136:139], v[124:127], v[132:135], v[136:139]
    s_waitcnt lgkmcnt(0)
    v_mfma_f32_16x16x32_bf16 v[140:143], v[128:131], v[132:135], v[140:143]
    buffer_load_dwordx4 v[144:147], v190, s[4:7], s34 offen offset:0 sc1
    buffer_load_dwordx4 v[148:151], v190, s[4:7], s34 offen offset:1024 sc1
    buffer_load_dwordx4 v[152:155], v190, s[4:7], s34 offen offset:2048 sc1
    buffer_load_dwordx4 v[156:159], v190, s[4:7], s34 offen offset:3072 sc1
    buffer_load_dwordx4 v[20:23], v190, s[4:7], s35 offen offset:0 sc1
    buffer_load_dwordx4 v[24:27], v190, s[4:7], s35 offen offset:1024 sc1
    buffer_load_dwordx4 v[28:31], v190, s[4:7], s35 offen offset:2048 sc1
    buffer_load_dwordx4 v[32:35], v190, s[4:7], s35 offen offset:3072 sc1
    buffer_load_dwordx2 v[160:161], v191, s[4:7], s33 offen sc1
    s_bitcmp1_b32 s70, 0
    s_cbranch_scc1 LF_kh1_6
    v_lshlrev_b32 v8, 3, v7
    v_sub_u32 v8, v6, v8
    v_cvt_pk_bf16_f32 v52, v143, v143
    v_cvt_pk_bf16_f32 v53, v143, v143
    v_cvt_pk_bf16_f32 v54, v142, v142
    v_cvt_pk_bf16_f32 v55, v142, v142
    v_cvt_pk_bf16_f32 v56, v142, v142
    v_cvt_pk_bf16_f32 v57, v142, v141
    v_cvt_pk_bf16_f32 v58, v141, v141
    v_cvt_pk_bf16_f32 v59, v141, v141
    ds_write_b128 v9, v[52:55] offset:2016
    v_cvt_pk_bf16_f32 v60, v143, v143
    v_cvt_pk_bf16_f32 v61, v143, v143
    v_cvt_pk_bf16_f32 v62, v143, v142
    v_cvt_pk_bf16_f32 v63, v142, v142
    v_cvt_pk_bf16_f32 v64, v142, v142
    v_cvt_pk_bf16_f32 v65, v142, v142
    v_cvt_pk_bf16_f32 v66, v141, v141
    v_cvt_pk_bf16_f32 v67, v141, v141
    ds_write_b128 v9, v[56:59] offset:2032
    v_cvt_pk_bf16_f32 v48, v139, v138
    v_cvt_pk_bf16_f32 v49, v137, v136
    v_cvt_pk_bf16_f32 v50, v138, v137
    ds_write_b128 v9, v[60:63] offset:6176
    ds_write_b128 v9, v[64:67] offset:6192
    ds_write_b64 v8, v[48:49] offset:4088
    ds_write_b16 v8, v48 offset:8250
    ds_write_b32 v8, v50 offset:8252
    ds_write_b16_d16_hi v8, v49 offset:8256
    s_branch LF_kj_7
LF_kh1_6:
    v_lshlrev_b32 v8, 4, v7
    v_sub_u32 v8, v6, v8
    v_cvt_pk_bf16_f32 v52, v140, v140
    v_cvt_pk_bf16_f32 v53, v139, v139
    v_cvt_pk_bf16_f32 v54, v139, v138
    v_cvt_pk_bf16_f32 v55, v138, v138
    v_cvt_pk_bf16_f32 v56, v138, v138
    v_cvt_pk_bf16_f32 v57, v137, v137
    v_cvt_pk_bf16_f32 v58, v137, v136
    v_cvt_pk_bf16_f32 v59, v136, v136
    s_mov_b32 exec_lo, 0
    ds_write_b128 v9, v[52:55] offset:4064
    ds_write_b128 v9, v[56:59] offset:4080
    s_mov_b32 exec_lo, -1
    v_cvt_pk_bf16_f32 v60, v140, v140
    v_cvt_pk_bf16_f32 v61, v140, v139
    v_cvt_pk_bf16_f32 v62, v139, v139
    v_cvt_pk_bf16_f32 v63, v138, v138
    v_cvt_pk_bf16_f32 v64, v138, v138
    v_cvt_pk_bf16_f32 v65, v138, v137
    v_cvt_pk_bf16_f32 v66, v137, v137
    v_cvt_pk_bf16_f32 v67, v136, v136
    s_mov_b32 exec_lo, 0
    ds_write_b128 v9, v[60:63] offset:8224
    ds_write_b128 v9, v[64:67] offset:8240
    s_mov_b32 exec_lo, -1
    v_cvt_pk_bf16_f32 v40, v140, v139
    v_cvt_pk_bf16_f32 v41, v138, v138
    v_cvt_pk_bf16_f32 v42, v138, v137
    v_cvt_pk_bf16_f32 v43, v136, v136
    v_cvt_pk_bf16_f32 v44, v140, v140
    v_cvt_pk_bf16_f32 v45, v139, v138
    v_cvt_pk_bf16_f32 v46, v138, v138
    v_cvt_pk_bf16_f32 v47, v137, v136
    s_mov_b32 exec_hi, 0
    ds_write_b128 v8, v[40:43] offset:3568
    ds_write_b128 v8, v[44:47] offset:7728
    ds_write_b16 v8, v43 offset:7744
    s_mov_b32 exec_hi, -1
LF_kj_7:
    s_waitcnt vmcnt(0)
LF_h0ck_10:
    v_min3_u32 v11, v145, v21, v161
    v_max3_u32 v12, v145, v21, v161
    v_min3_u32 v11, v147, v23, v11
    v_max3_u32 v12, v147, v23, v12
    v_min3_u32 v11, v149, v25, v11
    v_max3_u32 v12, v149, v25, v12
    v_min3_u32 v11, v151, v27, v11
    v_max3_u32 v12, v151, v27, v12
    v_min3_u32 v11, v153, v29, v11
    v_max3_u32 v12, v153, v29, v12
    v_min3_u32 v11, v155, v31, v11
    v_max3_u32 v12, v155, v31, v12
    v_min3_u32 v11, v157, v33, v11
    v_max3_u32 v12, v157, v33, v12
    v_min3_u32 v11, v159, v35, v11
    v_max3_u32 v12, v159, v35, v12
    v_xor_b32 v11, s68, v11
    v_xor_b32 v12, s68, v12
    v_or_b32 v7, v11, v12
    v_cmp_ne_u32 vcc, 0, v7
    s_nop 0
    s_cbranch_vccz LF_h0ok_9
    s_sub_u32 s78, s78, 1
    s_cmp_lg_u32 s78, 0
    s_cbranch_scc1 LF_h0_8
LF_h0ok_9:
    v_add_f32_dpp v8, v160, v160 quad_perm:[1,0,3,2] row_mask:0xf bank_mask:0xf
    v_lshlrev_b32 v64, 16, v144
    v_lshlrev_b32 v65, 16, v146
    v_lshlrev_b32 v66, 16, v148
    v_lshlrev_b32 v67, 16, v150
    v_add_f32_dpp v8, v8, v8 quad_perm:[2,3,0,1] row_mask:0xf bank_mask:0xf
    v_lshlrev_b32 v68, 16, v152
    v_lshlrev_b32 v69, 16, v154
    v_lshlrev_b32 v70, 16, v156
    v_lshlrev_b32 v71, 16, v158
    v_cvt_pk_bf16_f32 v8, v8, v8
    s_add_u32 m0, s12, 131072
    s_add_u32 s14, s18, 0
    buffer_load_dwordx4 v240, s[8:11], s14 offen lds
    v_rcp_f32 v64, v64
    v_and_b32 v8, 0xffff0000, v8
    v_rcp_f32 v65, v65
    v_add_f32 v9, 1.0, v8
    v_rcp_f32 v66, v66
    v_cvt_pk_bf16_f32 v9, v9, v9
    v_rcp_f32 v67, v67
    v_and_b32 v9, 0xffff0000, v9
    v_readlane_b32 s82, v8, 0
    v_readlane_b32 s83, v8, 4
    buffer_load_dwordx4 v247, s[8:11], s14 offen offset:1024 lds
    v_and_b32 v56, 0xffff0000, v144
    v_lshlrev_b32 v72, 16, v20
    v_and_b32 v73, 0xffff0000, v20
    v_readlane_b32 s84, v9, 8
    v_readlane_b32 s85, v9, 12
    v_and_b32 v57, 0xffff0000, v146
    v_lshlrev_b32 v74, 16, v22
    v_and_b32 v75, 0xffff0000, v22
    v_readlane_b32 s86, v8, 16
    v_readlane_b32 s87, v8, 20
    s_add_u32 m0, s12, 139264
    s_add_u32 s14, s19, 0
    buffer_load_dwordx4 v240, s[8:11], s14 offen lds
    v_and_b32 v58, 0xffff0000, v148
    v_lshlrev_b32 v80, 16, v24
    v_and_b32 v81, 0xffff0000, v24
    v_and_b32 v59, 0xffff0000, v150
    v_lshlrev_b32 v82, 16, v26
    v_and_b32 v83, 0xffff0000, v26
    v_readlane_b32 s90, v9, 32
    v_readlane_b32 s91, v9, 36
    v_rcp_f32 v68, v68
    v_and_b32 v60, 0xffff0000, v152
    v_lshlrev_b32 v76, 16, v28
    buffer_load_dwordx4 v247, s[8:11], s14 offen offset:1024 lds
    v_and_b32 v77, 0xffff0000, v28
    v_readlane_b32 s92, v8, 40
    v_readlane_b32 s93, v8, 44
    v_rcp_f32 v69, v69
    v_and_b32 v61, 0xffff0000, v154
    v_lshlrev_b32 v78, 16, v30
    v_and_b32 v79, 0xffff0000, v30
    v_rcp_f32 v70, v70
    v_and_b32 v62, 0xffff0000, v156
    v_lshlrev_b32 v84, 16, v32
    s_add_u32 m0, s12, 147456
    s_add_u32 s14, s20, 0
    buffer_load_dwordx4 v240, s[8:11], s14 offen lds
    v_and_b32 v85, 0xffff0000, v32
    v_rcp_f32 v71, v71
    v_and_b32 v63, 0xffff0000, v158
    v_lshlrev_b32 v86, 16, v34
    v_and_b32 v87, 0xffff0000, v34
    v_mov_b32 v16, s86
    v_mov_b32 v17, s87
    v_pk_add_f32 v[88:89], v[72:73], v[56:57] neg_lo:[0,1] neg_hi:[0,1]
    v_pk_add_f32 v[90:91], v[74:75], v[58:59] neg_lo:[0,1] neg_hi:[0,1]
    v_pk_add_f32 v[92:93], v[76:77], v[60:61] neg_lo:[0,1] neg_hi:[0,1]
    buffer_load_dwordx4 v247, s[8:11], s14 offen offset:1024 lds
    v_pk_add_f32 v[94:95], v[78:79], v[62:63] neg_lo:[0,1] neg_hi:[0,1]
    v_pk_add_f32 v[96:97], v[80:81], v[56:57] neg_lo:[0,1] neg_hi:[0,1]
    v_pk_add_f32 v[98:99], v[82:83], v[58:59] neg_lo:[0,1] neg_hi:[0,1]
    v_pk_add_f32 v[100:101], v[84:85], v[60:61] neg_lo:[0,1] neg_hi:[0,1]
    v_pk_add_f32 v[102:103], v[86:87], v[62:63] neg_lo:[0,1] neg_hi:[0,1]
    v_mul_f32 v10, s84, v16
    v_mul_f32 v11, s85, v17
    v_mul_f32 v12, s82, v16
    v_mul_f32 v13, s83, v17
    s_lshl_b32 s74, s73, 16
    s_add_u32 m0, s12, 111872
    s_add_u32 s14, s21, 0
    buffer_load_dwordx4 v240, s[8:11], s14 offen lds
    s_and_b32 s75, s73, 0xffff0000
    v_mov_b32 v14, s74
    v_mov_b32 v15, s75
    v_pk_mul_f32 v[88:89], v[88:89], v[64:65]
    v_pk_mul_f32 v[90:91], v[90:91], v[66:67]
    v_pk_mul_f32 v[92:93], v[92:93], v[68:69]
    v_pk_mul_f32 v[94:95], v[94:95], v[70:71]
    v_pk_mul_f32 v[96:97], v[96:97], v[64:65]
    v_pk_mul_f32 v[98:99], v[98:99], v[66:67]
    v_pk_mul_f32 v[100:101], v[100:101], v[68:69]
    v_pk_mul_f32 v[102:103], v[102:103], v[70:71]
    buffer_load_dwordx4 v247, s[8:11], s14 offen offset:1024 lds
    v_pk_fma_f32 v[88:89], v[88:89], v[10:11], v[12:13] op_sel:[0,0,0] op_sel_hi:[1,0,0]
    v_pk_fma_f32 v[90:91], v[90:91], v[10:11], v[12:13] op_sel:[0,0,0] op_sel_hi:[1,0,0]
    v_pk_fma_f32 v[92:93], v[92:93], v[10:11], v[12:13] op_sel:[0,0,0] op_sel_hi:[1,0,0]
    v_pk_fma_f32 v[94:95], v[94:95], v[10:11], v[12:13] op_sel:[0,0,0] op_sel_hi:[1,0,0]
    v_pk_fma_f32 v[96:97], v[96:97], v[10:11], v[12:13] op_sel:[0,1,1] op_sel_hi:[1,1,1]
    v_pk_fma_f32 v[98:99], v[98:99], v[10:11], v[12:13] op_sel:[0,1,1] op_sel_hi:[1,1,1]
    v_pk_fma_f32 v[100:101], v[100:101], v[10:11], v[12:13] op_sel:[0,1,1] op_sel_hi:[1,1,1]
    v_pk_fma_f32 v[102:103], v[102:103], v[10:11], v[12:13] op_sel:[0,1,1] op_sel_hi:[1,1,1]
    v_cvt_pk_bf16_f32 v120, v88, v89
    v_cvt_pk_bf16_f32 v121, v90, v91
    s_add_u32 m0, s12, 120064
    s_add_u32 s14, s22, 0
    buffer_load_dwordx4 v240, s[8:11], s14 offen lds
    v_cvt_pk_bf16_f32 v122, v92, v93
    v_cvt_pk_bf16_f32 v123, v94, v95
    ds_write_b128 v183, v[120:123] offset:0
    v_cvt_pk_bf16_f32 v124, v96, v97
    v_cvt_pk_bf16_f32 v125, v98, v99
    v_cvt_pk_bf16_f32 v126, v100, v101
    v_cvt_pk_bf16_f32 v127, v102, v103
    ds_write_b128 v183, v[124:127] offset:4608
    v_pk_fma_f32 v[104:105], v[88:89], v[14:15], v[72:73] op_sel:[0,0,0] op_sel_hi:[1,0,1]
    v_pk_fma_f32 v[106:107], v[90:91], v[14:15], v[74:75] op_sel:[0,0,0] op_sel_hi:[1,0,1]
    buffer_load_dwordx4 v247, s[8:11], s14 offen offset:1024 lds
    ds_write_b128 v184, v[104:107] offset:0
    v_pk_fma_f32 v[108:109], v[92:93], v[14:15], v[76:77] op_sel:[0,0,0] op_sel_hi:[1,0,1]
    v_pk_fma_f32 v[110:111], v[94:95], v[14:15], v[78:79] op_sel:[0,0,0] op_sel_hi:[1,0,1]
    ds_write_b128 v184, v[108:111] offset:16
    v_pk_fma_f32 v[112:113], v[96:97], v[14:15], v[80:81] op_sel:[0,1,0] op_sel_hi:[1,1,1]
    v_pk_fma_f32 v[114:115], v[98:99], v[14:15], v[82:83] op_sel:[0,1,0] op_sel_hi:[1,1,1]
    ds_write_b128 v184, v[112:115] offset:8192
    v_pk_fma_f32 v[116:117], v[100:101], v[14:15], v[84:85] op_sel:[0,1,0] op_sel_hi:[1,1,1]
    v_pk_fma_f32 v[118:119], v[102:103], v[14:15], v[86:87] op_sel:[0,1,0] op_sel_hi:[1,1,1]
    ds_write_b128 v184, v[116:119] offset:8208
    s_cmp_lt_u32 s79, 28
    s_cbranch_scc1 LF_hm_11
    s_mov_b32 s47, 45056
    buffer_load_dwordx4 v[200:203], v236, s[4:7], s47 offen sc1
    s_mov_b32 s47, 69632
    buffer_load_dwordx4 v[204:207], v236, s[4:7], s47 offen sc1
    s_mov_b32 s47, 94208
    buffer_load_dwordx4 v[208:211], v236, s[4:7], s47 offen sc1
    s_mov_b32 s47, 118784
    buffer_load_dwordx4 v[212:215], v236, s[4:7], s47 offen sc1
    s_mov_b32 s47, 49152
    buffer_load_dwordx4 v[216:219], v236, s[4:7], s47 offen sc1
    s_mov_b32 s47, 73728
    buffer_load_dwordx4 v[220:223], v236, s[4:7], s47 offen sc1
    s_mov_b32 s47, 98304
    buffer_load_dwordx4 v[224:227], v236, s[4:7], s47 offen sc1
    s_mov_b32 s47, 122880
    buffer_load_dwordx4 v[228:231], v236, s[4:7], s47 offen sc1
LF_hm_11:
    s_lshl_b32 s74, s2, 2
    s_add_u32 s74, s74, s70
    s_mul_i32 s74, s74, 1792
    v_min_u32 v197, 13, v1
    v_lshlrev_b32 v197, 7, v197
    buffer_load_dword v198, v197, s[60:63], s74 offen
    s_waitcnt lgkmcnt(0)
    s_barrier
    s_cmp_lg_u32 s17, 0
    s_cbranch_scc1 LF_cp1_12
    ds_read_b128 v[4:7], v173 offset:0
    ds_read_b128 v[8:11], v173 offset:1024
    ds_read_b128 v[12:15], v173 offset:2048
    ds_read_b128 v[16:19], v173 offset:3072
    v_mov_b32 v20, 0
    v_mov_b32 v21, 0
    v_mov_b32 v22, 0
    v_mov_b32 v23, 0
    v_mov_b32 v24, 0
    v_mov_b32 v25, 0
    v_mov_b32 v26, 0
    v_mov_b32 v27, 0
    v_mov_b32 v28, 0
    v_mov_b32 v29, 0
    v_mov_b32 v30, 0
    v_mov_b32 v31, 0
    v_mov_b32 v32, 0
    v_mov_b32 v33, 0
    v_mov_b32 v34, 0
    v_mov_b32 v35, 0
    s_branch LF_cj_13
LF_cp1_12:
    ds_read_b128 v[20:23], v173 offset:0
    ds_read_b128 v[24:27], v173 offset:1024
    ds_read_b128 v[28:31], v173 offset:2048
    ds_read_b128 v[32:35], v173 offset:3072
    v_mov_b32 v4, 0
    v_mov_b32 v5, 0
    v_mov_b32 v6, 0
    v_mov_b32 v7, 0
    v_mov_b32 v8, 0
    v_mov_b32 v9, 0
    v_mov_b32 v10, 0
    v_mov_b32 v11, 0
    v_mov_b32 v12, 0
    v_mov_b32 v13, 0
    v_mov_b32 v14, 0
    v_mov_b32 v15, 0
    v_mov_b32 v16, 0
    v_mov_b32 v17, 0
    v_mov_b32 v18, 0
    v_mov_b32 v19, 0
LF_cj_13:
    ds_read_b128 v[72:75], v172 offset:192
    ds_read2_b32 v[40:41], v168 offset0:176 offset1:177
    ds_read2_b32 v[42:43], v168 offset0:178 offset1:179
    ds_read_b128 v[76:79], v172 offset:704
    ds_read2_b32 v[44:45], v168 offset0:48 offset1:49
    ds_read2_b32 v[46:47], v168 offset0:50 offset1:51
    ds_read_b128 v[80:83], v172 offset:1216
    ds_read2_b32 v[48:49], v169 offset0:176 offset1:177
    ds_read2_b32 v[50:51], v169 offset0:178 offset1:179
    ds_read_b128 v[84:87], v172 offset:1728
    ds_read2_b32 v[52:53], v169 offset0:48 offset1:49
    ds_read2_b32 v[54:55], v169 offset0:50 offset1:51
    ds_read_b128 v[88:91], v172 offset:2240
    ds_read2_b32 v[56:57], v170 offset0:176 offset1:177
    ds_read2_b32 v[58:59], v170 offset0:178 offset1:179
    ds_read_b128 v[92:95], v172 offset:2752
    ds_read2_b32 v[60:61], v170 offset0:48 offset1:49
    ds_read2_b32 v[62:63], v170 offset0:50 offset1:51
    ds_read_b128 v[96:99], v172 offset:3264
    ds_read2_b32 v[64:65], v171 offset0:176 offset1:177
    ds_read2_b32 v[66:67], v171 offset0:178 offset1:179
    ds_read_b128 v[100:103], v172 offset:3776
    ds_read2_b32 v[68:69], v171 offset0:48 offset1:49
    ds_read2_b32 v[70:71], v171 offset0:50 offset1:51
    s_waitcnt lgkmcnt(15)
    v_mfma_f32_16x16x32_bf16 v[4:7], v[40:43], v[72:75], v[4:7]
    s_add_u32 m0, s12, 0
    v_mfma_f32_16x16x32_bf16 v[8:11], v[40:43], v[76:79], v[8:11]
    s_add_u32 s14, s23, 0
    buffer_load_dwordx4 v240, s[8:11], s14 offen lds
    v_mfma_f32_16x16x32_bf16 v[8:11], v[44:47], v[72:75], v[8:11]
    v_mfma_f32_16x16x32_bf16 v[12:15], v[44:47], v[76:79], v[12:15]
    v_mfma_f32_16x16x32_bf16 v[12:15], v[40:43], v[80:83], v[12:15]
    v_mfma_f32_16x16x32_bf16 v[16:19], v[44:47], v[80:83], v[16:19]
    buffer_load_dwordx4 v247, s[8:11], s14 offen offset:1024 lds
    v_mfma_f32_16x16x32_bf16 v[12:15], v[48:51], v[72:75], v[12:15]
    s_add_u32 m0, s12, 8192
    s_add_u32 s14, s24, 0
    v_mfma_f32_16x16x32_bf16 v[16:19], v[48:51], v[76:79], v[16:19]
    v_mfma_f32_16x16x32_bf16 v[20:23], v[48:51], v[80:83], v[20:23]
    s_waitcnt lgkmcnt(14)
    v_mfma_f32_16x16x32_bf16 v[16:19], v[40:43], v[84:87], v[16:19]
    buffer_load_dwordx4 v240, s[8:11], s14 offen lds
    v_mfma_f32_16x16x32_bf16 v[20:23], v[44:47], v[84:87], v[20:23]
    ds_read_b128 v[136:139], v172 offset:128
    v_mfma_f32_16x16x32_bf16 v[24:27], v[48:51], v[84:87], v[24:27]
    s_waitcnt lgkmcnt(13)
    ds_read2_b32 v[104:105], v168 offset0:160 offset1:161
    v_mfma_f32_16x16x32_bf16 v[16:19], v[52:55], v[72:75], v[16:19]
    ds_read2_b32 v[106:107], v168 offset0:162 offset1:163
    v_mfma_f32_16x16x32_bf16 v[20:23], v[52:55], v[76:79], v[20:23]
    ds_read_b128 v[140:143], v172 offset:640
    buffer_load_dwordx4 v247, s[8:11], s14 offen offset:1024 lds
    v_mfma_f32_16x16x32_bf16 v[24:27], v[52:55], v[80:83], v[24:27]
    s_add_u32 m0, s12, 16384
    ds_read2_b32 v[108:109], v168 offset0:32 offset1:33
    v_mfma_f32_16x16x32_bf16 v[28:31], v[52:55], v[84:87], v[28:31]
    s_waitcnt lgkmcnt(15)
    ds_read2_b32 v[110:111], v168 offset0:34 offset1:35
    v_mfma_f32_16x16x32_bf16 v[20:23], v[40:43], v[88:91], v[20:23]
    s_add_u32 s14, s25, 0
    ds_read_b128 v[144:147], v172 offset:1152
    v_mfma_f32_16x16x32_bf16 v[24:27], v[44:47], v[88:91], v[24:27]
    ds_read2_b32 v[112:113], v169 offset0:160 offset1:161
    buffer_load_dwordx4 v240, s[8:11], s14 offen lds
    v_mfma_f32_16x16x32_bf16 v[28:31], v[48:51], v[88:91], v[28:31]
    ds_read2_b32 v[114:115], v169 offset0:162 offset1:163
    v_mfma_f32_16x16x32_bf16 v[32:35], v[52:55], v[88:91], v[32:35]
    s_waitcnt lgkmcnt(15)
    ds_read_b128 v[148:151], v172 offset:1664
    v_mfma_f32_16x16x32_bf16 v[20:23], v[56:59], v[72:75], v[20:23]
    ds_read2_b32 v[116:117], v169 offset0:32 offset1:33
    v_mfma_f32_16x16x32_bf16 v[24:27], v[56:59], v[76:79], v[24:27]
    ds_read2_b32 v[118:119], v169 offset0:34 offset1:35
    buffer_load_dwordx4 v247, s[8:11], s14 offen offset:1024 lds
    v_mfma_f32_16x16x32_bf16 v[28:31], v[56:59], v[80:83], v[28:31]
    s_add_u32 m0, s12, 24576
    ds_read_b128 v[152:155], v172 offset:2176
    v_mfma_f32_16x16x32_bf16 v[32:35], v[56:59], v[84:87], v[32:35]
    ds_read2_b32 v[120:121], v170 offset0:160 offset1:161
    v_mfma_f32_16x16x32_bf16 v[24:27], v[40:43], v[92:95], v[24:27]
    s_add_u32 s14, s18, 458752
    ds_read2_b32 v[122:123], v170 offset0:162 offset1:163
    v_mfma_f32_16x16x32_bf16 v[28:31], v[44:47], v[92:95], v[28:31]
    ds_read_b128 v[156:159], v172 offset:2688
    buffer_load_dwordx4 v240, s[8:11], s14 offen lds
    v_mfma_f32_16x16x32_bf16 v[32:35], v[48:51], v[92:95], v[32:35]
    ds_read2_b32 v[124:125], v170 offset0:32 offset1:33
    v_mfma_f32_16x16x32_bf16 v[24:27], v[60:63], v[72:75], v[24:27]
    ds_read2_b32 v[126:127], v170 offset0:34 offset1:35
    v_mfma_f32_16x16x32_bf16 v[28:31], v[60:63], v[76:79], v[28:31]
    ds_read_b128 v[160:163], v172 offset:3200
    v_mfma_f32_16x16x32_bf16 v[32:35], v[60:63], v[80:83], v[32:35]
    s_waitcnt lgkmcnt(15)
    ds_read2_b32 v[128:129], v171 offset0:160 offset1:161
    buffer_load_dwordx4 v247, s[8:11], s14 offen offset:1024 lds
    v_mfma_f32_16x16x32_bf16 v[28:31], v[40:43], v[96:99], v[28:31]
    s_add_u32 m0, s12, 32768
    ds_read2_b32 v[130:131], v171 offset0:162 offset1:163
    v_mfma_f32_16x16x32_bf16 v[32:35], v[44:47], v[96:99], v[32:35]
    ds_read_b128 v[164:167], v172 offset:3712
    v_mfma_f32_16x16x32_bf16 v[28:31], v[64:67], v[72:75], v[28:31]
    s_add_u32 s14, s19, 458752
    ds_read2_b32 v[132:133], v171 offset0:32 offset1:33
    v_mfma_f32_16x16x32_bf16 v[32:35], v[64:67], v[76:79], v[32:35]
    ds_read2_b32 v[134:135], v171 offset0:34 offset1:35
    buffer_load_dwordx4 v240, s[8:11], s14 offen lds
    v_mfma_f32_16x16x32_bf16 v[32:35], v[40:43], v[100:103], v[32:35]
    v_mfma_f32_16x16x32_bf16 v[32:35], v[68:71], v[72:75], v[32:35]
    v_mfma_f32_16x16x32_bf16 v[4:7], v[104:107], v[136:139], v[4:7]
    ds_read_b128 v[72:75], v172 offset:64
    buffer_load_dwordx4 v247, s[8:11], s14 offen offset:1024 lds
    v_mfma_f32_16x16x32_bf16 v[8:11], v[104:107], v[140:143], v[8:11]
    s_waitcnt lgkmcnt(15)
    ds_read2_b32 v[40:41], v168 offset0:144 offset1:145
    v_mfma_f32_16x16x32_bf16 v[8:11], v[108:111], v[136:139], v[8:11]
    s_add_u32 m0, s12, 40960
    s_add_u32 s14, s20, 458752
    v_mfma_f32_16x16x32_bf16 v[12:15], v[108:111], v[140:143], v[12:15]
    ds_read2_b32 v[42:43], v168 offset0:146 offset1:147
    v_mfma_f32_16x16x32_bf16 v[12:15], v[104:107], v[144:147], v[12:15]
    ds_read_b128 v[76:79], v172 offset:576
    buffer_load_dwordx4 v240, s[8:11], s14 offen lds
    v_mfma_f32_16x16x32_bf16 v[16:19], v[108:111], v[144:147], v[16:19]
    v_mfma_f32_16x16x32_bf16 v[12:15], v[112:115], v[136:139], v[12:15]
    ds_read2_b32 v[44:45], v168 offset0:16 offset1:17
    v_mfma_f32_16x16x32_bf16 v[16:19], v[112:115], v[140:143], v[16:19]
    ds_read2_b32 v[46:47], v168 offset0:18 offset1:19
    v_mfma_f32_16x16x32_bf16 v[20:23], v[112:115], v[144:147], v[20:23]
    buffer_load_dwordx4 v247, s[8:11], s14 offen offset:1024 lds
    v_mfma_f32_16x16x32_bf16 v[16:19], v[104:107], v[148:151], v[16:19]
    s_add_u32 m0, s12, 49152
    ds_read_b128 v[80:83], v172 offset:1088
    v_mfma_f32_16x16x32_bf16 v[20:23], v[108:111], v[148:151], v[20:23]
    s_add_u32 s14, s21, 458752
    ds_read2_b32 v[48:49], v169 offset0:144 offset1:145
    v_mfma_f32_16x16x32_bf16 v[24:27], v[112:115], v[148:151], v[24:27]
    s_waitcnt lgkmcnt(15)
    v_mfma_f32_16x16x32_bf16 v[16:19], v[116:119], v[136:139], v[16:19]
    ds_read2_b32 v[50:51], v169 offset0:146 offset1:147
    buffer_load_dwordx4 v240, s[8:11], s14 offen lds
    v_mfma_f32_16x16x32_bf16 v[20:23], v[116:119], v[140:143], v[20:23]
    ds_read_b128 v[84:87], v172 offset:1600
    v_mfma_f32_16x16x32_bf16 v[24:27], v[116:119], v[144:147], v[24:27]
    v_mfma_f32_16x16x32_bf16 v[28:31], v[116:119], v[148:151], v[28:31]
    ds_read2_b32 v[52:53], v169 offset0:16 offset1:17
    v_mfma_f32_16x16x32_bf16 v[20:23], v[104:107], v[152:155], v[20:23]
    ds_read2_b32 v[54:55], v169 offset0:18 offset1:19
    buffer_load_dwordx4 v247, s[8:11], s14 offen offset:1024 lds
    v_mfma_f32_16x16x32_bf16 v[24:27], v[108:111], v[152:155], v[24:27]
    s_add_u32 m0, s12, 57344
    s_add_u32 s14, s22, 458752
    v_mfma_f32_16x16x32_bf16 v[28:31], v[112:115], v[152:155], v[28:31]
    ds_read_b128 v[88:91], v172 offset:2112
    v_mfma_f32_16x16x32_bf16 v[32:35], v[116:119], v[152:155], v[32:35]
    ds_read2_b32 v[56:57], v170 offset0:144 offset1:145
    v_mfma_f32_16x16x32_bf16 v[20:23], v[120:123], v[136:139], v[20:23]
    buffer_load_dwordx4 v240, s[8:11], s14 offen lds
    v_mfma_f32_16x16x32_bf16 v[24:27], v[120:123], v[140:143], v[24:27]
    ds_read2_b32 v[58:59], v170 offset0:146 offset1:147
    v_mfma_f32_16x16x32_bf16 v[28:31], v[120:123], v[144:147], v[28:31]
    ds_read_b128 v[92:95], v172 offset:2624
    v_mfma_f32_16x16x32_bf16 v[32:35], v[120:123], v[148:151], v[32:35]
    v_mfma_f32_16x16x32_bf16 v[24:27], v[104:107], v[156:159], v[24:27]
    ds_read2_b32 v[60:61], v170 offset0:16 offset1:17
    buffer_load_dwordx4 v247, s[8:11], s14 offen offset:1024 lds
    v_mfma_f32_16x16x32_bf16 v[28:31], v[108:111], v[156:159], v[28:31]
    s_waitcnt vmcnt(10)
    ds_read2_b32 v[62:63], v170 offset0:18 offset1:19
    v_mfma_f32_16x16x32_bf16 v[32:35], v[112:115], v[156:159], v[32:35]
    s_waitcnt lgkmcnt(15)
    s_barrier
    ds_read_b64_tr_b16 a[0:1], v245 offset:0
    v_mfma_f32_16x16x32_bf16 v[24:27], v[124:127], v[136:139], v[24:27]
    ds_read_b128 v[96:99], v172 offset:3136
    ds_read_b64_tr_b16 a[2:3], v245 offset:1024
    v_mfma_f32_16x16x32_bf16 v[28:31], v[124:127], v[140:143], v[28:31]
    ds_read2_b32 v[64:65], v171 offset0:144 offset1:145
    ds_read_b64_tr_b16 a[128:129], v246 offset:0
    v_mfma_f32_16x16x32_bf16 v[32:35], v[124:127], v[144:147], v[32:35]
    ds_read_b64_tr_b16 a[130:131], v246 offset:1024
    ds_read_b64_tr_b16 a[4:5], v245 offset:8192
    v_mfma_f32_16x16x32_bf16 v[28:31], v[104:107], v[160:163], v[28:31]
    ds_read2_b32 v[66:67], v171 offset0:146 offset1:147
    ds_read_b64_tr_b16 a[6:7], v245 offset:9216
    v_mfma_f32_16x16x32_bf16 v[32:35], v[108:111], v[160:163], v[32:35]
    ds_read_b128 v[100:103], v172 offset:3648
    ds_read_b64_tr_b16 a[132:133], v246 offset:8192
    v_mfma_f32_16x16x32_bf16 v[28:31], v[128:131], v[136:139], v[28:31]
    ds_read_b64_tr_b16 a[134:135], v246 offset:9216
    ds_read_b64_tr_b16 a[8:9], v245 offset:16384
    v_mfma_f32_16x16x32_bf16 v[32:35], v[128:131], v[140:143], v[32:35]
    ds_read2_b32 v[68:69], v171 offset0:16 offset1:17
    ds_read_b64_tr_b16 a[10:11], v245 offset:17408
    v_mfma_f32_16x16x32_bf16 v[32:35], v[104:107], v[164:167], v[32:35]
    ds_read2_b32 v[70:71], v171 offset0:18 offset1:19
    ds_read_b64_tr_b16 a[136:137], v246 offset:16384
    v_mfma_f32_16x16x32_bf16 v[32:35], v[132:135], v[136:139], v[32:35]
    ds_read_b64_tr_b16 a[138:139], v246 offset:17408
    ds_read_b64_tr_b16 a[12:13], v243 offset:46336
    v_mfma_f32_16x16x32_bf16 v[4:7], v[40:43], v[72:75], v[4:7]
    s_waitcnt lgkmcnt(15)
    ds_read_b128 v[136:139], v172 offset:0
    ds_read_b64_tr_b16 a[14:15], v243 offset:47360
    v_mfma_f32_16x16x32_bf16 v[8:11], v[40:43], v[76:79], v[8:11]
    ds_read2_b32 v[104:105], v168 offset0:128 offset1:129
    ds_read_b64_tr_b16 a[140:141], v244 offset:46336
    v_mfma_f32_16x16x32_bf16 v[8:11], v[44:47], v[72:75], v[8:11]
    ds_read_b64_tr_b16 a[142:143], v244 offset:47360
    ds_read_b64_tr_b16 a[16:17], v243 offset:54528
    v_mfma_f32_16x16x32_bf16 v[12:15], v[44:47], v[76:79], v[12:15]
    ds_read2_b32 v[106:107], v168 offset0:130 offset1:131
    ds_read_b64_tr_b16 a[18:19], v243 offset:55552
    v_mfma_f32_16x16x32_bf16 v[12:15], v[40:43], v[80:83], v[12:15]
    ds_read_b128 v[140:143], v172 offset:512
    ds_read_b64_tr_b16 a[144:145], v244 offset:54528
    v_mfma_f32_16x16x32_bf16 v[16:19], v[44:47], v[80:83], v[16:19]
    ds_read_b64_tr_b16 a[146:147], v244 offset:55552
    ds_read_b64_tr_b16 a[20:21], v241 offset:0
    v_mfma_f32_16x16x32_bf16 v[12:15], v[48:51], v[72:75], v[12:15]
    ds_read2_b32 v[108:109], v168 offset0:0 offset1:1
    ds_read_b64_tr_b16 a[22:23], v241 offset:1024
    v_mfma_f32_16x16x32_bf16 v[16:19], v[48:51], v[76:79], v[16:19]
    ds_read2_b32 v[110:111], v168 offset0:2 offset1:3
    ds_read_b64_tr_b16 a[148:149], v242 offset:0
    v_mfma_f32_16x16x32_bf16 v[20:23], v[48:51], v[80:83], v[20:23]
    ds_read_b64_tr_b16 a[150:151], v242 offset:1024
    ds_read_b64_tr_b16 a[24:25], v241 offset:8192
    v_mfma_f32_16x16x32_bf16 v[16:19], v[40:43], v[84:87], v[16:19]
    ds_read_b128 v[144:147], v172 offset:1024
    ds_read_b64_tr_b16 a[26:27], v241 offset:9216
    v_mfma_f32_16x16x32_bf16 v[20:23], v[44:47], v[84:87], v[20:23]
    ds_read2_b32 v[112:113], v169 offset0:128 offset1:129
    ds_read_b64_tr_b16 a[152:153], v242 offset:8192
    v_mfma_f32_16x16x32_bf16 v[24:27], v[48:51], v[84:87], v[24:27]
    ds_read_b64_tr_b16 a[154:155], v242 offset:9216
    ds_read_b64_tr_b16 a[28:29], v241 offset:16384
    v_mfma_f32_16x16x32_bf16 v[16:19], v[52:55], v[72:75], v[16:19]
    ds_read2_b32 v[114:115], v169 offset0:130 offset1:131
    ds_read_b64_tr_b16 a[30:31], v241 offset:17408
    v_mfma_f32_16x16x32_bf16 v[20:23], v[52:55], v[76:79], v[20:23]
    ds_read_b128 v[148:151], v172 offset:1536
    ds_read_b64_tr_b16 a[156:157], v242 offset:16384
    v_mfma_f32_16x16x32_bf16 v[24:27], v[52:55], v[80:83], v[24:27]
    ds_read_b64_tr_b16 a[158:159], v242 offset:17408
    v_mfma_f32_16x16x32_bf16 v[28:31], v[52:55], v[84:87], v[28:31]
    ds_read2_b32 v[116:117], v169 offset0:0 offset1:1
    v_mfma_f32_16x16x32_bf16 v[20:23], v[40:43], v[88:91], v[20:23]
    s_waitcnt lgkmcnt(1)
    ds_read2_b32 v[118:119], v169 offset0:2 offset1:3
    v_mfma_f32_16x16x32_bf16 v[24:27], v[44:47], v[88:91], v[24:27]
    s_barrier
    s_add_u32 m0, s12, 131072
    v_mfma_f32_16x16x32_bf16 v[28:31], v[48:51], v[88:91], v[28:31]
    s_add_u32 s14, s23, 458752
    ds_read_b128 v[152:155], v172 offset:2048
    buffer_load_dwordx4 v240, s[8:11], s14 offen lds
    v_mfma_f32_16x16x32_bf16 v[32:35], v[52:55], v[88:91], v[32:35]
    ds_read2_b32 v[120:121], v170 offset0:128 offset1:129
    v_mfma_f32_16x16x32_bf16 v[20:23], v[56:59], v[72:75], v[20:23]
    v_mfma_f32_16x16x32_bf16 v[24:27], v[56:59], v[76:79], v[24:27]
    ds_read2_b32 v[122:123], v170 offset0:130 offset1:131
    v_mfma_f32_16x16x32_bf16 v[28:31], v[56:59], v[80:83], v[28:31]
    ds_read_b128 v[156:159], v172 offset:2560
    buffer_load_dwordx4 v247, s[8:11], s14 offen offset:1024 lds
    v_mfma_f32_16x16x32_bf16 v[32:35], v[56:59], v[84:87], v[32:35]
    s_add_u32 m0, s12, 139264
    v_mfma_f32_16x16x32_bf16 v[24:27], v[40:43], v[92:95], v[24:27]
    s_add_u32 s14, s24, 458752
    ds_read2_b32 v[124:125], v170 offset0:0 offset1:1
    v_mfma_f32_16x16x32_bf16 v[28:31], v[44:47], v[92:95], v[28:31]
    ds_read2_b32 v[126:127], v170 offset0:2 offset1:3
    v_mfma_f32_16x16x32_bf16 v[32:35], v[48:51], v[92:95], v[32:35]
    buffer_load_dwordx4 v240, s[8:11], s14 offen lds
    v_mfma_f32_16x16x32_bf16 v[24:27], v[60:63], v[72:75], v[24:27]
    ds_read_b128 v[160:163], v172 offset:3072
    v_mfma_f32_16x16x32_bf16 v[28:31], v[60:63], v[76:79], v[28:31]
    ds_read2_b32 v[128:129], v171 offset0:128 offset1:129
    v_mfma_f32_16x16x32_bf16 v[32:35], v[60:63], v[80:83], v[32:35]
    v_mfma_f32_16x16x32_bf16 v[28:31], v[40:43], v[96:99], v[28:31]
    ds_read2_b32 v[130:131], v171 offset0:130 offset1:131
    buffer_load_dwordx4 v247, s[8:11], s14 offen offset:1024 lds
    v_mfma_f32_16x16x32_bf16 v[32:35], v[44:47], v[96:99], v[32:35]
    ds_read_b128 v[164:167], v172 offset:3584
    v_mfma_f32_16x16x32_bf16 v[28:31], v[64:67], v[72:75], v[28:31]
    s_add_u32 m0, s12, 147456
    s_add_u32 s14, s25, 458752
    v_mfma_f32_16x16x32_bf16 v[32:35], v[64:67], v[76:79], v[32:35]
    ds_read2_b32 v[132:133], v171 offset0:0 offset1:1
    v_mfma_f32_16x16x32_bf16 v[32:35], v[40:43], v[100:103], v[32:35]
    ds_read2_b32 v[134:135], v171 offset0:2 offset1:3
    buffer_load_dwordx4 v240, s[8:11], s14 offen lds
    v_mfma_f32_16x16x32_bf16 v[32:35], v[68:71], v[72:75], v[32:35]
    v_mfma_f32_16x16x32_bf16 v[4:7], v[104:107], v[136:139], v[4:7]
    buffer_load_dwordx4 v247, s[8:11], s14 offen offset:1024 lds
    v_mfma_f32_16x16x32_bf16 v[8:11], v[104:107], v[140:143], v[8:11]
    s_add_u32 m0, s12, 111872
    v_mfma_f32_16x16x32_bf16 v[8:11], v[108:111], v[136:139], v[8:11]
    s_add_u32 s14, s18, 917504
    v_mfma_f32_16x16x32_bf16 v[12:15], v[108:111], v[140:143], v[12:15]
    v_mfma_f32_16x16x32_bf16 v[12:15], v[104:107], v[144:147], v[12:15]
    buffer_load_dwordx4 v240, s[8:11], s14 offen lds
    v_mfma_f32_16x16x32_bf16 v[16:19], v[108:111], v[144:147], v[16:19]
    v_mfma_f32_16x16x32_bf16 v[12:15], v[112:115], v[136:139], v[12:15]
    v_mfma_f32_16x16x32_bf16 v[16:19], v[112:115], v[140:143], v[16:19]
    v_mfma_f32_16x16x32_bf16 v[20:23], v[112:115], v[144:147], v[20:23]
    buffer_load_dwordx4 v247, s[8:11], s14 offen offset:1024 lds
    v_mfma_f32_16x16x32_bf16 v[16:19], v[104:107], v[148:151], v[16:19]
    s_add_u32 m0, s12, 120064
    s_add_u32 s14, s19, 917504
    v_mfma_f32_16x16x32_bf16 v[20:23], v[108:111], v[148:151], v[20:23]
    v_mfma_f32_16x16x32_bf16 v[24:27], v[112:115], v[148:151], v[24:27]
    s_waitcnt lgkmcnt(12)
    v_mfma_f32_16x16x32_bf16 v[16:19], v[116:119], v[136:139], v[16:19]
    buffer_load_dwordx4 v240, s[8:11], s14 offen lds
    v_mfma_f32_16x16x32_bf16 v[20:23], v[116:119], v[140:143], v[20:23]
    v_mfma_f32_16x16x32_bf16 v[24:27], v[116:119], v[144:147], v[24:27]
    v_mfma_f32_16x16x32_bf16 v[28:31], v[116:119], v[148:151], v[28:31]
    s_waitcnt lgkmcnt(11)
    v_mfma_f32_16x16x32_bf16 v[20:23], v[104:107], v[152:155], v[20:23]
    buffer_load_dwordx4 v247, s[8:11], s14 offen offset:1024 lds
    v_mfma_f32_16x16x32_bf16 v[24:27], v[108:111], v[152:155], v[24:27]
    s_add_u32 m0, s12, 0
    s_add_u32 s14, s20, 917504
    v_mfma_f32_16x16x32_bf16 v[28:31], v[112:115], v[152:155], v[28:31]
    v_mfma_f32_16x16x32_bf16 v[32:35], v[116:119], v[152:155], v[32:35]
    s_waitcnt lgkmcnt(9)
    v_mfma_f32_16x16x32_bf16 v[20:23], v[120:123], v[136:139], v[20:23]
    buffer_load_dwordx4 v240, s[8:11], s14 offen lds
    v_mfma_f32_16x16x32_bf16 v[24:27], v[120:123], v[140:143], v[24:27]
    v_mfma_f32_16x16x32_bf16 v[28:31], v[120:123], v[144:147], v[28:31]
    v_mfma_f32_16x16x32_bf16 v[32:35], v[120:123], v[148:151], v[32:35]
    s_waitcnt lgkmcnt(8)
    v_mfma_f32_16x16x32_bf16 v[24:27], v[104:107], v[156:159], v[24:27]
    buffer_load_dwordx4 v247, s[8:11], s14 offen offset:1024 lds
    v_mfma_f32_16x16x32_bf16 v[28:31], v[108:111], v[156:159], v[28:31]
    s_add_u32 m0, s12, 8192
    s_add_u32 s14, s21, 917504
    v_mfma_f32_16x16x32_bf16 v[32:35], v[112:115], v[156:159], v[32:35]
    s_waitcnt lgkmcnt(6)
    v_mfma_f32_16x16x32_bf16 v[24:27], v[124:127], v[136:139], v[24:27]
    v_mfma_f32_16x16x32_bf16 v[28:31], v[124:127], v[140:143], v[28:31]
    buffer_load_dwordx4 v240, s[8:11], s14 offen lds
    v_mfma_f32_16x16x32_bf16 v[32:35], v[124:127], v[144:147], v[32:35]
    s_waitcnt lgkmcnt(5)
    v_mfma_f32_16x16x32_bf16 v[28:31], v[104:107], v[160:163], v[28:31]
    v_mfma_f32_16x16x32_bf16 v[32:35], v[108:111], v[160:163], v[32:35]
    s_waitcnt lgkmcnt(3)
    v_mfma_f32_16x16x32_bf16 v[28:31], v[128:131], v[136:139], v[28:31]
    buffer_load_dwordx4 v247, s[8:11], s14 offen offset:1024 lds
    v_mfma_f32_16x16x32_bf16 v[32:35], v[128:131], v[140:143], v[32:35]
    s_waitcnt lgkmcnt(2)
    s_add_u32 m0, s12, 16384
    v_mfma_f32_16x16x32_bf16 v[32:35], v[104:107], v[164:167], v[32:35]
    s_waitcnt lgkmcnt(0)
    s_add_u32 s14, s22, 917504
    v_mfma_f32_16x16x32_bf16 v[32:35], v[132:135], v[136:139], v[32:35]
    buffer_load_dwordx4 v240, s[8:11], s14 offen lds
    buffer_load_dwordx4 v247, s[8:11], s14 offen offset:1024 lds
    s_waitcnt vmcnt(16)
    s_cmp_lg_u32 s17, 0
    s_cbranch_scc1 LF_ep1_14
    s_nop 7
    ds_write_b128 v180, v[20:23] offset:0
    ds_write_b128 v180, v[24:27] offset:1024
    ds_write_b128 v180, v[28:31] offset:2048
    ds_write_b128 v180, v[32:35] offset:3072
    s_waitcnt lgkmcnt(0)
    s_barrier
    ds_read_b128 v[40:43], v181 offset:0
    ds_read_b128 v[44:47], v181 offset:1024
    ds_read_b128 v[48:51], v181 offset:2048
    ds_read_b128 v[52:55], v181 offset:3072
    s_waitcnt lgkmcnt(3)
    v_pk_add_f32 v[40:41], v[40:41], v[4:5]
    v_pk_add_f32 v[42:43], v[42:43], v[6:7]
    s_waitcnt lgkmcnt(2)
    v_pk_add_f32 v[44:45], v[44:45], v[8:9]
    v_pk_add_f32 v[46:47], v[46:47], v[10:11]
    s_waitcnt lgkmcnt(1)
    v_pk_add_f32 v[48:49], v[48:49], v[12:13]
    v_pk_add_f32 v[50:51], v[50:51], v[14:15]
    s_waitcnt lgkmcnt(0)
    v_pk_add_f32 v[52:53], v[52:53], v[16:17]
    v_pk_add_f32 v[54:55], v[54:55], v[18:19]
    s_branch LF_ej_15
LF_ep1_14:
    s_nop 7
    ds_write_b128 v180, v[4:7] offset:0
    ds_write_b128 v180, v[8:11] offset:1024
    ds_write_b128 v180, v[12:15] offset:2048
    ds_write_b128 v180, v[16:19] offset:3072
    s_waitcnt lgkmcnt(0)
    s_barrier
    ds_read_b128 v[40:43], v181 offset:0
    ds_read_b128 v[44:47], v181 offset:1024
    ds_read_b128 v[48:51], v181 offset:2048
    ds_read_b128 v[52:55], v181 offset:3072
    s_waitcnt lgkmcnt(3)
    v_pk_add_f32 v[40:41], v[40:41], v[20:21]
    v_pk_add_f32 v[42:43], v[42:43], v[22:23]
    s_waitcnt lgkmcnt(2)
    v_pk_add_f32 v[44:45], v[44:45], v[24:25]
    v_pk_add_f32 v[46:47], v[46:47], v[26:27]
    s_waitcnt lgkmcnt(1)
    v_pk_add_f32 v[48:49], v[48:49], v[28:29]
    v_pk_add_f32 v[50:51], v[50:51], v[30:31]
    s_waitcnt lgkmcnt(0)
    v_pk_add_f32 v[52:53], v[52:53], v[32:33]
    v_pk_add_f32 v[54:55], v[54:55], v[34:35]
LF_ej_15:
    s_cmp_eq_u32 s16, 0
    s_cselect_b32 s74, s90, s91
    v_mov_b32 v38, s74
    v_mov_b32 v39, s74
    v_pk_mul_f32 v[76:77], v[40:41], v[38:39]
    v_pk_mul_f32 v[78:79], v[42:43], v[38:39]
    v_pk_mul_f32 v[80:81], v[44:45], v[38:39]
    v_pk_mul_f32 v[82:83], v[46:47], v[38:39]
    v_cvt_pk_bf16_f32 v60, v76, v77
    v_cvt_pk_bf16_f32 v61, v78, v79
    v_cvt_pk_bf16_f32 v62, v80, v81
    v_cvt_pk_bf16_f32 v63, v82, v83
    v_and_or_b32 v60, v60, v252, s3
    v_and_or_b32 v61, v61, v252, s31
    v_and_or_b32 v62, v62, v252, s3
    v_and_or_b32 v63, v63, v252, s31
    s_nop 0
    v_permlane16_swap_b32 v60, v62
    v_permlane16_swap_b32 v61, v63
    buffer_store_dwordx4 v[60:63], v182, s[4:7], s28 offen sc1
    v_pk_mul_f32 v[76:77], v[48:49], v[38:39]
    v_pk_mul_f32 v[78:79], v[50:51], v[38:39]
    v_pk_mul_f32 v[80:81], v[52:53], v[38:39]
    v_pk_mul_f32 v[82:83], v[54:55], v[38:39]
    v_cvt_pk_bf16_f32 v68, v76, v77
    v_cvt_pk_bf16_f32 v69, v78, v79
    v_cvt_pk_bf16_f32 v70, v80, v81
    v_cvt_pk_bf16_f32 v71, v82, v83
    v_and_or_b32 v68, v68, v252, s3
    v_and_or_b32 v69, v69, v252, s31
    v_and_or_b32 v70, v70, v252, s3
    v_and_or_b32 v71, v71, v252, s31
    s_nop 0
    v_permlane16_swap_b32 v68, v70
    v_permlane16_swap_b32 v69, v71
    buffer_store_dwordx4 v[68:71], v182, s[4:7], s30 offen sc1
    v_cvt_pk_bf16_f32 v64, v40, v41
    v_cvt_pk_bf16_f32 v65, v42, v43
    v_cvt_pk_bf16_f32 v66, v44, v45
    v_cvt_pk_bf16_f32 v67, v46, v47
    v_and_or_b32 v64, v64, v252, s3
    v_and_or_b32 v65, v65, v252, s31
    v_and_or_b32 v66, v66, v252, s3
    v_and_or_b32 v67, v67, v252, s31
    s_nop 0
    v_permlane16_swap_b32 v64, v66
    v_permlane16_swap_b32 v65, v67
    buffer_store_dwordx4 v[64:67], v182, s[4:7], s27 offen sc1
    v_cvt_pk_bf16_f32 v72, v48, v49
    v_cvt_pk_bf16_f32 v73, v50, v51
    v_cvt_pk_bf16_f32 v74, v52, v53
    v_cvt_pk_bf16_f32 v75, v54, v55
    v_and_or_b32 v72, v72, v252, s3
    v_and_or_b32 v73, v73, v252, s31
    v_and_or_b32 v74, v74, v252, s3
    v_and_or_b32 v75, v75, v252, s31
    s_nop 0
    v_permlane16_swap_b32 v72, v74
    v_permlane16_swap_b32 v73, v75
    buffer_store_dwordx4 v[72:75], v182, s[4:7], s29 offen sc1
    s_cmp_ge_u32 s79, 28
    s_cbranch_scc1 F_alt
    v_mov_b32 v20, s92
    v_mov_b32 v21, s93
    s_lshr_b32 s101, s32, 3
    s_cmp_lg_u32 s70, 0
    s_cselect_b32 s101, 0x7f000000, s101
    s_add_u32 s101, s101, 131072
    buffer_store_dwordx2 v[20:21], v199, s[4:7], s101 offen sc1
    ds_read_b64_tr_b16 a[32:33], v241 offset:24576
    ds_read_b64_tr_b16 a[34:35], v241 offset:25600
    ds_read_b64_tr_b16 a[160:161], v242 offset:24576
    ds_read_b64_tr_b16 a[162:163], v242 offset:25600
    ds_read_b64_tr_b16 a[36:37], v241 offset:32768
    ds_read_b64_tr_b16 a[38:39], v241 offset:33792
    ds_read_b64_tr_b16 a[164:165], v242 offset:32768
    ds_read_b64_tr_b16 a[166:167], v242 offset:33792
    ds_read_b64_tr_b16 a[40:41], v241 offset:40960
    ds_read_b64_tr_b16 a[42:43], v241 offset:41984
    ds_read_b64_tr_b16 a[168:169], v242 offset:40960
    ds_read_b64_tr_b16 a[170:171], v242 offset:41984
    ds_read_b64_tr_b16 a[44:45], v241 offset:49152
    ds_read_b64_tr_b16 a[46:47], v241 offset:50176
    ds_read_b64_tr_b16 a[172:173], v242 offset:49152
    ds_read_b64_tr_b16 a[174:175], v242 offset:50176
    ds_read_b64_tr_b16 a[48:49], v241 offset:57344
    ds_read_b64_tr_b16 a[50:51], v241 offset:58368
    ds_read_b64_tr_b16 a[176:177], v242 offset:57344
    ds_read_b64_tr_b16 a[178:179], v242 offset:58368
    s_lshl_b32 s75, s70, 13
    s_lshl_b32 s33, s98, 10
    s_add_u32 s33, s33, 147456
    v_lshlrev_b32 v147, 4, v1
    v_add_u32 v146, s75, v147
    v_add_u32 v143, 0x10000, v146
    s_lshl_b32 s74, s98, 17
    s_add_u32 s74, s74, s75
    s_add_u32 s74, s74, 0x00300000
    s_waitcnt vmcnt(5)
    s_waitcnt lgkmcnt(0)
    s_barrier
    ds_read_b64_tr_b16 a[52:53], v245 offset:0
    ds_read_b64_tr_b16 a[54:55], v245 offset:1024
    ds_read_b64_tr_b16 a[180:181], v246 offset:0
    ds_read_b64_tr_b16 a[182:183], v246 offset:1024
    ds_read_b64_tr_b16 a[56:57], v245 offset:8192
    ds_read_b64_tr_b16 a[58:59], v245 offset:9216
    ds_read_b64_tr_b16 a[184:185], v246 offset:8192
    ds_read_b64_tr_b16 a[186:187], v246 offset:9216
    ds_read_b64_tr_b16 a[60:61], v245 offset:16384
    ds_read_b64_tr_b16 a[62:63], v245 offset:17408
    ds_read_b64_tr_b16 a[188:189], v246 offset:16384
    ds_read_b64_tr_b16 a[190:191], v246 offset:17408
    ds_read_b64_tr_b16 a[64:65], v243 offset:46336
    ds_read_b64_tr_b16 a[66:67], v243 offset:47360
    ds_read_b64_tr_b16 a[192:193], v244 offset:46336
    ds_read_b64_tr_b16 a[194:195], v244 offset:47360
    ds_read_b64_tr_b16 a[68:69], v243 offset:54528
    ds_read_b64_tr_b16 a[70:71], v243 offset:55552
    ds_read_b64_tr_b16 a[196:197], v244 offset:54528
    ds_read_b64_tr_b16 a[198:199], v244 offset:55552
    ds_read_b64_tr_b16 a[72:73], v241 offset:0
    ds_read_b64_tr_b16 a[74:75], v241 offset:1024
    ds_read_b64_tr_b16 a[200:201], v242 offset:0
    ds_read_b64_tr_b16 a[202:203], v242 offset:1024
    ds_read_b64_tr_b16 a[76:77], v241 offset:8192
    ds_read_b64_tr_b16 a[78:79], v241 offset:9216
    ds_read_b64_tr_b16 a[204:205], v242 offset:8192
    ds_read_b64_tr_b16 a[206:207], v242 offset:9216
    ds_read_b64_tr_b16 a[80:81], v241 offset:16384
    ds_read_b64_tr_b16 a[82:83], v241 offset:17408
    ds_read_b64_tr_b16 a[208:209], v242 offset:16384
    ds_read_b64_tr_b16 a[210:211], v242 offset:17408
    s_add_u32 m0, s12, 24576
    s_add_u32 s14, s23, 917504
    buffer_load_dwordx4 v240, s[8:11], s14 offen lds
    buffer_load_dwordx4 v247, s[8:11], s14 offen offset:1024 lds
    s_add_u32 m0, s12, 32768
    s_add_u32 s14, s24, 917504
    buffer_load_dwordx4 v240, s[8:11], s14 offen lds
    buffer_load_dwordx4 v247, s[8:11], s14 offen offset:1024 lds
    s_add_u32 m0, s12, 40960
    s_add_u32 s14, s25, 917504
    buffer_load_dwordx4 v240, s[8:11], s14 offen lds
    buffer_load_dwordx4 v247, s[8:11], s14 offen offset:1024 lds
    s_add_u32 m0, s12, 49152
    s_add_u32 s14, s18, 1376256
    buffer_load_dwordx4 v240, s[8:11], s14 offen lds
    buffer_load_dwordx4 v247, s[8:11], s14 offen offset:1024 lds
    s_add_u32 m0, s12, 57344
    s_add_u32 s14, s19, 1376256
    buffer_load_dwordx4 v240, s[8:11], s14 offen lds
    buffer_load_dwordx4 v247, s[8:11], s14 offen offset:1024 lds
    v_lshrrev_b32 v144, 5, v1
    v_lshlrev_b32 v144, 9, v144
    v_bfe_u32 v145, v1, 2, 2
    v_lshl_add_u32 v144, v145, 6, v144
    v_bfe_u32 v145, v1, 4, 1
    v_lshl_add_u32 v144, v145, 5, v144
    v_and_b32 v145, 3, v1
    v_lshl_add_u32 v144, v145, 3, v144
    v_add_u32 v144, 0x10000, v144
    s_add_u32 s101, s26, 0
    s_and_b32 s101, s101, 7
    v_lshl_add_u32 v124, s101, 10, v144
    s_add_u32 s101, s26, 1
    s_and_b32 s101, s101, 7
    v_lshl_add_u32 v125, s101, 10, v144
    s_add_u32 s101, s26, 2
    s_and_b32 s101, s101, 7
    v_lshl_add_u32 v126, s101, 10, v144
    s_add_u32 s101, s26, 3
    s_and_b32 s101, s101, 7
    v_lshl_add_u32 v127, s101, 10, v144
    s_add_u32 s101, s26, 4
    s_and_b32 s101, s101, 7
    v_lshl_add_u32 v141, s101, 10, v144
    s_add_u32 s101, s26, 5
    s_and_b32 s101, s101, 7
    v_lshl_add_u32 v142, s101, 10, v144
    s_add_u32 s101, s26, 6
    s_and_b32 s101, s101, 7
    v_lshl_add_u32 v2, s101, 10, v144
    s_add_u32 s101, s26, 7
    s_and_b32 s101, s101, 7
    v_lshl_add_u32 v3, s101, 10, v144
    v_and_b32 v145, 31, v1
    v_lshlrev_b32 v145, 3, v145
    v_mov_b32 v186, 0
    v_mov_b32 v187, 0
    v_mov_b32 v190, 0
    v_mov_b32 v191, 0
    v_mov_b32 v194, 0
    v_mov_b32 v195, 0
    v_mov_b32 v198, 0
    v_mov_b32 v199, 0
    v_mov_b32 v178, 0
    v_mov_b32 v179, 0
    v_mov_b32 v182, 0
    v_mov_b32 v183, 0
    v_bfe_u32 v138, v1, 4, 1
    v_mul_u32_u24 v138, 28672, v138
    v_bfe_u32 v139, v1, 2, 1
    v_lshl_add_u32 v138, v139, 7, v138
    v_bfe_u32 v139, v1, 3, 1
    v_lshl_add_u32 v138, v139, 6, v138
    v_and_b32 v139, 3, v1
    v_lshl_add_u32 v138, v139, 4, v138
    s_lshl_b32 s35, s99, 4
    s_add_u32 s35, s35, 524288
    s_add_u32 s34, s35, 57344
    s_mul_i32 s72, s70, 458752
    s_and_b32 s101, s79, 7
    s_lshl_b32 s101, s101, 7
    s_add_u32 s72, s72, s101
    s_lshr_b32 s36, s79, 3
    s_lshl_b32 s36, s36, 1
    s_add_u32 s36, s36, s79
    s_and_b32 s36, s36, 7
    s_cmp_eq_u32 s36, 7
    s_cselect_b32 s36, 0, s36
    s_lshl_b32 s36, s36, 10
    s_add_u32 s37, s36, 1024
    s_cmp_eq_u32 s37, 7168
    s_cselect_b32 s37, 0, s37
    s_add_u32 s38, s37, 1024
    s_cmp_eq_u32 s38, 7168
    s_cselect_b32 s38, 0, s38
    s_add_u32 s39, s38, 1024
    s_cmp_eq_u32 s39, 7168
    s_cselect_b32 s39, 0, s39
    s_add_u32 s40, s39, 1024
    s_cmp_eq_u32 s40, 7168
    s_cselect_b32 s40, 0, s40
    s_add_u32 s41, s40, 1024
    s_cmp_eq_u32 s41, 7168
    s_cselect_b32 s41, 0, s41
    s_add_u32 s42, s41, 1024
    s_cmp_eq_u32 s42, 7168
    s_cselect_b32 s42, 0, s42
    s_add_u32 s28, s72, 114688
    s_add_u32 s29, s72, 229376
    s_add_u32 s30, s72, 344064
    s_mul_i32 s90, s70, 6144
    s_add_u32 s90, s90, 131072
    s_lshl_b32 s91, s70, 13
    s_waitcnt lgkmcnt(0)
    s_barrier
    s_add_u32 m0, s12, 131072
    s_add_u32 s14, s20, 1376256
    buffer_load_dwordx4 v240, s[8:11], s14 offen lds
    buffer_load_dwordx4 v247, s[8:11], s14 offen offset:1024 lds
    s_add_u32 m0, s12, 139264
    s_add_u32 s14, s21, 1376256
    buffer_load_dwordx4 v240, s[8:11], s14 offen lds
    buffer_load_dwordx4 v247, s[8:11], s14 offen offset:1024 lds
    s_add_u32 m0, s12, 147456
    s_add_u32 s14, s22, 1376256
    buffer_load_dwordx4 v240, s[8:11], s14 offen lds
    buffer_load_dwordx4 v247, s[8:11], s14 offen offset:1024 lds
    s_add_u32 m0, s12, 0
    s_add_u32 s14, s23, 1376256
    buffer_load_dwordx4 v240, s[8:11], s14 offen lds
    buffer_load_dwordx4 v247, s[8:11], s14 offen offset:1024 lds
    s_add_u32 m0, s12, 8192
    s_add_u32 s14, s24, 1376256
    buffer_load_dwordx4 v240, s[8:11], s14 offen lds
    buffer_load_dwordx4 v247, s[8:11], s14 offen offset:1024 lds
    s_add_u32 m0, s12, 16384
    s_add_u32 s14, s25, 1376256
    buffer_load_dwordx4 v240, s[8:11], s14 offen lds
    buffer_load_dwordx4 v247, s[8:11], s14 offen offset:1024 lds
    s_add_u32 m0, s75, 98304
    s_add_u32 s13, s74, 0
    buffer_load_dwordx4 v147, s[4:7], s13 offen offset:0 sc1 lds
    buffer_load_dwordx4 v147, s[4:7], s13 offen offset:1024 sc1 lds
    buffer_load_dwordx4 v147, s[4:7], s13 offen offset:2048 sc1 lds
    buffer_load_dwordx4 v147, s[4:7], s13 offen offset:3072 sc1 lds
    s_add_u32 m0, s75, 102400
    s_add_u32 s13, s74, 4096
    buffer_load_dwordx4 v147, s[4:7], s13 offen offset:0 sc1 lds
    buffer_load_dwordx4 v147, s[4:7], s13 offen offset:1024 sc1 lds
    buffer_load_dwordx4 v147, s[4:7], s13 offen offset:2048 sc1 lds
    buffer_load_dwordx4 v147, s[4:7], s13 offen offset:3072 sc1 lds
    s_add_u32 m0, s75, 65536
    s_add_u32 s13, s74, 32768
    buffer_load_dwordx4 v147, s[4:7], s13 offen offset:0 sc1 lds
    buffer_load_dwordx4 v147, s[4:7], s13 offen offset:1024 sc1 lds
    buffer_load_dwordx4 v147, s[4:7], s13 offen offset:2048 sc1 lds
    buffer_load_dwordx4 v147, s[4:7], s13 offen offset:3072 sc1 lds
    s_add_u32 m0, s75, 69632
    s_add_u32 s13, s74, 36864
    buffer_load_dwordx4 v147, s[4:7], s13 offen offset:0 sc1 lds
    buffer_load_dwordx4 v147, s[4:7], s13 offen offset:1024 sc1 lds
    buffer_load_dwordx4 v147, s[4:7], s13 offen offset:2048 sc1 lds
    buffer_load_dwordx4 v147, s[4:7], s13 offen offset:3072 sc1 lds
    s_lshl_b32 s98, s80, 1
    s_bfe_u32 s44, s79, 0x10004
    s_add_u32 s98, s98, s44
    s_lshl_b32 s98, s98, 2
    s_bfe_u32 s44, s79, 0x10003
    s_sub_u32 s99, s98, s44
    s_add_u32 s99, s99, 3
    s_add_u32 s98, s98, s44
    s_and_b32 s100, s79, 7
    s_mul_i32 s86, s98, 114688
    s_mul_i32 s87, s99, 114688
    s_mul_i32 s88, s70, 28672
    s_add_u32 s88, s88, 0x00500000
    s_add_u32 s86, s86, s88
    s_add_u32 s87, s87, s88
    s_add_u32 s18, s86, 0
    s_add_u32 s22, s87, 0
    s_add_u32 s19, s86, 7168
    s_add_u32 s23, s87, 7168
    s_add_u32 s20, s86, 14336
    s_add_u32 s24, s87, 14336
    s_add_u32 s21, s86, 21504
    s_add_u32 s25, s87, 21504
    s_lshr_b32 s45, s70, 1
    s_sub_u32 s44, s99, s98
    s_mul_i32 s45, s45, s44
    s_add_u32 s45, s45, s98
    s_and_b32 s46, s70, 1
    s_lshl_b32 s46, s46, 5
    s_lshl_b32 s44, s100, 6
    s_add_u32 s46, s46, s44
    s_lshl_b32 s82, s45, 15
    s_lshl_b32 s83, s46, 6
    s_add_u32 s82, s82, s83
    s_add_u32 s82, s82, 0x00100000
    s_lshl_b32 s83, s70, 11
    s_add_u32 s83, s83, 155648
    s_waitcnt vmcnt(8)
    ds_read_b128 v[148:151], v143 offset:32768
    ds_read_b128 v[152:155], v143 offset:33792
    ds_read_b128 v[156:159], v143 offset:34816
    ds_read_b128 v[160:163], v143 offset:35840
    s_waitcnt lgkmcnt(2)
    v_bitop3_b32 v148, v148, v150, s3 bitop3:0x7e
    v_bitop3_b32 v149, v149, v151, s31 bitop3:0x7e
    v_or3_b32 v164, v148, v149, 0
    v_bitop3_b32 v152, v152, v154, s3 bitop3:0x7e
    v_bitop3_b32 v153, v153, v155, s31 bitop3:0x7e
    v_or3_b32 v164, v152, v153, v164
    s_waitcnt lgkmcnt(0)
    v_bitop3_b32 v156, v156, v158, s3 bitop3:0x7e
    v_bitop3_b32 v157, v157, v159, s31 bitop3:0x7e
    v_or3_b32 v164, v156, v157, v164
    v_bitop3_b32 v160, v160, v162, s3 bitop3:0x7e
    v_bitop3_b32 v161, v161, v163, s31 bitop3:0x7e
    v_or3_b32 v164, v160, v161, v164
    ds_read_b128 v[148:151], v143 offset:36864
    ds_read_b128 v[152:155], v143 offset:37888
    ds_read_b128 v[156:159], v143 offset:38912
    ds_read_b128 v[160:163], v143 offset:39936
    s_waitcnt lgkmcnt(2)
    v_bitop3_b32 v148, v148, v150, s3 bitop3:0x7e
    v_bitop3_b32 v149, v149, v151, s31 bitop3:0x7e
    v_or3_b32 v164, v148, v149, v164
    v_bitop3_b32 v152, v152, v154, s3 bitop3:0x7e
    v_bitop3_b32 v153, v153, v155, s31 bitop3:0x7e
    v_or3_b32 v164, v152, v153, v164
    s_waitcnt lgkmcnt(0)
    v_bitop3_b32 v156, v156, v158, s3 bitop3:0x7e
    v_bitop3_b32 v157, v157, v159, s31 bitop3:0x7e
    v_or3_b32 v164, v156, v157, v164
    v_bitop3_b32 v160, v160, v162, s3 bitop3:0x7e
    v_bitop3_b32 v161, v161, v163, s31 bitop3:0x7e
    v_or3_b32 v164, v160, v161, v164
    v_and_b32 v164, 0x00010001, v164
    v_cmp_ne_u32 vcc, 0, v164
    s_nop 0
    s_cbranch_vccnz LF_xr_16
LF_xb_18:
    s_waitcnt lgkmcnt(0)
    s_barrier
    s_mov_b32 s76, s81
    s_mov_b32 s77, 0xc09d30fc
    ds_read_b64_tr_b16 v[100:101], v124 offset:32768
    ds_read_b64_tr_b16 v[102:103], v124 offset:33024
    ds_read_b64_tr_b16 v[104:105], v125 offset:32768
    ds_read_b64_tr_b16 v[106:107], v125 offset:33024
    ds_read_b64_tr_b16 v[108:109], v126 offset:32768
    ds_read_b64_tr_b16 v[110:111], v126 offset:33024
    ds_read_b64_tr_b16 v[112:113], v127 offset:32768
    ds_read_b64_tr_b16 v[114:115], v127 offset:33024
    ds_read_b64_tr_b16 v[116:117], v141 offset:32768
    ds_read_b64_tr_b16 v[118:119], v141 offset:33024
    s_waitcnt lgkmcnt(8)
    v_mfma_f32_32x32x16_bf16 v[4:19], a[0:3], v[100:103], 0
    ds_read_b64_tr_b16 v[120:121], v142 offset:32768
    ds_read_b64_tr_b16 v[122:123], v142 offset:33024
    v_mfma_f32_32x32x16_bf16 v[20:35], a[128:131], v[100:103], 0
    s_waitcnt lgkmcnt(8)
    v_mfma_f32_32x32x16_bf16 v[4:19], a[4:7], v[104:107], v[4:19]
    ds_read_b64_tr_b16 v[100:101], v2 offset:32768
    ds_read_b64_tr_b16 v[102:103], v2 offset:33024
    v_mfma_f32_32x32x16_bf16 v[20:35], a[132:135], v[104:107], v[20:35]
    s_waitcnt lgkmcnt(8)
    v_mfma_f32_32x32x16_bf16 v[4:19], a[8:11], v[108:111], v[4:19]
    ds_read_b64_tr_b16 v[104:105], v3 offset:32768
    ds_read_b64_tr_b16 v[106:107], v3 offset:33024
    v_mfma_f32_32x32x16_bf16 v[20:35], a[136:139], v[108:111], v[20:35]
    s_waitcnt lgkmcnt(8)
    v_mfma_f32_32x32x16_bf16 v[4:19], a[12:15], v[112:115], v[4:19]
    ds_read_b64_tr_b16 v[108:109], v124 offset:40960
    ds_read_b64_tr_b16 v[110:111], v124 offset:41216
    v_mfma_f32_32x32x16_bf16 v[20:35], a[140:143], v[112:115], v[20:35]
    s_waitcnt lgkmcnt(8)
    v_mfma_f32_32x32x16_bf16 v[4:19], a[16:19], v[116:119], v[4:19]
    ds_read_b64_tr_b16 v[112:113], v125 offset:40960
    ds_read_b64_tr_b16 v[114:115], v125 offset:41216
    v_mfma_f32_32x32x16_bf16 v[20:35], a[144:147], v[116:119], v[20:35]
    s_waitcnt lgkmcnt(8)
    v_mfma_f32_32x32x16_bf16 v[4:19], a[20:23], v[120:123], v[4:19]
    ds_read_b64_tr_b16 v[116:117], v126 offset:40960
    ds_read_b64_tr_b16 v[118:119], v126 offset:41216
    v_mfma_f32_32x32x16_bf16 v[20:35], a[148:151], v[120:123], v[20:35]
    s_waitcnt lgkmcnt(8)
    v_mfma_f32_32x32x16_bf16 v[4:19], a[24:27], v[100:103], v[4:19]
    s_waitcnt vmcnt(0)
    ds_read_b64_tr_b16 v[120:121], v127 offset:40960
    ds_read_b64_tr_b16 v[122:123], v127 offset:41216
    ds_read_b128 v[148:151], v143 offset:0
    ds_read_b128 v[152:155], v143 offset:1024
    ds_read_b128 v[156:159], v143 offset:2048
    ds_read_b128 v[160:163], v143 offset:3072
    v_mfma_f32_32x32x16_bf16 v[20:35], a[152:155], v[100:103], v[20:35]
    s_waitcnt lgkmcnt(12)
    s_waitcnt lgkmcnt(2)
    v_bitop3_b32 v148, v148, v150, s3 bitop3:0x7e
    v_bitop3_b32 v149, v149, v151, s31 bitop3:0x7e
    v_or3_b32 v164, v148, v149, 0
    v_bitop3_b32 v152, v152, v154, s3 bitop3:0x7e
    v_bitop3_b32 v153, v153, v155, s31 bitop3:0x7e
    v_mfma_f32_32x32x16_bf16 v[4:19], a[28:31], v[104:107], v[4:19]
    ds_read_b64_tr_b16 v[100:101], v141 offset:40960
    ds_read_b64_tr_b16 v[102:103], v141 offset:41216
    v_or3_b32 v164, v152, v153, v164
    s_waitcnt lgkmcnt(2)
    v_bitop3_b32 v156, v156, v158, s3 bitop3:0x7e
    v_bitop3_b32 v157, v157, v159, s31 bitop3:0x7e
    v_mfma_f32_32x32x16_bf16 v[20:35], a[156:159], v[104:107], v[20:35]
    v_or3_b32 v164, v156, v157, v164
    v_bitop3_b32 v160, v160, v162, s3 bitop3:0x7e
    v_bitop3_b32 v161, v161, v163, s31 bitop3:0x7e
    v_or3_b32 v164, v160, v161, v164
    v_mfma_f32_32x32x16_bf16 v[4:19], a[32:35], v[108:111], v[4:19]
    ds_read_b64_tr_b16 v[104:105], v142 offset:40960
    ds_read_b64_tr_b16 v[106:107], v142 offset:41216
    ds_read_b128 v[148:151], v143 offset:4096
    ds_read_b128 v[152:155], v143 offset:5120
    ds_read_b128 v[156:159], v143 offset:6144
    ds_read_b128 v[160:163], v143 offset:7168
    v_mfma_f32_32x32x16_bf16 v[20:35], a[160:163], v[108:111], v[20:35]
    s_waitcnt lgkmcnt(2)
    v_bitop3_b32 v148, v148, v150, s3 bitop3:0x7e
    v_bitop3_b32 v149, v149, v151, s31 bitop3:0x7e
    v_or3_b32 v164, v148, v149, v164
    v_bitop3_b32 v152, v152, v154, s3 bitop3:0x7e
    v_bitop3_b32 v153, v153, v155, s31 bitop3:0x7e
    v_mfma_f32_32x32x16_bf16 v[4:19], a[36:39], v[112:115], v[4:19]
    ds_read_b64_tr_b16 v[108:109], v2 offset:40960
    ds_read_b64_tr_b16 v[110:111], v2 offset:41216
    v_or3_b32 v164, v152, v153, v164
    s_waitcnt lgkmcnt(2)
    v_bitop3_b32 v156, v156, v158, s3 bitop3:0x7e
    v_bitop3_b32 v157, v157, v159, s31 bitop3:0x7e
    v_mfma_f32_32x32x16_bf16 v[20:35], a[164:167], v[112:115], v[20:35]
    v_or3_b32 v164, v156, v157, v164
    v_bitop3_b32 v160, v160, v162, s3 bitop3:0x7e
    v_bitop3_b32 v161, v161, v163, s31 bitop3:0x7e
    v_or3_b32 v164, v160, v161, v164
    v_and_b32 v164, 0x00010001, v164
    v_cmp_ne_u32 vcc, 0, v164
    v_mfma_f32_32x32x16_bf16 v[4:19], a[40:43], v[116:119], v[4:19]
    s_cbranch_vccnz LF_xr_19
LF_xb_21:
    ds_read_b64_tr_b16 v[112:113], v3 offset:40960
    ds_read_b64_tr_b16 v[114:115], v3 offset:41216
    v_mfma_f32_32x32x16_bf16 v[20:35], a[168:171], v[116:119], v[20:35]
    s_barrier
    v_mfma_f32_32x32x16_bf16 v[4:19], a[44:47], v[120:123], v[4:19]
    ds_read_b64_tr_b16 v[116:117], v124 offset:0
    ds_read_b64_tr_b16 v[118:119], v124 offset:256
    ds_read_b64_tr_b16 a[84:85], v241 offset:24576
    ds_read_b64_tr_b16 a[86:87], v241 offset:25600
    ds_read_b64_tr_b16 a[212:213], v242 offset:24576
    ds_read_b64_tr_b16 a[214:215], v242 offset:25600
    v_mfma_f32_32x32x16_bf16 v[20:35], a[172:175], v[120:123], v[20:35]
    ds_read_b64_tr_b16 a[88:89], v241 offset:32768
    ds_read_b64_tr_b16 a[90:91], v241 offset:33792
    ds_read_b64_tr_b16 a[216:217], v242 offset:32768
    ds_read_b64_tr_b16 a[218:219], v242 offset:33792
    ds_read_b64_tr_b16 a[92:93], v241 offset:40960
    ds_read_b64_tr_b16 a[94:95], v241 offset:41984
    v_mfma_f32_32x32x16_bf16 v[4:19], a[48:51], v[100:103], v[4:19]
    ds_read_b64_tr_b16 v[120:121], v125 offset:0
    ds_read_b64_tr_b16 v[122:123], v125 offset:256
    ds_read_b64_tr_b16 a[220:221], v242 offset:40960
    ds_read_b64_tr_b16 a[222:223], v242 offset:41984
    ds_read_b64_tr_b16 a[96:97], v241 offset:49152
    ds_read_b64_tr_b16 a[98:99], v241 offset:50176
    v_mfma_f32_32x32x16_bf16 v[20:35], a[176:179], v[100:103], v[20:35]
    ds_read_b64_tr_b16 a[224:225], v242 offset:49152
    ds_read_b64_tr_b16 a[226:227], v242 offset:50176
    ds_read_b64_tr_b16 a[100:101], v241 offset:57344
    ds_read_b64_tr_b16 a[102:103], v241 offset:58368
    ds_read_b64_tr_b16 a[228:229], v242 offset:57344
    ds_read_b64_tr_b16 a[230:231], v242 offset:58368
    v_mfma_f32_32x32x16_bf16 v[4:19], a[52:55], v[104:107], v[4:19]
    s_waitcnt lgkmcnt(0)
    ds_read_b64_tr_b16 v[100:101], v126 offset:0
    ds_read_b64_tr_b16 v[102:103], v126 offset:256
    v_mfma_f32_32x32x16_bf16 v[20:35], a[180:183], v[104:107], v[20:35]
    v_mfma_f32_32x32x16_bf16 v[4:19], a[56:59], v[108:111], v[4:19]
    ds_read_b64_tr_b16 v[104:105], v127 offset:0
    ds_read_b64_tr_b16 v[106:107], v127 offset:256
    v_mfma_f32_32x32x16_bf16 v[20:35], a[184:187], v[108:111], v[20:35]
    v_mfma_f32_32x32x16_bf16 v[4:19], a[60:63], v[112:115], v[4:19]
    ds_read_b64_tr_b16 v[108:109], v141 offset:0
    ds_read_b64_tr_b16 v[110:111], v141 offset:256
    v_mfma_f32_32x32x16_bf16 v[20:35], a[188:191], v[112:115], v[20:35]
    v_mfma_f32_32x32x16_bf16 v[36:51], a[0:3], v[116:119], 0
    ds_read_b64_tr_b16 v[112:113], v142 offset:0
    ds_read_b64_tr_b16 v[114:115], v142 offset:256
    v_mfma_f32_32x32x16_bf16 v[52:67], a[128:131], v[116:119], 0
    s_barrier
    v_mfma_f32_32x32x16_bf16 v[36:51], a[4:7], v[120:123], v[36:51]
    s_add_u32 m0, s75, 32768
    ds_read_b64_tr_b16 v[116:117], v2 offset:0
    ds_read_b64_tr_b16 v[118:119], v2 offset:256
    s_add_u32 s13, s74, 65536
    buffer_load_dwordx4 v147, s[4:7], s13 offen offset:0 sc1 lds
    ds_read_b64_tr_b16 a[104:105], v245 offset:0
    v_mfma_f32_32x32x16_bf16 v[52:67], a[132:135], v[120:123], v[52:67]
    s_waitcnt lgkmcnt(9)
    ds_read_b64_tr_b16 a[106:107], v245 offset:1024
    ds_read_b64_tr_b16 a[232:233], v246 offset:0
    ds_read_b64_tr_b16 a[234:235], v246 offset:1024
    ds_read_b64_tr_b16 a[108:109], v245 offset:8192
    ds_read_b64_tr_b16 a[110:111], v245 offset:9216
    ds_read_b64_tr_b16 a[236:237], v246 offset:8192
    v_mfma_f32_32x32x16_bf16 v[36:51], a[8:11], v[100:103], v[36:51]
    ds_read_b64_tr_b16 v[120:121], v3 offset:0
    ds_read_b64_tr_b16 v[122:123], v3 offset:256
    buffer_load_dwordx4 v147, s[4:7], s13 offen offset:1024 sc1 lds
    ds_read_b64_tr_b16 a[238:239], v246 offset:9216
    ds_read_b64_tr_b16 a[112:113], v245 offset:16384
    v_mfma_f32_32x32x16_bf16 v[52:67], a[136:139], v[100:103], v[52:67]
    s_waitcnt lgkmcnt(15)
    ds_read_b64_tr_b16 a[114:115], v245 offset:17408
    ds_read_b64_tr_b16 a[240:241], v246 offset:16384
    ds_read_b64_tr_b16 a[242:243], v246 offset:17408
    ds_read_b64_tr_b16 a[116:117], v241 offset:0
    ds_read_b64_tr_b16 a[118:119], v241 offset:1024
    ds_read_b64_tr_b16 a[244:245], v242 offset:0
    v_mfma_f32_32x32x16_bf16 v[36:51], a[12:15], v[104:107], v[36:51]
    ds_read_b64_tr_b16 v[100:101], v124 offset:8192
    ds_read_b64_tr_b16 v[102:103], v124 offset:8448
    buffer_load_dwordx4 v147, s[4:7], s13 offen offset:2048 sc1 lds
    ds_read_b64_tr_b16 a[246:247], v242 offset:1024
    ds_read_b64_tr_b16 a[120:121], v241 offset:8192
    v_mfma_f32_32x32x16_bf16 v[52:67], a[140:143], v[104:107], v[52:67]
    ds_read_b64_tr_b16 a[122:123], v241 offset:9216
    ds_read_b64_tr_b16 a[248:249], v242 offset:8192
    ds_read_b64_tr_b16 a[250:251], v242 offset:9216
    ds_read_b64_tr_b16 a[124:125], v241 offset:16384
    ds_read_b64_tr_b16 a[126:127], v241 offset:17408
    ds_read_b64_tr_b16 a[252:253], v242 offset:16384
    v_mfma_f32_32x32x16_bf16 v[36:51], a[16:19], v[108:111], v[36:51]
    ds_read_b64_tr_b16 v[104:105], v125 offset:8192
    ds_read_b64_tr_b16 v[106:107], v125 offset:8448
    buffer_load_dwordx4 v147, s[4:7], s13 offen offset:3072 sc1 lds
    ds_read_b64_tr_b16 a[254:255], v242 offset:17408
    v_mfma_f32_32x32x16_bf16 v[52:67], a[144:147], v[108:111], v[52:67]
    s_waitcnt lgkmcnt(15)
    s_waitcnt lgkmcnt(0)
    v_mfma_f32_32x32x16_bf16 v[36:51], a[20:23], v[112:115], v[36:51]
    s_add_u32 m0, s75, 36864
    ds_read_b64_tr_b16 v[108:109], v126 offset:8192
    ds_read_b64_tr_b16 v[110:111], v126 offset:8448
    s_add_u32 s13, s74, 69632
    buffer_load_dwordx4 v147, s[4:7], s13 offen offset:0 sc1 lds
    v_mfma_f32_32x32x16_bf16 v[52:67], a[148:151], v[112:115], v[52:67]
    v_mfma_f32_32x32x16_bf16 v[36:51], a[24:27], v[116:119], v[36:51]
    ds_read_b64_tr_b16 v[112:113], v127 offset:8192
    ds_read_b64_tr_b16 v[114:115], v127 offset:8448
    buffer_load_dwordx4 v147, s[4:7], s13 offen offset:1024 sc1 lds
    v_mfma_f32_32x32x16_bf16 v[52:67], a[152:155], v[116:119], v[52:67]
    s_barrier
    v_mfma_f32_32x32x16_bf16 v[36:51], a[28:31], v[120:123], v[36:51]
    ds_read_b64_tr_b16 v[116:117], v141 offset:8192
    ds_read_b64_tr_b16 v[118:119], v141 offset:8448
    buffer_load_dwordx4 v147, s[4:7], s13 offen offset:2048 sc1 lds
    v_lshrrev_b32 v240, 3, v1
    v_bfe_u32 v241, v1, 4, 1
    v_mfma_f32_32x32x16_bf16 v[52:67], a[156:159], v[120:123], v[52:67]
    v_lshlrev_b32 v241, 2, v241
    v_and_b32 v242, 7, v1
    v_xor_b32 v241, v241, v242
    v_lshlrev_b32 v240, 10, v240
    v_lshl_add_u32 v240, v241, 4, v240
    v_add_u32 v241, 7168, v240
    v_mfma_f32_32x32x16_bf16 v[36:51], a[32:35], v[100:103], v[36:51]
    ds_read_b64_tr_b16 v[120:121], v142 offset:8192
    ds_read_b64_tr_b16 v[122:123], v142 offset:8448
    buffer_load_dwordx4 v147, s[4:7], s13 offen offset:3072 sc1 lds
    v_lshrrev_b32 v242, 5, v1
    v_lshlrev_b32 v242, 10, v242
    v_mfma_f32_32x32x16_bf16 v[52:67], a[160:163], v[100:103], v[52:67]
    v_bfe_u32 v243, v1, 2, 2
    v_lshl_add_u32 v242, v243, 7, v242
    v_bfe_u32 v243, v1, 3, 1
    v_lshl_add_u32 v242, v243, 6, v242
    v_and_b32 v243, 1, v1
    v_lshl_add_u32 v242, v243, 5, v242
    v_mfma_f32_32x32x16_bf16 v[36:51], a[36:39], v[104:107], v[36:51]
    s_add_u32 m0, s75, 0
    ds_read_b64_tr_b16 v[100:101], v2 offset:8192
    ds_read_b64_tr_b16 v[102:103], v2 offset:8448
    s_add_u32 s13, s74, 98304
    buffer_load_dwordx4 v147, s[4:7], s13 offen offset:0 sc1 lds
    v_bfe_u32 v243, v1, 1, 1
    v_mfma_f32_32x32x16_bf16 v[52:67], a[164:167], v[104:107], v[52:67]
    s_waitcnt lgkmcnt(8)
    v_bfe_u32 v244, v1, 4, 1
    v_lshl_add_u32 v243, v244, 1, v243
    v_add_u32 v243, s70, v243
    v_and_b32 v243, 3, v243
    v_lshl_add_u32 v242, v243, 3, v242
    v_add_u32 v244, s91, v242
    v_mfma_f32_32x32x16_bf16 v[36:51], a[40:43], v[108:111], v[36:51]
    ds_read_b64_tr_b16 v[104:105], v3 offset:8192
    ds_read_b64_tr_b16 v[106:107], v3 offset:8448
    buffer_load_dwordx4 v147, s[4:7], s13 offen offset:1024 sc1 lds
    buffer_load_dwordx4 v[200:203], v138, s[4:7], s35 offen offset:0 sc1
    v_mfma_f32_32x32x16_bf16 v[52:67], a[168:171], v[108:111], v[52:67]
    s_waitcnt lgkmcnt(8)
    v_xor_b32 v245, 64, v244
    v_add_u32 v246, 0x10000, v244
    v_add_u32 v247, 0x10000, v245
    v_add_u32 v242, s90, v242
    v_xor_b32 v243, 64, v242
    v_mfma_f32_32x32x16_bf16 v[36:51], a[44:47], v[112:115], v[36:51]
    ds_read_b64_tr_b16 v[108:109], v124 offset:49152
    ds_read_b64_tr_b16 v[110:111], v124 offset:49408
    buffer_load_dwordx4 v147, s[4:7], s13 offen offset:2048 sc1 lds
    buffer_load_dwordx4 v[204:207], v138, s[4:7], s34 offen offset:0 sc1
    v_mfma_f32_32x32x16_bf16 v[52:67], a[172:175], v[112:115], v[52:67]
    s_waitcnt lgkmcnt(8)
    v_mfma_f32_32x32x16_bf16 v[36:51], a[48:51], v[116:119], v[36:51]
    ds_read_b64_tr_b16 v[112:113], v125 offset:49152
    ds_read_b64_tr_b16 v[114:115], v125 offset:49408
    buffer_load_dwordx4 v147, s[4:7], s13 offen offset:3072 sc1 lds
    buffer_load_dwordx4 v[208:211], v138, s[4:7], s35 offen offset:256 sc1
    v_mfma_f32_32x32x16_bf16 v[52:67], a[176:179], v[116:119], v[52:67]
    s_waitcnt lgkmcnt(8)
    v_mfma_f32_32x32x16_bf16 v[36:51], a[52:55], v[120:123], v[36:51]
    s_add_u32 m0, s75, 4096
    ds_read_b64_tr_b16 v[116:117], v126 offset:49152
    ds_read_b64_tr_b16 v[118:119], v126 offset:49408
    s_add_u32 s13, s74, 102400
    buffer_load_dwordx4 v147, s[4:7], s13 offen offset:0 sc1 lds
    buffer_load_dwordx4 v[212:215], v138, s[4:7], s34 offen offset:256 sc1
    v_mfma_f32_32x32x16_bf16 v[52:67], a[180:183], v[120:123], v[52:67]
    s_waitcnt lgkmcnt(8)
    v_mfma_f32_32x32x16_bf16 v[36:51], a[56:59], v[100:103], v[36:51]
    ds_read_b64_tr_b16 v[120:121], v127 offset:49152
    ds_read_b64_tr_b16 v[122:123], v127 offset:49408
    buffer_load_dwordx4 v147, s[4:7], s13 offen offset:1024 sc1 lds
    v_mfma_f32_32x32x16_bf16 v[52:67], a[184:187], v[100:103], v[52:67]
    s_waitcnt lgkmcnt(8)
    v_mfma_f32_32x32x16_bf16 v[36:51], a[60:63], v[104:107], v[36:51]
    ds_read_b64_tr_b16 v[100:101], v141 offset:49152
    ds_read_b64_tr_b16 v[102:103], v141 offset:49408
    buffer_load_dwordx4 v147, s[4:7], s13 offen offset:2048 sc1 lds
    v_mfma_f32_32x32x16_bf16 v[52:67], a[188:191], v[104:107], v[52:67]
    s_waitcnt lgkmcnt(8)
    v_mfma_f32_32x32x16_bf16 v[4:19], a[64:67], v[108:111], v[4:19]
    ds_read_b64_tr_b16 v[104:105], v142 offset:49152
    ds_read_b64_tr_b16 v[106:107], v142 offset:49408
    buffer_load_dwordx4 v147, s[4:7], s13 offen offset:3072 sc1 lds
    v_mfma_f32_32x32x16_bf16 v[20:35], a[192:195], v[108:111], v[20:35]
    s_waitcnt lgkmcnt(8)
    v_mfma_f32_32x32x16_bf16 v[4:19], a[68:71], v[112:115], v[4:19]
    ds_read_b64_tr_b16 v[108:109], v2 offset:49152
    ds_read_b64_tr_b16 v[110:111], v2 offset:49408
    v_mfma_f32_32x32x16_bf16 v[20:35], a[196:199], v[112:115], v[20:35]
    s_waitcnt lgkmcnt(8)
    v_mfma_f32_32x32x16_bf16 v[4:19], a[72:75], v[116:119], v[4:19]
    ds_read_b64_tr_b16 v[112:113], v3 offset:49152
    ds_read_b64_tr_b16 v[114:115], v3 offset:49408
    buffer_load_dwordx2 v[128:129], v145, s[4:7], s33 offen offset:0 sc1
    buffer_load_dwordx2 v[130:131], v145, s[4:7], s33 offen offset:256 sc1
    v_mfma_f32_32x32x16_bf16 v[20:35], a[200:203], v[116:119], v[20:35]
    s_waitcnt lgkmcnt(8)
    v_mfma_f32_32x32x16_bf16 v[4:19], a[76:79], v[120:123], v[4:19]
    s_add_u32 m0, s90, 0
    ds_read_b64_tr_b16 v[116:117], v124 offset:57344
    ds_read_b64_tr_b16 v[118:119], v124 offset:57600
    s_lshl4_add_u32 s15, s36, s72
    buffer_load_dwordx4 v240, s[60:63], s15 offen lds
    v_mfma_f32_32x32x16_bf16 v[20:35], a[204:207], v[120:123], v[20:35]
    s_waitcnt lgkmcnt(8)
    v_mfma_f32_32x32x16_bf16 v[4:19], a[80:83], v[100:103], v[4:19]
    s_waitcnt vmcnt(15)
    ds_read_b64_tr_b16 v[120:121], v125 offset:57344
    ds_read_b64_tr_b16 v[122:123], v125 offset:57600
    buffer_load_dwordx4 v241, s[60:63], s15 offen offset:1024 lds
    ds_read_b32 v148, v146 offset:32768
    ds_read_b32 v149, v146 offset:33792
    v_mfma_f32_32x32x16_bf16 v[20:35], a[208:211], v[100:103], v[20:35]
    s_waitcnt lgkmcnt(10)
    ds_read_b32 v150, v146 offset:34816
    ds_read_b32 v151, v146 offset:35840
    ds_read_b32 v152, v146 offset:36864
    ds_read_b32 v153, v146 offset:37888
    ds_read_b32 v154, v146 offset:38912
    ds_read_b32 v155, v146 offset:39936
    v_mfma_f32_32x32x16_bf16 v[4:19], a[84:87], v[104:107], v[4:19]
    s_add_u32 m0, s90, 2048
    ds_read_b64_tr_b16 v[100:101], v126 offset:57344
    ds_read_b64_tr_b16 v[102:103], v126 offset:57600
    s_lshl4_add_u32 s15, s37, s72
    buffer_load_dwordx4 v240, s[60:63], s15 offen lds
    v_mfma_f32_32x32x16_bf16 v[20:35], a[212:215], v[104:107], v[20:35]
    s_waitcnt lgkmcnt(15)
    s_waitcnt lgkmcnt(2)
    v_bitop3_b32 v148, v148, v149, s3 bitop3:0x7e
    v_bitop3_b32 v150, v150, v151, s3 bitop3:0x7e
    v_bitop3_b32 v152, v152, v153, s3 bitop3:0x7e
    v_bitop3_b32 v154, v154, v155, s3 bitop3:0x7e
    v_or3_b32 v148, v148, v150, v152
    v_mfma_f32_32x32x16_bf16 v[4:19], a[88:91], v[108:111], v[4:19]
    ds_read_b64_tr_b16 v[104:105], v127 offset:57344
    ds_read_b64_tr_b16 v[106:107], v127 offset:57600
    buffer_load_dwordx4 v241, s[60:63], s15 offen offset:1024 lds
    v_or_b32 v148, v148, v154
    v_and_b32 v148, 0x00010001, v148
    v_mfma_f32_32x32x16_bf16 v[20:35], a[216:219], v[108:111], v[20:35]
    v_cmp_ne_u32 vcc, 0, v148
    s_nop 0
    s_cbranch_vccnz LF_xr_22
LF_xb_24:
    v_mfma_f32_32x32x16_bf16 v[4:19], a[92:95], v[112:115], v[4:19]
    s_add_u32 m0, s90, 4096
    ds_read_b64_tr_b16 v[108:109], v141 offset:57344
    ds_read_b64_tr_b16 v[110:111], v141 offset:57600
    s_lshl4_add_u32 s15, s38, s72
    buffer_load_dwordx4 v240, s[60:63], s15 offen lds
    v_mfma_f32_32x32x16_bf16 v[20:35], a[220:223], v[112:115], v[20:35]
    s_waitcnt vmcnt(10)
    v_min3_u32 v136, v201, v203, v201
    v_max3_u32 v137, v201, v203, v201
    v_min3_u32 v136, v205, v207, v136
    v_max3_u32 v137, v205, v207, v137
    v_min3_u32 v136, v209, v211, v136
    v_mfma_f32_32x32x16_bf16 v[4:19], a[96:99], v[116:119], v[4:19]
    ds_read_b64_tr_b16 v[112:113], v142 offset:57344
    ds_read_b64_tr_b16 v[114:115], v142 offset:57600
    buffer_load_dwordx4 v241, s[60:63], s15 offen offset:1024 lds
    v_max3_u32 v137, v209, v211, v137
    v_min3_u32 v136, v213, v215, v136
    v_mfma_f32_32x32x16_bf16 v[20:35], a[224:227], v[116:119], v[20:35]
    v_max3_u32 v137, v213, v215, v137
    v_xor_b32 v136, s68, v136
    v_xor_b32 v137, s68, v137
    v_or_b32 v136, v136, v137
    v_cmp_ne_u32 vcc, 0, v136
    v_mfma_f32_32x32x16_bf16 v[4:19], a[100:103], v[120:123], v[4:19]
    s_cbranch_vccnz LF_mfr_25
LF_mfb_27:
    ds_read_b64_tr_b16 v[116:117], v2 offset:57344
    ds_read_b64_tr_b16 v[118:119], v2 offset:57600
    v_cmp_gt_u32 vcc, 32, v1
    v_add_f32 v200, v200, v204
    v_cvt_pk_bf16_f32 v136, v200, v200
    v_and_b32 v136, 0xffff0000, v136
    v_mfma_f32_32x32x16_bf16 v[20:35], a[228:231], v[120:123], v[20:35]
    s_waitcnt lgkmcnt(8)
    v_sub_f32 v136, v200, v136
    v_cvt_pk_bf16_f32 v136, v200, v136
    v_cndmask_b32 v176, 0, v136, vcc
    v_add_f32 v202, v202, v206
    v_cvt_pk_bf16_f32 v136, v202, v202
    v_and_b32 v136, 0xffff0000, v136
    v_mfma_f32_32x32x16_bf16 v[4:19], a[104:107], v[100:103], v[4:19]
    ds_read_b64_tr_b16 v[120:121], v3 offset:57344
    ds_read_b64_tr_b16 v[122:123], v3 offset:57600
    v_sub_f32 v136, v202, v136
    v_cvt_pk_bf16_f32 v136, v202, v136
    v_cndmask_b32 v177, 0, v136, vcc
    v_add_f32 v208, v208, v212
    v_mfma_f32_32x32x16_bf16 v[20:35], a[232:235], v[100:103], v[20:35]
    s_waitcnt lgkmcnt(8)
    v_cvt_pk_bf16_f32 v136, v208, v208
    v_and_b32 v136, 0xffff0000, v136
    v_sub_f32 v136, v208, v136
    v_cvt_pk_bf16_f32 v136, v208, v136
    v_cndmask_b32 v180, 0, v136, vcc
    v_add_f32 v210, v210, v214
    v_mfma_f32_32x32x16_bf16 v[4:19], a[108:111], v[104:107], v[4:19]
    ds_read_b64_tr_b16 v[100:101], v124 offset:16384
    ds_read_b64_tr_b16 v[102:103], v124 offset:16640
    v_cvt_pk_bf16_f32 v136, v210, v210
    v_and_b32 v136, 0xffff0000, v136
    v_sub_f32 v136, v210, v136
    v_cvt_pk_bf16_f32 v136, v210, v136
    v_mfma_f32_32x32x16_bf16 v[20:35], a[236:239], v[104:107], v[20:35]
    s_waitcnt lgkmcnt(8)
    v_cndmask_b32 v181, 0, v136, vcc
    v_mfma_f32_32x32x16_bf16 v[4:19], a[112:115], v[108:111], v[4:19]
    ds_read_b64_tr_b16 v[104:105], v125 offset:16384
    ds_read_b64_tr_b16 v[106:107], v125 offset:16640
    v_mfma_f32_32x32x16_bf16 v[20:35], a[240:243], v[108:111], v[20:35]
    s_waitcnt lgkmcnt(8)
    v_mfma_f32_32x32x16_bf16 v[4:19], a[116:119], v[112:115], v[4:19]
    s_waitcnt vmcnt(6)
    ds_read_b64_tr_b16 v[108:109], v126 offset:16384
    ds_read_b64_tr_b16 v[110:111], v126 offset:16640
    v_xor_b32 v136, s68, v129
    v_xor_b32 v137, s68, v131
    v_or_b32 v136, v136, v137
    v_cmp_ne_u32 vcc, 0, v136
    v_mfma_f32_32x32x16_bf16 v[20:35], a[244:247], v[112:115], v[20:35]
    s_waitcnt lgkmcnt(8)
    s_cbranch_vccnz LF_str_28
LF_stb_30:
    s_mov_b32 s44, 0x03020302
    s_mov_b32 s43, 0x01000100
    v_lshlrev_b32 v129, 16, v128
    v_rcp_f32 v136, v129
    v_mfma_f32_32x32x16_bf16 v[4:19], a[120:123], v[116:119], v[4:19]
    ds_read_b64_tr_b16 v[112:113], v127 offset:16384
    ds_read_b64_tr_b16 v[114:115], v127 offset:16640
    v_perm_b32 v184, v128, v128, s44
    v_perm_b32 v185, v128, v128, s43
    v_mul_f32 v128, 0x3eeff558, v136
    v_xor_b32 v184, 0x80008000, v184
    v_mfma_f32_32x32x16_bf16 v[20:35], a[248:251], v[116:119], v[20:35]
    s_waitcnt lgkmcnt(8)
    v_mul_f32 v129, 0x3eeff558, v129
    v_lshlrev_b32 v131, 16, v130
    v_rcp_f32 v136, v131
    v_perm_b32 v188, v130, v130, s44
    v_perm_b32 v189, v130, v130, s43
    v_mfma_f32_32x32x16_bf16 v[4:19], a[124:127], v[120:123], v[4:19]
    ds_read_b64_tr_b16 v[116:117], v141 offset:16384
    ds_read_b64_tr_b16 v[118:119], v141 offset:16640
    v_mul_f32 v130, 0x3eeff558, v136
    v_xor_b32 v188, 0x80008000, v188
    v_mul_f32 v131, 0x3eeff558, v131
    v_mfma_f32_32x32x16_bf16 v[20:35], a[252:255], v[120:123], v[20:35]
    v_mfma_f32_32x32x16_bf16 v[4:19], v[176:179], v[184:187], v[4:19]
    v_mfma_f32_32x32x16_bf16 v[20:35], v[180:183], v[184:187], v[20:35]
    s_waitcnt lgkmcnt(8)
    v_mfma_f32_32x32x16_bf16 v[36:51], a[64:67], v[100:103], v[36:51]
    ds_read_b64_tr_b16 v[120:121], v142 offset:16384
    ds_read_b64_tr_b16 v[122:123], v142 offset:16640
    s_nop 6
    v_mul_f32 v148, v128, v4
    v_mul_f32 v149, v128, v5
    v_mul_f32 v150, v128, v6
    v_mul_f32 v151, v128, v7
    v_mfma_f32_32x32x16_bf16 v[52:67], a[192:195], v[100:103], v[52:67]
    s_waitcnt lgkmcnt(8)
    v_fma_f32 v152, -v148, v148, s77
    v_fma_f32 v153, -v149, v149, s77
    v_fma_f32 v154, -v150, v150, s77
    v_fma_f32 v155, -v151, v151, s77
    v_mul_f32 v152, v148, v152
    v_mul_f32 v153, v149, v153
    v_mfma_f32_32x32x16_bf16 v[36:51], a[68:71], v[104:107], v[36:51]
    ds_read_b64_tr_b16 v[100:101], v2 offset:16384
    ds_read_b64_tr_b16 v[102:103], v2 offset:16640
    v_mul_f32 v154, v150, v154
    v_mul_f32 v155, v151, v155
    v_exp_f32 v152, v152
    v_mfma_f32_32x32x16_bf16 v[52:67], a[196:199], v[104:107], v[52:67]
    v_mul_f32 v148, v148, v12
    v_exp_f32 v153, v153
    v_mul_f32 v149, v149, v13
    v_exp_f32 v154, v154
    s_barrier
    s_waitcnt lgkmcnt(8)
    v_mfma_f32_32x32x16_bf16 v[36:51], a[72:75], v[108:111], v[36:51]
    s_add_u32 m0, s91, 98304
    ds_read_b64_tr_b16 v[104:105], v3 offset:16384
    ds_read_b64_tr_b16 v[106:107], v3 offset:16640
    s_lshl4_add_u32 s15, s39, s72
    buffer_load_dwordx4 v240, s[60:63], s15 offen lds
    v_mul_f32 v150, v150, v14
    v_mfma_f32_32x32x16_bf16 v[52:67], a[200:203], v[108:111], v[52:67]
    s_waitcnt lgkmcnt(8)
    v_exp_f32 v155, v155
    v_mul_f32 v151, v151, v15
    v_fma_f32 v152, v152, v129, v129
    v_fma_f32 v153, v153, v129, v129
    v_fma_f32 v154, v154, v129, v129
    v_mfma_f32_32x32x16_bf16 v[36:51], a[76:79], v[112:115], v[36:51]
    ds_read_b64_tr_b16 v[108:109], v124 offset:24576
    ds_read_b64_tr_b16 v[110:111], v124 offset:24832
    v_add_u32 v124, 0xffff0000, v124
    buffer_load_dwordx4 v241, s[60:63], s15 offen offset:1024 lds
    v_fma_f32 v155, v155, v129, v129
    v_mfma_f32_32x32x16_bf16 v[52:67], a[204:207], v[112:115], v[52:67]
    s_waitcnt lgkmcnt(8)
    s_waitcnt vmcnt(6)
    ds_read_b64_tr_b16 v[200:201], v242 offset:0
    ds_read_b64_tr_b16 v[202:203], v242 offset:512
    ds_read_b64_tr_b16 v[204:205], v243 offset:0
    ds_read_b64_tr_b16 v[206:207], v243 offset:512
    v_mfma_f32_32x32x16_bf16 v[36:51], a[80:83], v[116:119], v[36:51]
    ds_read_b64_tr_b16 v[112:113], v125 offset:24576
    ds_read_b64_tr_b16 v[114:115], v125 offset:24832
    v_add_u32 v125, 0xffff0000, v125
    s_add_u32 m0, s91, 100352
    s_lshl4_add_u32 s15, s40, s72
    buffer_load_dwordx4 v240, s[60:63], s15 offen lds
    v_mfma_f32_32x32x16_bf16 v[52:67], a[208:211], v[116:119], v[52:67]
    s_waitcnt lgkmcnt(12)
    ds_read_b32 v164, v146 offset:0
    ds_read_b32 v165, v146 offset:1024
    ds_read_b32 v166, v146 offset:2048
    ds_read_b32 v167, v146 offset:3072
    ds_read_b32 v168, v146 offset:4096
    ds_read_b32 v169, v146 offset:5120
    v_mfma_f32_32x32x16_bf16 v[36:51], a[84:87], v[120:123], v[36:51]
    ds_read_b64_tr_b16 v[116:117], v126 offset:24576
    ds_read_b64_tr_b16 v[118:119], v126 offset:24832
    v_add_u32 v126, 0xffff0000, v126
    buffer_load_dwordx4 v241, s[60:63], s15 offen offset:1024 lds
    v_mfma_f32_32x32x16_bf16 v[52:67], a[212:215], v[120:123], v[52:67]
    s_waitcnt lgkmcnt(15)
    s_waitcnt vmcnt(6)
    ds_read_b64_tr_b16 v[208:209], v242 offset:2048
    ds_read_b64_tr_b16 v[210:211], v242 offset:2560
    ds_read_b64_tr_b16 v[212:213], v243 offset:2048
    ds_read_b64_tr_b16 v[214:215], v243 offset:2560
    ds_read_b32 v170, v146 offset:6144
    v_mfma_f32_32x32x16_bf16 v[36:51], a[88:91], v[100:103], v[36:51]
    ds_read_b64_tr_b16 v[120:121], v127 offset:24576
    ds_read_b64_tr_b16 v[122:123], v127 offset:24832
    v_add_u32 v127, 0xffff0000, v127
    s_add_u32 m0, s91, 102400
    s_lshl4_add_u32 s15, s41, s72
    buffer_load_dwordx4 v240, s[60:63], s15 offen lds
    v_mfma_f32_32x32x16_bf16 v[52:67], a[216:219], v[100:103], v[52:67]
    ds_read_b32 v171, v146 offset:7168
    v_rcp_f32 v152, v152
    v_rcp_f32 v153, v153
    v_mul_f32 v148, v148, v152
    v_mfma_f32_32x32x16_bf16 v[36:51], a[92:95], v[104:107], v[36:51]
    ds_read_b64_tr_b16 v[100:101], v141 offset:24576
    ds_read_b64_tr_b16 v[102:103], v141 offset:24832
    v_add_u32 v141, 0xffff0000, v141
    buffer_load_dwordx4 v241, s[60:63], s15 offen offset:1024 lds
    v_mul_f32 v149, v149, v153
    v_mfma_f32_32x32x16_bf16 v[52:67], a[220:223], v[104:107], v[52:67]
    s_waitcnt lgkmcnt(15)
    s_waitcnt vmcnt(6)
    ds_read_b64_tr_b16 v[216:217], v242 offset:4096
    ds_read_b64_tr_b16 v[218:219], v242 offset:4608
    ds_read_b64_tr_b16 v[220:221], v243 offset:4096
    ds_read_b64_tr_b16 v[222:223], v243 offset:4608
    v_cvt_pk_bf16_f32 v172, v148, v149
    v_mfma_f32_32x32x16_bf16 v[36:51], a[96:99], v[108:111], v[36:51]
    ds_read_b64_tr_b16 v[104:105], v142 offset:24576
    ds_read_b64_tr_b16 v[106:107], v142 offset:24832
    v_add_u32 v142, 0xffff0000, v142
    s_add_u32 m0, s91, 104448
    s_lshl4_add_u32 s15, s42, s72
    buffer_load_dwordx4 v240, s[60:63], s15 offen lds
    v_mfma_f32_32x32x16_bf16 v[52:67], a[224:227], v[108:111], v[52:67]
    v_rcp_f32 v154, v154
    v_rcp_f32 v155, v155
    v_mul_f32 v150, v150, v154
    v_mul_f32 v151, v151, v155
    v_mfma_f32_32x32x16_bf16 v[36:51], a[100:103], v[112:115], v[36:51]
    ds_read_b64_tr_b16 v[108:109], v2 offset:24576
    ds_read_b64_tr_b16 v[110:111], v2 offset:24832
    v_add_u32 v2, 0xffff0000, v2
    buffer_load_dwordx4 v241, s[60:63], s15 offen offset:1024 lds
    v_cvt_pk_bf16_f32 v173, v150, v151
    v_mfma_f32_32x32x16_bf16 v[52:67], a[228:231], v[112:115], v[52:67]
    s_waitcnt lgkmcnt(15)
    v_and_or_b32 v172, v172, v252, s3
    v_and_or_b32 v173, v173, v252, s31
    v_mul_f32 v156, v128, v8
    v_mul_f32 v157, v128, v9
    v_mul_f32 v158, v128, v10
    v_mul_f32 v159, v128, v11
    v_mfma_f32_32x32x16_bf16 v[36:51], a[104:107], v[116:119], v[36:51]
    ds_read_b64_tr_b16 v[112:113], v3 offset:24576
    ds_read_b64_tr_b16 v[114:115], v3 offset:24832
    v_add_u32 v3, 0xffff0000, v3
    v_fma_f32 v160, -v156, v156, s77
    v_fma_f32 v161, -v157, v157, s77
    v_fma_f32 v162, -v158, v158, s77
    v_mfma_f32_32x32x16_bf16 v[52:67], a[232:235], v[116:119], v[52:67]
    s_waitcnt lgkmcnt(13)
    buffer_load_dwordx2 v[132:133], v145, s[4:7], s33 offen offset:512 sc1
    buffer_load_dwordx2 v[134:135], v145, s[4:7], s33 offen offset:768 sc1
    v_fma_f32 v163, -v159, v159, s77
    v_mul_f32 v160, v156, v160
    v_mfma_f32_32x32x16_bf16 v[36:51], a[108:111], v[120:123], v[36:51]
    ds_read_b64_tr_b16 v[116:117], v124 offset:32768
    ds_read_b64_tr_b16 v[118:119], v124 offset:33024
    s_add_u32 m0, s90, 0
    s_lshl4_add_u32 s15, s36, s28
    buffer_load_dwordx4 v240, s[60:63], s15 offen lds
    v_mfma_f32_32x32x16_bf16 v[52:67], a[236:239], v[120:123], v[52:67]
    s_waitcnt lgkmcnt(12)
    v_mul_f32 v161, v157, v161
    v_mul_f32 v162, v158, v162
    v_mul_f32 v163, v159, v163
    v_bitop3_b32 v164, v164, v165, s3 bitop3:0x7e
    v_bitop3_b32 v166, v166, v167, s3 bitop3:0x7e
    v_mfma_f32_32x32x16_bf16 v[36:51], a[112:115], v[100:103], v[36:51]
    ds_read_b64_tr_b16 v[120:121], v125 offset:32768
    ds_read_b64_tr_b16 v[122:123], v125 offset:33024
    buffer_load_dwordx4 v241, s[60:63], s15 offen offset:1024 lds
    v_bitop3_b32 v168, v168, v169, s3 bitop3:0x7e
    v_bitop3_b32 v170, v170, v171, s3 bitop3:0x7e
    v_mfma_f32_32x32x16_bf16 v[52:67], a[240:243], v[100:103], v[52:67]
    s_waitcnt lgkmcnt(8)
    v_or3_b32 v164, v164, v166, v168
    v_or_b32 v164, v164, v170
    v_and_b32 v164, 0x00010001, v164
    v_cmp_ne_u32 vcc, 0, v164
    s_nop 0
    s_cbranch_vccnz LF_xr_31
LF_xb_33:
    v_mul_f32 v156, v156, v16
    v_mfma_f32_32x32x16_bf16 v[36:51], a[116:119], v[104:107], v[36:51]
    ds_read_b64_tr_b16 v[100:101], v126 offset:32768
    ds_read_b64_tr_b16 v[102:103], v126 offset:33024
    s_add_u32 m0, s90, 2048
    s_lshl4_add_u32 s15, s37, s28
    buffer_load_dwordx4 v240, s[60:63], s15 offen lds
    v_mfma_f32_32x32x16_bf16 v[52:67], a[244:247], v[104:107], v[52:67]
    s_waitcnt lgkmcnt(8)
    v_exp_f32 v160, v160
    v_exp_f32 v161, v161
    v_mul_f32 v157, v157, v17
    v_mul_f32 v158, v158, v18
    v_mfma_f32_32x32x16_bf16 v[36:51], a[120:123], v[108:111], v[36:51]
    ds_read_b64_tr_b16 v[104:105], v127 offset:32768
    ds_read_b64_tr_b16 v[106:107], v127 offset:33024
    buffer_load_dwordx4 v241, s[60:63], s15 offen offset:1024 lds
    v_exp_f32 v162, v162
    v_mfma_f32_32x32x16_bf16 v[52:67], a[248:251], v[108:111], v[52:67]
    s_waitcnt lgkmcnt(8)
    v_exp_f32 v163, v163
    v_mul_f32 v159, v159, v19
    v_fma_f32 v160, v160, v129, v129
    v_fma_f32 v161, v161, v129, v129
    v_fma_f32 v162, v162, v129, v129
    v_mfma_f32_32x32x16_bf16 v[36:51], a[124:127], v[112:115], v[36:51]
    ds_read_b64_tr_b16 v[108:109], v141 offset:32768
    ds_read_b64_tr_b16 v[110:111], v141 offset:33024
    s_add_u32 m0, s90, 4096
    s_lshl4_add_u32 s15, s38, s28
    buffer_load_dwordx4 v240, s[60:63], s15 offen lds
    v_mfma_f32_32x32x16_bf16 v[52:67], a[252:255], v[112:115], v[52:67]
    v_fma_f32 v163, v163, v129, v129
    v_rcp_f32 v160, v160
    v_rcp_f32 v161, v161
    v_mul_f32 v156, v156, v160
    v_mfma_f32_32x32x16_bf16 v[36:51], v[176:179], v[188:191], v[36:51]
    v_rcp_f32 v162, v162
    v_rcp_f32 v163, v163
    v_mul_f32 v157, v157, v161
    v_mul_f32 v158, v158, v162
    v_mfma_f32_32x32x16_bf16 v[52:67], v[180:183], v[188:191], v[52:67]
    v_mul_f32 v159, v159, v163
    v_cvt_pk_bf16_f32 v174, v156, v157
    v_cvt_pk_bf16_f32 v175, v158, v159
    s_add_u32 s101, s76, 0
    v_mul_f32 v148, v128, v20
    v_mul_f32 v149, v128, v21
    s_waitcnt lgkmcnt(8)
    v_mfma_f32_32x32x16_bf16 v[68:83], a[0:3], v[116:119], 0
    ds_read_b64_tr_b16 v[112:113], v142 offset:32768
    ds_read_b64_tr_b16 v[114:115], v142 offset:33024
    buffer_load_dwordx4 v241, s[60:63], s15 offen offset:1024 lds
    v_mul_f32 v150, v128, v22
    v_mul_f32 v151, v128, v23
    v_mfma_f32_32x32x16_bf16 v[84:99], a[128:131], v[116:119], 0
    s_waitcnt lgkmcnt(8)
    buffer_store_dwordx4 v[172:175], v147, s[4:7], s101 offen sc1
    v_fma_f32 v152, -v148, v148, s77
    v_fma_f32 v153, -v149, v149, s77
    v_mfma_f32_32x32x16_bf16 v[68:83], a[4:7], v[120:123], v[68:83]
    ds_read_b64_tr_b16 v[116:117], v2 offset:32768
    ds_read_b64_tr_b16 v[118:119], v2 offset:33024
    v_fma_f32 v154, -v150, v150, s77
    v_fma_f32 v155, -v151, v151, s77
    v_mul_f32 v152, v148, v152
    v_mul_f32 v153, v149, v153
    v_mfma_f32_32x32x16_bf16 v[84:99], a[132:135], v[120:123], v[84:99]
    v_mul_f32 v154, v150, v154
    v_mul_f32 v155, v151, v155
    v_exp_f32 v152, v152
    v_mul_f32 v148, v148, v28
    v_mul_f32 v149, v149, v29
    s_barrier
    s_waitcnt lgkmcnt(8)
    v_mfma_f32_32x32x16_bf16 v[68:83], a[8:11], v[100:103], v[68:83]
    ds_read_b64_tr_b16 v[120:121], v3 offset:32768
    ds_read_b64_tr_b16 v[122:123], v3 offset:33024
    v_exp_f32 v153, v153
    v_exp_f32 v154, v154
    v_mfma_f32_32x32x16_bf16 v[84:99], a[136:139], v[100:103], v[84:99]
    s_waitcnt lgkmcnt(8)
    v_mul_f32 v150, v150, v30
    v_exp_f32 v155, v155
    v_mul_f32 v151, v151, v31
    v_fma_f32 v152, v152, v129, v129
    v_fma_f32 v153, v153, v129, v129
    v_mfma_f32_32x32x16_bf16 v[68:83], a[12:15], v[104:107], v[68:83]
    s_add_u32 m0, s91, 65536
    ds_read_b64_tr_b16 v[100:101], v124 offset:40960
    ds_read_b64_tr_b16 v[102:103], v124 offset:41216
    s_lshl4_add_u32 s15, s39, s28
    buffer_load_dwordx4 v240, s[60:63], s15 offen lds
    v_fma_f32 v154, v154, v129, v129
    v_mfma_f32_32x32x16_bf16 v[84:99], a[140:143], v[104:107], v[84:99]
    s_waitcnt lgkmcnt(8)
    v_fma_f32 v155, v155, v129, v129
    v_rcp_f32 v152, v152
    v_rcp_f32 v153, v153
    v_mul_f32 v148, v148, v152
    v_mfma_f32_32x32x16_bf16 v[68:83], a[16:19], v[108:111], v[68:83]
    ds_read_b64_tr_b16 v[104:105], v125 offset:40960
    ds_read_b64_tr_b16 v[106:107], v125 offset:41216
    buffer_load_dwordx4 v241, s[60:63], s15 offen offset:1024 lds
    v_rcp_f32 v154, v154
    v_mfma_f32_32x32x16_bf16 v[84:99], a[144:147], v[108:111], v[84:99]
    s_waitcnt lgkmcnt(8)
    s_waitcnt vmcnt(17)
    ds_read_b64_tr_b16 v[224:225], v246 offset:32768
    ds_read_b64_tr_b16 v[226:227], v246 offset:33280
    ds_read_b64_tr_b16 v[228:229], v247 offset:32768
    ds_read_b64_tr_b16 v[230:231], v247 offset:33280
    v_mul_f32 v149, v149, v153
    v_mfma_f32_32x32x16_bf16 v[68:83], a[20:23], v[112:115], v[68:83]
    s_add_u32 m0, s91, 67584
    ds_read_b64_tr_b16 v[108:109], v126 offset:40960
    ds_read_b64_tr_b16 v[110:111], v126 offset:41216
    s_lshl4_add_u32 s15, s40, s28
    buffer_load_dwordx4 v240, s[60:63], s15 offen lds
    v_mul_f32 v150, v150, v154
    v_mfma_f32_32x32x16_bf16 v[84:99], a[148:151], v[112:115], v[84:99]
    s_waitcnt lgkmcnt(12)
    v_rcp_f32 v155, v155
    s_nop 0
    v_mul_f32 v151, v151, v155
    v_cvt_pk_bf16_f32 v172, v148, v149
    v_cvt_pk_bf16_f32 v173, v150, v151
    v_and_or_b32 v172, v172, v252, s3
    v_mfma_f32_32x32x16_bf16 v[68:83], a[24:27], v[116:119], v[68:83]
    ds_read_b64_tr_b16 v[112:113], v127 offset:40960
    ds_read_b64_tr_b16 v[114:115], v127 offset:41216
    buffer_load_dwordx4 v241, s[60:63], s15 offen offset:1024 lds
    v_and_or_b32 v173, v173, v252, s31
    v_mul_f32 v156, v128, v24
    v_mfma_f32_32x32x16_bf16 v[84:99], a[152:155], v[116:119], v[84:99]
    s_waitcnt lgkmcnt(12)
    s_waitcnt vmcnt(17)
    ds_read_b64_tr_b16 v[232:233], v246 offset:34816
    ds_read_b64_tr_b16 v[234:235], v246 offset:35328
    ds_read_b64_tr_b16 v[236:237], v247 offset:34816
    ds_read_b64_tr_b16 v[238:239], v247 offset:35328
    v_mul_f32 v157, v128, v25
    v_mfma_f32_32x32x16_bf16 v[68:83], a[28:31], v[120:123], v[68:83]
    s_add_u32 m0, s91, 69632
    ds_read_b64_tr_b16 v[116:117], v141 offset:40960
    ds_read_b64_tr_b16 v[118:119], v141 offset:41216
    s_lshl4_add_u32 s15, s41, s28
    buffer_load_dwordx4 v240, s[60:63], s15 offen lds
    v_mul_f32 v158, v128, v26
    v_mfma_f32_32x32x16_bf16 v[84:99], a[156:159], v[120:123], v[84:99]
    v_mul_f32 v159, v128, v27
    v_fma_f32 v160, -v156, v156, s77
    v_fma_f32 v161, -v157, v157, s77
    v_fma_f32 v162, -v158, v158, s77
    v_fma_f32 v163, -v159, v159, s77
    v_mul_f32 v160, v156, v160
    s_waitcnt lgkmcnt(15)
    v_mfma_f32_32x32x16_bf16 v[68:83], a[32:35], v[100:103], v[68:83]
    s_waitcnt vmcnt(12)
    ds_read_b64_tr_b16 v[120:121], v142 offset:40960
    ds_read_b64_tr_b16 v[122:123], v142 offset:41216
    buffer_load_dwordx4 v241, s[60:63], s15 offen offset:1024 lds
    v_xor_b32 v136, s68, v133
    v_xor_b32 v137, s68, v135
    v_mfma_f32_32x32x16_bf16 v[84:99], a[160:163], v[100:103], v[84:99]
    s_waitcnt lgkmcnt(15)
    v_or_b32 v136, v136, v137
    v_cmp_ne_u32 vcc, 0, v136
    s_nop 0
    s_cbranch_vccnz LF_str_34
LF_stb_36:
    s_mov_b32 s44, 0x03020302
    s_mov_b32 s43, 0x01000100
    v_lshlrev_b32 v133, 16, v132
    v_mfma_f32_32x32x16_bf16 v[68:83], a[36:39], v[104:107], v[68:83]
    s_add_u32 m0, s91, 71680
    ds_read_b64_tr_b16 v[100:101], v2 offset:40960
    ds_read_b64_tr_b16 v[102:103], v2 offset:41216
    s_lshl4_add_u32 s15, s42, s28
    buffer_load_dwordx4 v240, s[60:63], s15 offen lds
    v_perm_b32 v192, v132, v132, s44
    v_mfma_f32_32x32x16_bf16 v[84:99], a[164:167], v[104:107], v[84:99]
    s_waitcnt lgkmcnt(12)
    v_rcp_f32 v136, v133
    v_perm_b32 v193, v132, v132, s43
    v_mul_f32 v132, 0x3eeff558, v136
    v_xor_b32 v192, 0x80008000, v192
    v_mul_f32 v133, 0x3eeff558, v133
    v_mfma_f32_32x32x16_bf16 v[68:83], a[40:43], v[108:111], v[68:83]
    ds_read_b64_tr_b16 v[104:105], v3 offset:40960
    ds_read_b64_tr_b16 v[106:107], v3 offset:41216
    buffer_load_dwordx4 v241, s[60:63], s15 offen offset:1024 lds
    v_lshlrev_b32 v135, 16, v134
    v_perm_b32 v196, v134, v134, s44
    v_mfma_f32_32x32x16_bf16 v[84:99], a[168:171], v[108:111], v[84:99]
    s_waitcnt lgkmcnt(12)
    v_rcp_f32 v136, v135
    v_perm_b32 v197, v134, v134, s43
    v_mul_f32 v134, 0x3eeff558, v136
    v_xor_b32 v196, 0x80008000, v196
    v_mul_f32 v135, 0x3eeff558, v135
    v_mfma_f32_32x32x16_bf16 v[68:83], a[44:47], v[112:115], v[68:83]
    ds_read_b64_tr_b16 v[108:109], v124 offset:49152
    ds_read_b64_tr_b16 v[110:111], v124 offset:49408
    s_add_u32 m0, s91, 98304
    s_lshl4_add_u32 s15, s36, s29
    buffer_load_dwordx4 v240, s[60:63], s15 offen lds
    v_mfma_f32_32x32x16_bf16 v[84:99], a[172:175], v[112:115], v[84:99]
    s_waitcnt lgkmcnt(8)
    v_mul_f32 v161, v157, v161
    v_mul_f32 v162, v158, v162
    v_mul_f32 v163, v159, v163
    v_exp_f32 v160, v160
    v_mul_f32 v156, v156, v32
    v_mfma_f32_32x32x16_bf16 v[68:83], a[48:51], v[116:119], v[68:83]
    ds_read_b64_tr_b16 v[112:113], v125 offset:49152
    ds_read_b64_tr_b16 v[114:115], v125 offset:49408
    buffer_load_dwordx4 v241, s[60:63], s15 offen offset:1024 lds
    v_exp_f32 v161, v161
    v_mfma_f32_32x32x16_bf16 v[84:99], a[176:179], v[116:119], v[84:99]
    s_waitcnt lgkmcnt(8)
    v_mul_f32 v157, v157, v33
    v_exp_f32 v162, v162
    v_mul_f32 v158, v158, v34
    v_exp_f32 v163, v163
    v_mfma_f32_32x32x16_bf16 v[68:83], a[52:55], v[120:123], v[68:83]
    ds_read_b64_tr_b16 v[116:117], v126 offset:49152
    ds_read_b64_tr_b16 v[118:119], v126 offset:49408
    s_add_u32 m0, s91, 100352
    s_lshl4_add_u32 s15, s37, s29
    buffer_load_dwordx4 v240, s[60:63], s15 offen lds
    v_mfma_f32_32x32x16_bf16 v[84:99], a[180:183], v[120:123], v[84:99]
    s_waitcnt lgkmcnt(8)
    v_mul_f32 v159, v159, v35
    v_fma_f32 v160, v160, v129, v129
    v_fma_f32 v161, v161, v129, v129
    v_fma_f32 v162, v162, v129, v129
    v_fma_f32 v163, v163, v129, v129
    v_mfma_f32_32x32x16_bf16 v[68:83], a[56:59], v[100:103], v[68:83]
    ds_read_b64_tr_b16 v[120:121], v127 offset:49152
    ds_read_b64_tr_b16 v[122:123], v127 offset:49408
    buffer_load_dwordx4 v241, s[60:63], s15 offen offset:1024 lds
    v_rcp_f32 v160, v160
    v_mfma_f32_32x32x16_bf16 v[84:99], a[184:187], v[100:103], v[84:99]
    s_waitcnt lgkmcnt(8)
    v_rcp_f32 v161, v161
    v_rcp_f32 v162, v162
    v_rcp_f32 v163, v163
    v_mfma_f32_32x32x16_bf16 v[68:83], a[60:63], v[104:107], v[68:83]
    ds_read_b64_tr_b16 v[100:101], v141 offset:49152
    ds_read_b64_tr_b16 v[102:103], v141 offset:49408
    v_mul_f32 v156, v156, v160
    v_mul_f32 v157, v157, v161
    v_mul_f32 v158, v158, v162
    v_mul_f32 v159, v159, v163
    v_mfma_f32_32x32x16_bf16 v[84:99], a[188:191], v[104:107], v[84:99]
    s_waitcnt lgkmcnt(8)
    v_cvt_pk_bf16_f32 v174, v156, v157
    v_cvt_pk_bf16_f32 v175, v158, v159
    s_add_u32 s101, s76, 1024
    v_mul_f32 v148, v130, v36
    v_mul_f32 v149, v130, v37
    v_mul_f32 v150, v130, v38
    v_mfma_f32_32x32x16_bf16 v[68:83], a[64:67], v[108:111], v[68:83]
    ds_read_b64_tr_b16 v[104:105], v142 offset:49152
    ds_read_b64_tr_b16 v[106:107], v142 offset:49408
    buffer_store_dwordx4 v[172:175], v147, s[4:7], s101 offen sc1
    v_mfma_f32_32x32x16_bf16 v[84:99], a[192:195], v[108:111], v[84:99]
    s_waitcnt lgkmcnt(8)
    v_mul_f32 v151, v130, v39
    v_fma_f32 v152, -v148, v148, s77
    v_fma_f32 v153, -v149, v149, s77
    v_fma_f32 v154, -v150, v150, s77
    v_fma_f32 v155, -v151, v151, s77
    v_mul_f32 v152, v148, v152
    v_mfma_f32_32x32x16_bf16 v[68:83], a[68:71], v[112:115], v[68:83]
    ds_read_b64_tr_b16 v[108:109], v2 offset:49152
    ds_read_b64_tr_b16 v[110:111], v2 offset:49408
    v_mul_f32 v153, v149, v153
    v_mul_f32 v154, v150, v154
    v_mul_f32 v155, v151, v155
    v_mul_f32 v148, v148, v44
    v_mfma_f32_32x32x16_bf16 v[84:99], a[196:199], v[112:115], v[84:99]
    s_waitcnt lgkmcnt(8)
    v_exp_f32 v152, v152
    v_exp_f32 v153, v153
    v_mul_f32 v149, v149, v45
    v_mul_f32 v150, v150, v46
    v_mfma_f32_32x32x16_bf16 v[68:83], a[72:75], v[116:119], v[68:83]
    ds_read_b64_tr_b16 v[112:113], v3 offset:49152
    ds_read_b64_tr_b16 v[114:115], v3 offset:49408
    v_exp_f32 v154, v154
    v_exp_f32 v155, v155
    v_mfma_f32_32x32x16_bf16 v[84:99], a[200:203], v[116:119], v[84:99]
    s_waitcnt lgkmcnt(8)
    v_mul_f32 v151, v151, v47
    v_fma_f32 v152, v152, v131, v131
    v_fma_f32 v153, v153, v131, v131
    v_fma_f32 v154, v154, v131, v131
    v_fma_f32 v155, v155, v131, v131
    v_mfma_f32_32x32x16_bf16 v[68:83], a[76:79], v[120:123], v[68:83]
    ds_read_b64_tr_b16 v[116:117], v124 offset:57344
    ds_read_b64_tr_b16 v[118:119], v124 offset:57600
    v_rcp_f32 v152, v152
    v_rcp_f32 v153, v153
    v_mfma_f32_32x32x16_bf16 v[84:99], a[204:207], v[120:123], v[84:99]
    s_waitcnt lgkmcnt(8)
    v_rcp_f32 v154, v154
    v_rcp_f32 v155, v155
    v_mul_f32 v148, v148, v152
    v_mul_f32 v149, v149, v153
    v_mfma_f32_32x32x16_bf16 v[68:83], a[80:83], v[100:103], v[68:83]
    ds_read_b64_tr_b16 v[120:121], v125 offset:57344
    ds_read_b64_tr_b16 v[122:123], v125 offset:57600
    v_mul_f32 v150, v150, v154
    v_mul_f32 v151, v151, v155
    v_cvt_pk_bf16_f32 v172, v148, v149
    v_cvt_pk_bf16_f32 v173, v150, v151
    v_mfma_f32_32x32x16_bf16 v[84:99], a[208:211], v[100:103], v[84:99]
    s_waitcnt lgkmcnt(8)
    v_and_or_b32 v172, v172, v252, s3
    v_and_or_b32 v173, v173, v252, s31
    v_mul_f32 v156, v130, v40
    v_mul_f32 v157, v130, v41
    v_mul_f32 v158, v130, v42
    v_mul_f32 v159, v130, v43
    v_mfma_f32_32x32x16_bf16 v[68:83], a[84:87], v[104:107], v[68:83]
    ds_read_b64_tr_b16 v[100:101], v126 offset:57344
    ds_read_b64_tr_b16 v[102:103], v126 offset:57600
    v_fma_f32 v160, -v156, v156, s77
    v_fma_f32 v161, -v157, v157, s77
    v_fma_f32 v162, -v158, v158, s77
    v_fma_f32 v163, -v159, v159, s77
    v_mfma_f32_32x32x16_bf16 v[84:99], a[212:215], v[104:107], v[84:99]
    s_waitcnt lgkmcnt(8)
    v_mul_f32 v160, v156, v160
    v_mul_f32 v161, v157, v161
    v_mul_f32 v162, v158, v162
    v_mul_f32 v163, v159, v163
    v_exp_f32 v160, v160
    v_mfma_f32_32x32x16_bf16 v[68:83], a[88:91], v[108:111], v[68:83]
    ds_read_b64_tr_b16 v[104:105], v127 offset:57344
    ds_read_b64_tr_b16 v[106:107], v127 offset:57600
    v_mul_f32 v156, v156, v48
    v_exp_f32 v161, v161
    v_mul_f32 v157, v157, v49
    v_mfma_f32_32x32x16_bf16 v[84:99], a[216:219], v[108:111], v[84:99]
    s_waitcnt lgkmcnt(8)
    v_exp_f32 v162, v162
    v_mul_f32 v158, v158, v50
    v_exp_f32 v163, v163
    v_mul_f32 v159, v159, v51
    v_mfma_f32_32x32x16_bf16 v[68:83], a[92:95], v[112:115], v[68:83]
    ds_read_b64_tr_b16 v[108:109], v141 offset:57344
    ds_read_b64_tr_b16 v[110:111], v141 offset:57600
    v_fma_f32 v160, v160, v131, v131
    v_fma_f32 v161, v161, v131, v131
    v_fma_f32 v162, v162, v131, v131
    v_fma_f32 v163, v163, v131, v131
    v_mfma_f32_32x32x16_bf16 v[84:99], a[220:223], v[112:115], v[84:99]
    v_rcp_f32 v160, v160
    v_rcp_f32 v161, v161
    v_rcp_f32 v162, v162
    s_barrier
    s_waitcnt lgkmcnt(8)
    v_mfma_f32_32x32x16_bf16 v[68:83], a[96:99], v[116:119], v[68:83]
    ds_read_b64_tr_b16 v[112:113], v142 offset:57344
    ds_read_b64_tr_b16 v[114:115], v142 offset:57600
    v_rcp_f32 v163, v163
    v_mul_f32 v156, v156, v160
    v_mul_f32 v157, v157, v161
    v_mfma_f32_32x32x16_bf16 v[84:99], a[224:227], v[116:119], v[84:99]
    s_waitcnt lgkmcnt(8)
    v_mul_f32 v158, v158, v162
    v_mul_f32 v159, v159, v163
    v_cvt_pk_bf16_f32 v174, v156, v157
    v_cvt_pk_bf16_f32 v175, v158, v159
    s_add_u32 s101, s76, 114688
    v_mul_f32 v148, v130, v52
    v_mfma_f32_32x32x16_bf16 v[68:83], a[100:103], v[120:123], v[68:83]
    ds_read_b64_tr_b16 v[116:117], v2 offset:57344
    ds_read_b64_tr_b16 v[118:119], v2 offset:57600
    buffer_store_dwordx4 v[172:175], v147, s[4:7], s101 offen sc1
    v_mfma_f32_32x32x16_bf16 v[84:99], a[228:231], v[120:123], v[84:99]
    s_waitcnt lgkmcnt(8)
    v_mul_f32 v149, v130, v53
    v_mul_f32 v150, v130, v54
    v_mul_f32 v151, v130, v55
    v_fma_f32 v152, -v148, v148, s77
    v_fma_f32 v153, -v149, v149, s77
    v_fma_f32 v154, -v150, v150, s77
    v_mfma_f32_32x32x16_bf16 v[68:83], a[104:107], v[100:103], v[68:83]
    ds_read_b64_tr_b16 v[120:121], v3 offset:57344
    ds_read_b64_tr_b16 v[122:123], v3 offset:57600
    v_fma_f32 v155, -v151, v151, s77
    v_mul_f32 v152, v148, v152
    v_mul_f32 v153, v149, v153
    v_mul_f32 v154, v150, v154
    v_mfma_f32_32x32x16_bf16 v[84:99], a[232:235], v[100:103], v[84:99]
    s_waitcnt lgkmcnt(8)
    v_mul_f32 v155, v151, v155
    v_exp_f32 v152, v152
    v_mul_f32 v148, v148, v60
    v_exp_f32 v153, v153
    v_mfma_f32_32x32x16_bf16 v[68:83], a[108:111], v[104:107], v[68:83]
    ds_read_b64_tr_b16 v[100:101], v124 offset:0
    ds_read_b64_tr_b16 v[102:103], v124 offset:256
    v_mul_f32 v149, v149, v61
    v_exp_f32 v154, v154
    v_mul_f32 v150, v150, v62
    v_mfma_f32_32x32x16_bf16 v[84:99], a[236:239], v[104:107], v[84:99]
    s_waitcnt lgkmcnt(8)
    v_exp_f32 v155, v155
    v_mul_f32 v151, v151, v63
    v_fma_f32 v152, v152, v131, v131
    v_fma_f32 v153, v153, v131, v131
    v_fma_f32 v154, v154, v131, v131
    v_mfma_f32_32x32x16_bf16 v[68:83], a[112:115], v[108:111], v[68:83]
    ds_read_b64_tr_b16 v[104:105], v125 offset:0
    ds_read_b64_tr_b16 v[106:107], v125 offset:256
    v_fma_f32 v155, v155, v131, v131
    v_rcp_f32 v152, v152
    v_mfma_f32_32x32x16_bf16 v[84:99], a[240:243], v[108:111], v[84:99]
    s_waitcnt lgkmcnt(8)
    v_rcp_f32 v153, v153
    v_rcp_f32 v154, v154
    v_rcp_f32 v155, v155
    v_mfma_f32_32x32x16_bf16 v[68:83], a[116:119], v[112:115], v[68:83]
    ds_read_b64_tr_b16 v[108:109], v126 offset:0
    ds_read_b64_tr_b16 v[110:111], v126 offset:256
    v_mul_f32 v148, v148, v152
    v_mul_f32 v149, v149, v153
    v_mul_f32 v150, v150, v154
    v_mul_f32 v151, v151, v155
    v_mfma_f32_32x32x16_bf16 v[84:99], a[244:247], v[112:115], v[84:99]
    s_waitcnt lgkmcnt(8)
    v_cvt_pk_bf16_f32 v172, v148, v149
    v_cvt_pk_bf16_f32 v173, v150, v151
    v_and_or_b32 v172, v172, v252, s3
    v_and_or_b32 v173, v173, v252, s31
    v_mul_f32 v156, v130, v56
    v_mul_f32 v157, v130, v57
    v_mfma_f32_32x32x16_bf16 v[68:83], a[120:123], v[116:119], v[68:83]
    ds_read_b64_tr_b16 v[112:113], v127 offset:0
    ds_read_b64_tr_b16 v[114:115], v127 offset:256
    v_mul_f32 v158, v130, v58
    v_mul_f32 v159, v130, v59
    v_fma_f32 v160, -v156, v156, s77
    v_fma_f32 v161, -v157, v157, s77
    v_mfma_f32_32x32x16_bf16 v[84:99], a[248:251], v[116:119], v[84:99]
    s_waitcnt lgkmcnt(8)
    v_fma_f32 v162, -v158, v158, s77
    v_fma_f32 v163, -v159, v159, s77
    v_mul_f32 v160, v156, v160
    v_mul_f32 v161, v157, v161
    v_mul_f32 v162, v158, v162
    v_mul_f32 v163, v159, v163
    v_mfma_f32_32x32x16_bf16 v[68:83], a[124:127], v[120:123], v[68:83]
    ds_read_b64_tr_b16 v[116:117], v141 offset:0
    ds_read_b64_tr_b16 v[118:119], v141 offset:256
    v_exp_f32 v160, v160
    v_mul_f32 v156, v156, v64
    v_mul_f32 v157, v157, v65
    v_mfma_f32_32x32x16_bf16 v[84:99], a[252:255], v[120:123], v[84:99]
    v_exp_f32 v161, v161
    v_exp_f32 v162, v162
    v_mul_f32 v158, v158, v66
    v_mul_f32 v159, v159, v67
    v_mfma_f32_32x32x16_bf16 v[68:83], v[176:179], v[192:195], v[68:83]
    v_exp_f32 v163, v163
    v_fma_f32 v160, v160, v131, v131
    v_fma_f32 v161, v161, v131, v131
    v_fma_f32 v162, v162, v131, v131
    v_fma_f32 v163, v163, v131, v131
    v_mfma_f32_32x32x16_bf16 v[84:99], v[180:183], v[192:195], v[84:99]
    v_rcp_f32 v160, v160
    v_rcp_f32 v161, v161
    v_rcp_f32 v162, v162
    s_waitcnt lgkmcnt(8)
    v_mfma_f32_32x32x16_bf16 v[4:19], a[0:3], v[100:103], 0
    ds_read_b64_tr_b16 v[120:121], v142 offset:0
    ds_read_b64_tr_b16 v[122:123], v142 offset:256
    v_rcp_f32 v163, v163
    v_mul_f32 v156, v156, v160
    v_mul_f32 v157, v157, v161
    v_mfma_f32_32x32x16_bf16 v[20:35], a[128:131], v[100:103], 0
    s_waitcnt lgkmcnt(8)
    v_mul_f32 v158, v158, v162
    v_mul_f32 v159, v159, v163
    v_cvt_pk_bf16_f32 v174, v156, v157
    v_cvt_pk_bf16_f32 v175, v158, v159
    s_add_u32 s101, s76, 115712
    v_mul_f32 v148, v132, v68
    v_mfma_f32_32x32x16_bf16 v[4:19], a[4:7], v[104:107], v[4:19]
    ds_read_b64_tr_b16 v[100:101], v2 offset:0
    ds_read_b64_tr_b16 v[102:103], v2 offset:256
    buffer_store_dwordx4 v[172:175], v147, s[4:7], s101 offen sc1
    v_mfma_f32_32x32x16_bf16 v[20:35], a[132:135], v[104:107], v[20:35]
    v_mul_f32 v149, v132, v69
    v_mul_f32 v150, v132, v70
    v_mul_f32 v151, v132, v71
    v_fma_f32 v152, -v148, v148, s77
    v_fma_f32 v153, -v149, v149, s77
    v_fma_f32 v154, -v150, v150, s77
    s_barrier
    s_waitcnt lgkmcnt(8)
    v_mfma_f32_32x32x16_bf16 v[4:19], a[8:11], v[108:111], v[4:19]
    s_add_u32 m0, s91, 32768
    ds_read_b64_tr_b16 v[104:105], v3 offset:0
    ds_read_b64_tr_b16 v[106:107], v3 offset:256
    s_lshl4_add_u32 s15, s38, s29
    buffer_load_dwordx4 v240, s[60:63], s15 offen lds
    v_fma_f32 v155, -v151, v151, s77
    v_mfma_f32_32x32x16_bf16 v[20:35], a[136:139], v[108:111], v[20:35]
    s_waitcnt lgkmcnt(8)
    ds_read_b64_tr_b16 a[0:1], v246 offset:36864
    ds_read_b64_tr_b16 a[2:3], v246 offset:37376
    ds_read_b64_tr_b16 a[128:129], v247 offset:36864
    ds_read_b64_tr_b16 a[130:131], v247 offset:37376
    v_mul_f32 v152, v148, v152
    v_mfma_f32_32x32x16_bf16 v[4:19], a[12:15], v[112:115], v[4:19]
    ds_read_b64_tr_b16 v[108:109], v124 offset:8192
    ds_read_b64_tr_b16 v[110:111], v124 offset:8448
    buffer_load_dwordx4 v241, s[60:63], s15 offen offset:1024 lds
    v_mul_f32 v153, v149, v153
    v_mul_f32 v154, v150, v154
    v_mfma_f32_32x32x16_bf16 v[20:35], a[140:143], v[112:115], v[20:35]
    s_waitcnt lgkmcnt(12)
    v_mul_f32 v155, v151, v155
    v_exp_f32 v152, v152
    v_mul_f32 v148, v148, v76
    v_exp_f32 v153, v153
    v_mfma_f32_32x32x16_bf16 v[4:19], a[16:19], v[116:119], v[4:19]
    s_add_u32 m0, s91, 34816
    ds_read_b64_tr_b16 v[112:113], v125 offset:8192
    ds_read_b64_tr_b16 v[114:115], v125 offset:8448
    s_lshl4_add_u32 s15, s39, s29
    buffer_load_dwordx4 v240, s[60:63], s15 offen lds
    v_mul_f32 v149, v149, v77
    v_mfma_f32_32x32x16_bf16 v[20:35], a[144:147], v[116:119], v[20:35]
    s_waitcnt lgkmcnt(12)
    ds_read_b64_tr_b16 a[4:5], v246 offset:38912
    ds_read_b64_tr_b16 a[6:7], v246 offset:39424
    ds_read_b64_tr_b16 a[132:133], v247 offset:38912
    ds_read_b64_tr_b16 a[134:135], v247 offset:39424
    v_mul_f32 v150, v150, v78
    v_mfma_f32_32x32x16_bf16 v[4:19], a[20:23], v[120:123], v[4:19]
    ds_read_b64_tr_b16 v[116:117], v126 offset:8192
    ds_read_b64_tr_b16 v[118:119], v126 offset:8448
    buffer_load_dwordx4 v241, s[60:63], s15 offen offset:1024 lds
    v_exp_f32 v154, v154
    v_mfma_f32_32x32x16_bf16 v[20:35], a[148:151], v[120:123], v[20:35]
    s_waitcnt lgkmcnt(15)
    v_exp_f32 v155, v155
    v_mul_f32 v151, v151, v79
    v_fma_f32 v152, v152, v133, v133
    v_fma_f32 v153, v153, v133, v133
    v_fma_f32 v154, v154, v133, v133
    v_mfma_f32_32x32x16_bf16 v[4:19], a[24:27], v[100:103], v[4:19]
    s_add_u32 m0, s91, 36864
    ds_read_b64_tr_b16 v[120:121], v127 offset:8192
    ds_read_b64_tr_b16 v[122:123], v127 offset:8448
    s_lshl4_add_u32 s15, s40, s29
    buffer_load_dwordx4 v240, s[60:63], s15 offen lds
    v_fma_f32 v155, v155, v133, v133
    v_mfma_f32_32x32x16_bf16 v[20:35], a[152:155], v[100:103], v[20:35]
    s_waitcnt lgkmcnt(15)
    s_waitcnt vmcnt(25)
    ds_read_b64_tr_b16 a[8:9], v242 offset:0
    ds_read_b64_tr_b16 a[10:11], v242 offset:512
    ds_read_b64_tr_b16 a[136:137], v243 offset:0
    ds_read_b64_tr_b16 a[138:139], v243 offset:512
    v_mfma_f32_32x32x16_bf16 v[4:19], a[28:31], v[104:107], v[4:19]
    ds_read_b64_tr_b16 v[100:101], v141 offset:8192
    ds_read_b64_tr_b16 v[102:103], v141 offset:8448
    buffer_load_dwordx4 v241, s[60:63], s15 offen offset:1024 lds
    v_rcp_f32 v152, v152
    v_mfma_f32_32x32x16_bf16 v[20:35], a[156:159], v[104:107], v[20:35]
    s_waitcnt lgkmcnt(15)
    v_rcp_f32 v153, v153
    v_rcp_f32 v154, v154
    v_rcp_f32 v155, v155
    v_mfma_f32_32x32x16_bf16 v[4:19], a[32:35], v[108:111], v[4:19]
    s_add_u32 m0, s91, 38912
    ds_read_b64_tr_b16 v[104:105], v142 offset:8192
    ds_read_b64_tr_b16 v[106:107], v142 offset:8448
    s_lshl4_add_u32 s15, s41, s29
    buffer_load_dwordx4 v240, s[60:63], s15 offen lds
    v_mul_f32 v148, v148, v152
    v_mfma_f32_32x32x16_bf16 v[20:35], a[160:163], v[108:111], v[20:35]
    s_waitcnt lgkmcnt(15)
    s_waitcnt vmcnt(25)
    ds_read_b64_tr_b16 a[12:13], v242 offset:2048
    ds_read_b64_tr_b16 a[14:15], v242 offset:2560
    ds_read_b64_tr_b16 a[140:141], v243 offset:2048
    ds_read_b64_tr_b16 a[142:143], v243 offset:2560
    v_mul_f32 v149, v149, v153
    v_mfma_f32_32x32x16_bf16 v[4:19], a[36:39], v[112:115], v[4:19]
    ds_read_b64_tr_b16 v[108:109], v2 offset:8192
    ds_read_b64_tr_b16 v[110:111], v2 offset:8448
    buffer_load_dwordx4 v241, s[60:63], s15 offen offset:1024 lds
    v_mul_f32 v150, v150, v154
    v_mul_f32 v151, v151, v155
    v_mfma_f32_32x32x16_bf16 v[20:35], a[164:167], v[112:115], v[20:35]
    s_waitcnt lgkmcnt(15)
    v_cvt_pk_bf16_f32 v172, v148, v149
    v_cvt_pk_bf16_f32 v173, v150, v151
    v_and_or_b32 v172, v172, v252, s3
    v_and_or_b32 v173, v173, v252, s31
    v_mul_f32 v156, v132, v72
    v_mul_f32 v157, v132, v73
    v_mfma_f32_32x32x16_bf16 v[4:19], a[40:43], v[116:119], v[4:19]
    ds_read_b64_tr_b16 v[112:113], v3 offset:8192
    ds_read_b64_tr_b16 v[114:115], v3 offset:8448
    s_add_u32 m0, s91, 102400
    s_lshl4_add_u32 s15, s42, s29
    buffer_load_dwordx4 v240, s[60:63], s15 offen lds
    v_mfma_f32_32x32x16_bf16 v[20:35], a[168:171], v[116:119], v[20:35]
    s_waitcnt lgkmcnt(15)
    s_waitcnt vmcnt(25)
    ds_read_b64_tr_b16 a[16:17], v242 offset:4096
    ds_read_b64_tr_b16 a[18:19], v242 offset:4608
    ds_read_b64_tr_b16 a[144:145], v243 offset:4096
    ds_read_b64_tr_b16 a[146:147], v243 offset:4608
    v_mul_f32 v158, v132, v74
    v_mfma_f32_32x32x16_bf16 v[4:19], a[44:47], v[120:123], v[4:19]
    ds_read_b64_tr_b16 v[116:117], v124 offset:16384
    ds_read_b64_tr_b16 v[118:119], v124 offset:16640
    buffer_load_dwordx4 v241, s[60:63], s15 offen offset:1024 lds
    v_mul_f32 v159, v132, v75
    v_fma_f32 v160, -v156, v156, s77
    v_mfma_f32_32x32x16_bf16 v[20:35], a[172:175], v[120:123], v[20:35]
    s_waitcnt lgkmcnt(15)
    v_fma_f32 v161, -v157, v157, s77
    v_fma_f32 v162, -v158, v158, s77
    v_fma_f32 v163, -v159, v159, s77
    v_mul_f32 v160, v156, v160
    v_mul_f32 v161, v157, v161
    v_mul_f32 v162, v158, v162
    v_mfma_f32_32x32x16_bf16 v[4:19], a[48:51], v[100:103], v[4:19]
    ds_read_b64_tr_b16 v[120:121], v125 offset:16384
    ds_read_b64_tr_b16 v[122:123], v125 offset:16640
    s_add_u32 m0, s91, 104448
    s_lshl4_add_u32 s15, s36, s30
    buffer_load_dwordx4 v240, s[60:63], s15 offen lds
    v_mfma_f32_32x32x16_bf16 v[20:35], a[176:179], v[100:103], v[20:35]
    s_waitcnt lgkmcnt(15)
    s_waitcnt vmcnt(24)
    ds_read_b64_tr_b16 a[20:21], v246 offset:0
    ds_read_b64_tr_b16 a[22:23], v246 offset:512
    ds_read_b64_tr_b16 a[148:149], v247 offset:0
    ds_read_b64_tr_b16 a[150:151], v247 offset:512
    v_mul_f32 v163, v159, v163
    v_mfma_f32_32x32x16_bf16 v[4:19], a[52:55], v[104:107], v[4:19]
    ds_read_b64_tr_b16 v[100:101], v126 offset:16384
    ds_read_b64_tr_b16 v[102:103], v126 offset:16640
    buffer_load_dwordx4 v241, s[60:63], s15 offen offset:1024 lds
    v_exp_f32 v160, v160
    v_mfma_f32_32x32x16_bf16 v[20:35], a[180:183], v[104:107], v[20:35]
    s_waitcnt lgkmcnt(15)
    v_mul_f32 v156, v156, v80
    v_exp_f32 v161, v161
    v_mul_f32 v157, v157, v81
    v_exp_f32 v162, v162
    v_mfma_f32_32x32x16_bf16 v[4:19], a[56:59], v[108:111], v[4:19]
    ds_read_b64_tr_b16 v[104:105], v127 offset:16384
    ds_read_b64_tr_b16 v[106:107], v127 offset:16640
    s_add_u32 m0, s90, 0
    s_lshl4_add_u32 s15, s37, s30
    buffer_load_dwordx4 v240, s[60:63], s15 offen lds
    v_mfma_f32_32x32x16_bf16 v[20:35], a[184:187], v[108:111], v[20:35]
    s_waitcnt lgkmcnt(15)
    s_waitcnt vmcnt(24)
    ds_read_b64_tr_b16 a[24:25], v246 offset:2048
    ds_read_b64_tr_b16 a[26:27], v246 offset:2560
    ds_read_b64_tr_b16 a[152:153], v247 offset:2048
    ds_read_b64_tr_b16 a[154:155], v247 offset:2560
    v_mul_f32 v158, v158, v82
    v_mfma_f32_32x32x16_bf16 v[4:19], a[60:63], v[112:115], v[4:19]
    ds_read_b64_tr_b16 v[108:109], v141 offset:16384
    ds_read_b64_tr_b16 v[110:111], v141 offset:16640
    buffer_load_dwordx4 v241, s[60:63], s15 offen offset:1024 lds
    v_exp_f32 v163, v163
    v_mfma_f32_32x32x16_bf16 v[20:35], a[188:191], v[112:115], v[20:35]
    s_waitcnt lgkmcnt(15)
    v_mul_f32 v159, v159, v83
    v_fma_f32 v160, v160, v133, v133
    v_fma_f32 v161, v161, v133, v133
    v_fma_f32 v162, v162, v133, v133
    v_fma_f32 v163, v163, v133, v133
    v_mfma_f32_32x32x16_bf16 v[4:19], a[64:67], v[116:119], v[4:19]
    ds_read_b64_tr_b16 v[112:113], v142 offset:16384
    ds_read_b64_tr_b16 v[114:115], v142 offset:16640
    s_add_u32 m0, s90, 2048
    s_lshl4_add_u32 s15, s38, s30
    buffer_load_dwordx4 v240, s[60:63], s15 offen lds
    v_mfma_f32_32x32x16_bf16 v[20:35], a[192:195], v[116:119], v[20:35]
    s_waitcnt lgkmcnt(15)
    s_waitcnt vmcnt(24)
    ds_read_b64_tr_b16 a[28:29], v246 offset:4096
    ds_read_b64_tr_b16 a[30:31], v246 offset:4608
    ds_read_b64_tr_b16 a[156:157], v247 offset:4096
    ds_read_b64_tr_b16 a[158:159], v247 offset:4608
    v_mfma_f32_32x32x16_bf16 v[4:19], a[68:71], v[120:123], v[4:19]
    ds_read_b64_tr_b16 v[116:117], v2 offset:16384
    ds_read_b64_tr_b16 v[118:119], v2 offset:16640
    buffer_load_dwordx4 v241, s[60:63], s15 offen offset:1024 lds
    v_rcp_f32 v160, v160
    v_mfma_f32_32x32x16_bf16 v[20:35], a[196:199], v[120:123], v[20:35]
    s_waitcnt lgkmcnt(15)
    v_rcp_f32 v161, v161
    v_rcp_f32 v162, v162
    v_rcp_f32 v163, v163
    v_mfma_f32_32x32x16_bf16 v[4:19], a[72:75], v[100:103], v[4:19]
    ds_read_b64_tr_b16 v[120:121], v3 offset:16384
    ds_read_b64_tr_b16 v[122:123], v3 offset:16640
    s_add_u32 m0, s90, 4096
    s_lshl4_add_u32 s15, s39, s30
    buffer_load_dwordx4 v240, s[60:63], s15 offen lds
    v_mfma_f32_32x32x16_bf16 v[20:35], a[200:203], v[100:103], v[20:35]
    s_waitcnt lgkmcnt(15)
    v_mul_f32 v156, v156, v160
    v_mul_f32 v157, v157, v161
    v_mul_f32 v158, v158, v162
    v_mul_f32 v159, v159, v163
    v_cvt_pk_bf16_f32 v174, v156, v157
    v_cvt_pk_bf16_f32 v175, v158, v159
    v_mfma_f32_32x32x16_bf16 v[4:19], a[76:79], v[104:107], v[4:19]
    s_add_u32 s101, s76, 229376
    ds_read_b64_tr_b16 v[100:101], v124 offset:24576
    ds_read_b64_tr_b16 v[102:103], v124 offset:24832
    buffer_load_dwordx4 v241, s[60:63], s15 offen offset:1024 lds
    v_mul_f32 v148, v132, v84
    v_mul_f32 v149, v132, v85
    v_mfma_f32_32x32x16_bf16 v[20:35], a[204:207], v[104:107], v[20:35]
    s_waitcnt lgkmcnt(12)
    buffer_store_dwordx4 v[172:175], v147, s[4:7], s101 offen sc1
    v_mul_f32 v150, v132, v86
    v_mul_f32 v151, v132, v87
    v_mfma_f32_32x32x16_bf16 v[4:19], a[80:83], v[108:111], v[4:19]
    ds_read_b64_tr_b16 v[104:105], v125 offset:24576
    ds_read_b64_tr_b16 v[106:107], v125 offset:24832
    s_add_u32 m0, s91, 65536
    s_lshl4_add_u32 s15, s40, s30
    buffer_load_dwordx4 v240, s[60:63], s15 offen lds
    v_mfma_f32_32x32x16_bf16 v[20:35], a[208:211], v[108:111], v[20:35]
    s_waitcnt lgkmcnt(12)
    v_fma_f32 v152, -v148, v148, s77
    v_fma_f32 v153, -v149, v149, s77
    v_fma_f32 v154, -v150, v150, s77
    v_fma_f32 v155, -v151, v151, s77
    v_mul_f32 v152, v148, v152
    v_mul_f32 v153, v149, v153
    v_mfma_f32_32x32x16_bf16 v[4:19], a[84:87], v[112:115], v[4:19]
    ds_read_b64_tr_b16 v[108:109], v126 offset:24576
    ds_read_b64_tr_b16 v[110:111], v126 offset:24832
    buffer_load_dwordx4 v241, s[60:63], s15 offen offset:1024 lds
    v_mul_f32 v154, v150, v154
    v_mul_f32 v155, v151, v155
    v_mfma_f32_32x32x16_bf16 v[20:35], a[212:215], v[112:115], v[20:35]
    s_waitcnt lgkmcnt(8)
    v_exp_f32 v152, v152
    v_mul_f32 v148, v148, v92
    v_exp_f32 v153, v153
    v_mul_f32 v149, v149, v93
    v_mfma_f32_32x32x16_bf16 v[4:19], a[88:91], v[116:119], v[4:19]
    ds_read_b64_tr_b16 v[112:113], v127 offset:24576
    ds_read_b64_tr_b16 v[114:115], v127 offset:24832
    s_add_u32 m0, s91, 67584
    s_lshl4_add_u32 s15, s41, s30
    buffer_load_dwordx4 v240, s[60:63], s15 offen lds
    v_mfma_f32_32x32x16_bf16 v[20:35], a[216:219], v[116:119], v[20:35]
    s_waitcnt lgkmcnt(8)
    v_exp_f32 v154, v154
    v_mul_f32 v150, v150, v94
    v_exp_f32 v155, v155
    v_mul_f32 v151, v151, v95
    v_mfma_f32_32x32x16_bf16 v[4:19], a[92:95], v[120:123], v[4:19]
    ds_read_b64_tr_b16 v[116:117], v141 offset:24576
    ds_read_b64_tr_b16 v[118:119], v141 offset:24832
    buffer_load_dwordx4 v241, s[60:63], s15 offen offset:1024 lds
    v_fma_f32 v152, v152, v133, v133
    v_fma_f32 v153, v153, v133, v133
    v_mfma_f32_32x32x16_bf16 v[20:35], a[220:223], v[120:123], v[20:35]
    s_waitcnt lgkmcnt(8)
    v_fma_f32 v154, v154, v133, v133
    v_fma_f32 v155, v155, v133, v133
    v_rcp_f32 v152, v152
    v_rcp_f32 v153, v153
    v_mfma_f32_32x32x16_bf16 v[4:19], a[96:99], v[100:103], v[4:19]
    ds_read_b64_tr_b16 v[120:121], v142 offset:24576
    ds_read_b64_tr_b16 v[122:123], v142 offset:24832
    s_add_u32 m0, s91, 69632
    s_lshl4_add_u32 s15, s42, s30
    buffer_load_dwordx4 v240, s[60:63], s15 offen lds
    v_mfma_f32_32x32x16_bf16 v[20:35], a[224:227], v[100:103], v[20:35]
    s_waitcnt lgkmcnt(8)
    v_rcp_f32 v154, v154
    v_rcp_f32 v155, v155
    v_mul_f32 v148, v148, v152
    v_mul_f32 v149, v149, v153
    v_mfma_f32_32x32x16_bf16 v[4:19], a[100:103], v[104:107], v[4:19]
    ds_read_b64_tr_b16 v[100:101], v2 offset:24576
    ds_read_b64_tr_b16 v[102:103], v2 offset:24832
    buffer_load_dwordx4 v241, s[60:63], s15 offen offset:1024 lds
    v_mul_f32 v150, v150, v154
    v_mul_f32 v151, v151, v155
    v_mfma_f32_32x32x16_bf16 v[20:35], a[228:231], v[104:107], v[20:35]
    s_waitcnt lgkmcnt(8)
    v_cvt_pk_bf16_f32 v172, v148, v149
    v_cvt_pk_bf16_f32 v173, v150, v151
    v_and_or_b32 v172, v172, v252, s3
    v_and_or_b32 v173, v173, v252, s31
    v_mul_f32 v156, v132, v88
    v_mul_f32 v157, v132, v89
    v_mfma_f32_32x32x16_bf16 v[4:19], a[104:107], v[108:111], v[4:19]
    s_add_u32 s47, s36, s18
    ds_read_b64_tr_b16 v[104:105], v3 offset:24576
    ds_read_b64_tr_b16 v[106:107], v3 offset:24832
    buffer_load_dwordx4 v[36:39], v147, s[4:7], s47 offen sc1
    v_mul_f32 v158, v132, v90
    v_mul_f32 v159, v132, v91
    v_mfma_f32_32x32x16_bf16 v[20:35], a[232:235], v[108:111], v[20:35]
    s_waitcnt lgkmcnt(8)
    v_fma_f32 v160, -v156, v156, s77
    v_fma_f32 v161, -v157, v157, s77
    v_fma_f32 v162, -v158, v158, s77
    v_fma_f32 v163, -v159, v159, s77
    v_mul_f32 v160, v156, v160
    v_mul_f32 v161, v157, v161
    v_mfma_f32_32x32x16_bf16 v[4:19], a[108:111], v[112:115], v[4:19]
    s_add_u32 s47, s37, s18
    buffer_load_dwordx4 v[40:43], v147, s[4:7], s47 offen sc1
    v_mul_f32 v162, v158, v162
    v_mul_f32 v163, v159, v163
    v_exp_f32 v160, v160
    v_mfma_f32_32x32x16_bf16 v[20:35], a[236:239], v[112:115], v[20:35]
    s_waitcnt lgkmcnt(6)
    v_mul_f32 v156, v156, v96
    v_exp_f32 v161, v161
    v_mul_f32 v157, v157, v97
    v_exp_f32 v162, v162
    v_mfma_f32_32x32x16_bf16 v[4:19], a[112:115], v[116:119], v[4:19]
    s_add_u32 s47, s38, s18
    buffer_load_dwordx4 v[44:47], v147, s[4:7], s47 offen sc1
    v_mul_f32 v158, v158, v98
    v_exp_f32 v163, v163
    v_mul_f32 v159, v159, v99
    v_mfma_f32_32x32x16_bf16 v[20:35], a[240:243], v[116:119], v[20:35]
    s_waitcnt lgkmcnt(4)
    v_fma_f32 v160, v160, v133, v133
    v_fma_f32 v161, v161, v133, v133
    v_fma_f32 v162, v162, v133, v133
    v_fma_f32 v163, v163, v133, v133
    v_rcp_f32 v160, v160
    v_mfma_f32_32x32x16_bf16 v[4:19], a[116:119], v[120:123], v[4:19]
    s_add_u32 s47, s39, s18
    buffer_load_dwordx4 v[48:51], v147, s[4:7], s47 offen sc1
    v_rcp_f32 v161, v161
    v_rcp_f32 v162, v162
    v_mfma_f32_32x32x16_bf16 v[20:35], a[244:247], v[120:123], v[20:35]
    s_waitcnt lgkmcnt(2)
    v_rcp_f32 v163, v163
    v_mul_f32 v156, v156, v160
    v_mul_f32 v157, v157, v161
    v_mul_f32 v158, v158, v162
    v_mul_f32 v159, v159, v163
    v_mfma_f32_32x32x16_bf16 v[4:19], a[120:123], v[100:103], v[4:19]
    s_add_u32 s47, s40, s18
    buffer_load_dwordx4 v[52:55], v147, s[4:7], s47 offen sc1
    v_cvt_pk_bf16_f32 v174, v156, v157
    v_cvt_pk_bf16_f32 v175, v158, v159
    s_add_u32 s101, s76, 230400
    v_mfma_f32_32x32x16_bf16 v[20:35], a[248:251], v[100:103], v[20:35]
    s_waitcnt lgkmcnt(0)
    buffer_store_dwordx4 v[172:175], v147, s[4:7], s101 offen sc1
    v_mfma_f32_32x32x16_bf16 v[4:19], a[124:127], v[104:107], v[4:19]
    s_add_u32 s47, s41, s18
    buffer_load_dwordx4 v[56:59], v147, s[4:7], s47 offen sc1
    v_mfma_f32_32x32x16_bf16 v[20:35], a[252:255], v[104:107], v[20:35]
    v_mfma_f32_32x32x16_bf16 v[4:19], v[176:179], v[196:199], v[4:19]
    v_mfma_f32_32x32x16_bf16 v[20:35], v[180:183], v[196:199], v[20:35]
    s_nop 10
    v_mul_f32 v148, v134, v4
    v_mul_f32 v149, v134, v5
    v_mul_f32 v150, v134, v6
    v_mul_f32 v151, v134, v7
    v_fma_f32 v152, -v148, v148, s77
    v_fma_f32 v153, -v149, v149, s77
    v_fma_f32 v154, -v150, v150, s77
    v_fma_f32 v155, -v151, v151, s77
    v_mul_f32 v152, v148, v152
    v_mul_f32 v153, v149, v153
    v_mul_f32 v154, v150, v154
    v_mul_f32 v155, v151, v155
    v_exp_f32 v152, v152
    s_add_u32 s47, s42, s18
    buffer_load_dwordx4 v[60:63], v147, s[4:7], s47 offen sc1
    v_mul_f32 v148, v148, v12
    v_exp_f32 v153, v153
    v_mul_f32 v149, v149, v13
    v_exp_f32 v154, v154
    v_mul_f32 v150, v150, v14
    v_exp_f32 v155, v155
    v_mul_f32 v151, v151, v15
    v_fma_f32 v152, v152, v135, v135
    v_fma_f32 v153, v153, v135, v135
    v_fma_f32 v154, v154, v135, v135
    v_fma_f32 v155, v155, v135, v135
    v_rcp_f32 v152, v152
    v_rcp_f32 v153, v153
    s_add_u32 s47, s36, s19
    buffer_load_dwordx4 v[64:67], v147, s[4:7], s47 offen sc1
    v_rcp_f32 v154, v154
    v_rcp_f32 v155, v155
    v_mul_f32 v148, v148, v152
    v_mul_f32 v149, v149, v153
    v_mul_f32 v150, v150, v154
    v_mul_f32 v151, v151, v155
    v_cvt_pk_bf16_f32 v172, v148, v149
    v_cvt_pk_bf16_f32 v173, v150, v151
    v_and_or_b32 v172, v172, v252, s3
    v_and_or_b32 v173, v173, v252, s31
    v_mul_f32 v156, v134, v8
    v_mul_f32 v157, v134, v9
    v_mul_f32 v158, v134, v10
    s_add_u32 s47, s37, s19
    buffer_load_dwordx4 v[68:71], v147, s[4:7], s47 offen sc1
    v_mul_f32 v159, v134, v11
    v_fma_f32 v160, -v156, v156, s77
    v_fma_f32 v161, -v157, v157, s77
    v_fma_f32 v162, -v158, v158, s77
    v_fma_f32 v163, -v159, v159, s77
    v_mul_f32 v160, v156, v160
    v_mul_f32 v161, v157, v161
    v_mul_f32 v162, v158, v162
    v_mul_f32 v163, v159, v163
    v_exp_f32 v160, v160
    v_mul_f32 v156, v156, v16
    v_exp_f32 v161, v161
    v_mul_f32 v157, v157, v17
    s_add_u32 s47, s38, s19
    buffer_load_dwordx4 v[72:75], v147, s[4:7], s47 offen sc1
    v_exp_f32 v162, v162
    v_mul_f32 v158, v158, v18
    v_exp_f32 v163, v163
    v_mul_f32 v159, v159, v19
    v_fma_f32 v160, v160, v135, v135
    v_fma_f32 v161, v161, v135, v135
    v_fma_f32 v162, v162, v135, v135
    v_fma_f32 v163, v163, v135, v135
    v_rcp_f32 v160, v160
    v_rcp_f32 v161, v161
    v_rcp_f32 v162, v162
    v_rcp_f32 v163, v163
    v_mul_f32 v156, v156, v160
    s_add_u32 s47, s39, s19
    buffer_load_dwordx4 v[76:79], v147, s[4:7], s47 offen sc1
    v_mul_f32 v157, v157, v161
    v_mul_f32 v158, v158, v162
    v_mul_f32 v159, v159, v163
    v_cvt_pk_bf16_f32 v174, v156, v157
    v_cvt_pk_bf16_f32 v175, v158, v159
    s_add_u32 s101, s76, 344064
    buffer_store_dwordx4 v[172:175], v147, s[4:7], s101 offen sc1
    v_mul_f32 v148, v134, v20
    v_mul_f32 v149, v134, v21
    v_mul_f32 v150, v134, v22
    v_mul_f32 v151, v134, v23
    v_fma_f32 v152, -v148, v148, s77
    v_fma_f32 v153, -v149, v149, s77
    s_add_u32 s47, s40, s19
    buffer_load_dwordx4 v[80:83], v147, s[4:7], s47 offen sc1
    v_fma_f32 v154, -v150, v150, s77
    v_fma_f32 v155, -v151, v151, s77
    v_mul_f32 v152, v148, v152
    v_mul_f32 v153, v149, v153
    v_mul_f32 v154, v150, v154
    v_mul_f32 v155, v151, v155
    v_exp_f32 v152, v152
    v_mul_f32 v148, v148, v28
    v_exp_f32 v153, v153
    v_mul_f32 v149, v149, v29
    v_exp_f32 v154, v154
    v_mul_f32 v150, v150, v30
    v_exp_f32 v155, v155
    s_add_u32 s47, s41, s19
    buffer_load_dwordx4 v[84:87], v147, s[4:7], s47 offen sc1
    v_mul_f32 v151, v151, v31
    v_fma_f32 v152, v152, v135, v135
    v_fma_f32 v153, v153, v135, v135
    v_fma_f32 v154, v154, v135, v135
    v_fma_f32 v155, v155, v135, v135
    v_rcp_f32 v152, v152
    v_rcp_f32 v153, v153
    v_rcp_f32 v154, v154
    v_rcp_f32 v155, v155
    v_mul_f32 v148, v148, v152
    v_mul_f32 v149, v149, v153
    v_mul_f32 v150, v150, v154
    v_mul_f32 v151, v151, v155
    s_add_u32 s47, s42, s19
    buffer_load_dwordx4 v[88:91], v147, s[4:7], s47 offen sc1
    v_cvt_pk_bf16_f32 v172, v148, v149
    v_cvt_pk_bf16_f32 v173, v150, v151
    v_and_or_b32 v172, v172, v252, s3
    v_and_or_b32 v173, v173, v252, s31
    v_mul_f32 v156, v134, v24
    v_mul_f32 v157, v134, v25
    v_mul_f32 v158, v134, v26
    v_mul_f32 v159, v134, v27
    v_fma_f32 v160, -v156, v156, s77
    v_fma_f32 v161, -v157, v157, s77
    v_fma_f32 v162, -v158, v158, s77
    v_fma_f32 v163, -v159, v159, s77
    v_mul_f32 v160, v156, v160
    s_add_u32 s47, s36, s20
    buffer_load_dwordx4 v[92:95], v147, s[4:7], s47 offen sc1
    v_mul_f32 v161, v157, v161
    v_mul_f32 v162, v158, v162
    v_mul_f32 v163, v159, v163
    v_exp_f32 v160, v160
    v_mul_f32 v156, v156, v32
    v_exp_f32 v161, v161
    v_mul_f32 v157, v157, v33
    v_exp_f32 v162, v162
    v_mul_f32 v158, v158, v34
    v_exp_f32 v163, v163
    v_mul_f32 v159, v159, v35
    v_fma_f32 v160, v160, v135, v135
    v_fma_f32 v161, v161, v135, v135
    s_add_u32 s47, s37, s20
    buffer_load_dwordx4 v[96:99], v147, s[4:7], s47 offen sc1
    v_fma_f32 v162, v162, v135, v135
    v_fma_f32 v163, v163, v135, v135
    v_rcp_f32 v160, v160
    v_rcp_f32 v161, v161
    v_rcp_f32 v162, v162
    v_rcp_f32 v163, v163
    v_mul_f32 v156, v156, v160
    v_mul_f32 v157, v157, v161
    v_mul_f32 v158, v158, v162
    v_mul_f32 v159, v159, v163
    v_cvt_pk_bf16_f32 v174, v156, v157
    v_cvt_pk_bf16_f32 v175, v158, v159
    s_add_u32 s101, s76, 345088
    buffer_store_dwordx4 v[172:175], v147, s[4:7], s101 offen sc1
F_g2:
    v_mov_b32 v182, v147
    v_min_u32 v183, 27, v1
    v_lshlrev_b32 v183, 10, v183
    s_barrier
    s_waitcnt vmcnt(11)
    v_xor_b32 v189, s3, v36
    v_bitop3_b32 v189, v189, v37, s31 bitop3:0xf6
    v_bitop3_b32 v189, v189, v40, s3 bitop3:0xf6
    v_bitop3_b32 v189, v189, v41, s31 bitop3:0xf6
    v_bitop3_b32 v189, v189, v44, s3 bitop3:0xf6
    v_bitop3_b32 v189, v189, v45, s31 bitop3:0xf6
    v_bitop3_b32 v189, v189, v48, s3 bitop3:0xf6
    v_bitop3_b32 v189, v189, v49, s31 bitop3:0xf6
    v_bitop3_b32 v189, v189, v52, s3 bitop3:0xf6
    v_bitop3_b32 v189, v189, v53, s31 bitop3:0xf6
    v_bitop3_b32 v189, v189, v56, s3 bitop3:0xf6
    v_bitop3_b32 v189, v189, v57, s31 bitop3:0xf6
    v_bitop3_b32 v189, v189, v60, s3 bitop3:0xf6
    v_bitop3_b32 v189, v189, v61, s31 bitop3:0xf6
    v_and_b32 v189, 0x00010001, v189
    v_cmp_ne_u32 vcc, 0, v189
    s_nop 0
    s_cbranch_vccnz LF_hcr_51
LF_hcb_53:
    s_add_u32 s47, s38, s20
    buffer_load_dwordx4 v[100:103], v182, s[4:7], s47 offen sc1
    s_add_u32 s47, s39, s20
    buffer_load_dwordx4 v[104:107], v182, s[4:7], s47 offen sc1
    s_add_u32 s47, s40, s20
    buffer_load_dwordx4 v[108:111], v182, s[4:7], s47 offen sc1
    s_add_u32 s47, s41, s20
    buffer_load_dwordx4 v[112:115], v182, s[4:7], s47 offen sc1
    v_mfma_f32_32x32x16_bf16 v[4:19], v[200:203], v[36:39], 0
    v_mfma_f32_32x32x16_bf16 v[20:35], v[204:207], v[36:39], 0
    s_add_u32 s47, s42, s20
    buffer_load_dwordx4 v[116:119], v182, s[4:7], s47 offen sc1
    s_add_u32 s47, s36, s21
    buffer_load_dwordx4 v[120:123], v182, s[4:7], s47 offen sc1
    s_add_u32 s47, s37, s21
    buffer_load_dwordx4 v[124:127], v182, s[4:7], s47 offen sc1
    s_add_u32 s47, s38, s21
    buffer_load_dwordx4 v[128:131], v182, s[4:7], s47 offen sc1
    v_mfma_f32_32x32x16_bf16 v[4:19], v[208:211], v[40:43], v[4:19]
    v_mfma_f32_32x32x16_bf16 v[20:35], v[212:215], v[40:43], v[20:35]
    s_add_u32 s47, s39, s21
    buffer_load_dwordx4 v[132:135], v182, s[4:7], s47 offen sc1
    s_add_u32 s47, s40, s21
    buffer_load_dwordx4 v[136:139], v182, s[4:7], s47 offen sc1
    s_add_u32 s47, s41, s21
    buffer_load_dwordx4 a[92:95], v182, s[4:7], s47 offen sc1
    s_add_u32 s47, s42, s21
    buffer_load_dwordx4 a[96:99], v182, s[4:7], s47 offen sc1
    s_mov_b32 m0, s83
    s_nop 0
    buffer_load_dwordx4 v182, s[4:7], s82 offen sc1 lds
    buffer_load_dwordx4 v182, s[4:7], s82 offen offset:1024 sc1 lds
    v_lshrrev_b32 v185, 5, v1
    v_lshlrev_b32 v250, 5, v185
    v_lshlrev_b32 v185, 6, v185
    s_lshl_b32 s84, s100, 8
    s_lshl_b32 s44, s70, 4
    s_add_u32 s84, s84, s44
    s_add_u32 s84, s84, 131072
    buffer_load_dwordx4 v[140:143], v185, s[4:7], s84 offen offset:0 sc1
    buffer_load_dwordx4 v[144:147], v185, s[4:7], s84 offen offset:128 sc1
    buffer_load_dword v184, v183, s[4:7], s87 offen sc1
    v_mfma_f32_32x32x16_bf16 v[4:19], v[216:219], v[44:47], v[4:19]
    v_mfma_f32_32x32x16_bf16 v[20:35], v[220:223], v[44:47], v[20:35]
    v_mfma_f32_32x32x16_bf16 v[4:19], v[224:227], v[48:51], v[4:19]
    v_mfma_f32_32x32x16_bf16 v[20:35], v[228:231], v[48:51], v[20:35]
    v_mfma_f32_32x32x16_bf16 v[4:19], v[232:235], v[52:55], v[4:19]
    s_waitcnt vmcnt(20)
    v_xor_b32 v189, s3, v64
    v_bitop3_b32 v189, v189, v65, s31 bitop3:0xf6
    v_bitop3_b32 v189, v189, v68, s3 bitop3:0xf6
    v_bitop3_b32 v189, v189, v69, s31 bitop3:0xf6
    v_bitop3_b32 v189, v189, v72, s3 bitop3:0xf6
    v_bitop3_b32 v189, v189, v73, s31 bitop3:0xf6
    v_mfma_f32_32x32x16_bf16 v[20:35], v[236:239], v[52:55], v[20:35]
    v_bitop3_b32 v189, v189, v76, s3 bitop3:0xf6
    v_bitop3_b32 v189, v189, v77, s31 bitop3:0xf6
    v_bitop3_b32 v189, v189, v80, s3 bitop3:0xf6
    v_bitop3_b32 v189, v189, v81, s31 bitop3:0xf6
    v_bitop3_b32 v189, v189, v84, s3 bitop3:0xf6
    v_bitop3_b32 v189, v189, v85, s31 bitop3:0xf6
    v_mfma_f32_32x32x16_bf16 v[4:19], a[0:3], v[56:59], v[4:19]
    v_bitop3_b32 v189, v189, v88, s3 bitop3:0xf6
    v_bitop3_b32 v189, v189, v89, s31 bitop3:0xf6
    v_and_b32 v189, 0x00010001, v189
    v_cmp_ne_u32 vcc, 0, v189
    s_nop 0
    s_cbranch_vccnz LF_hcr_54
LF_hcb_56:
    v_mfma_f32_32x32x16_bf16 v[20:35], a[128:131], v[56:59], v[20:35]
    v_mfma_f32_32x32x16_bf16 v[4:19], a[4:7], v[60:63], v[4:19]
    v_mfma_f32_32x32x16_bf16 v[20:35], a[132:135], v[60:63], v[20:35]
    v_mfma_f32_32x32x16_bf16 v[4:19], a[8:11], v[64:67], v[4:19]
    v_mfma_f32_32x32x16_bf16 v[20:35], a[136:139], v[64:67], v[20:35]
    s_waitcnt vmcnt(0)
    v_xor_b32 v184, s3, v184
    v_and_b32 v184, 0x00010001, v184
    v_cmp_ne_u32 vcc, 0, v184
    s_nop 0
    s_cbranch_vccnz LF_g2slow_57
    s_add_u32 s47, s36, s22
    buffer_load_dwordx4 a[100:103], v182, s[4:7], s47 offen sc1
    v_mfma_f32_32x32x16_bf16 v[4:19], a[12:15], v[68:71], v[4:19]
    v_xor_b32 v189, s3, v92
    v_bitop3_b32 v189, v189, v93, s31 bitop3:0xf6
    v_bitop3_b32 v189, v189, v96, s3 bitop3:0xf6
    v_bitop3_b32 v189, v189, v97, s31 bitop3:0xf6
    v_bitop3_b32 v189, v189, v100, s3 bitop3:0xf6
    v_bitop3_b32 v189, v189, v101, s31 bitop3:0xf6
    v_mfma_f32_32x32x16_bf16 v[20:35], a[140:143], v[68:71], v[20:35]
    s_add_u32 s47, s37, s22
    buffer_load_dwordx4 a[104:107], v182, s[4:7], s47 offen sc1
    v_bitop3_b32 v189, v189, v104, s3 bitop3:0xf6
    v_bitop3_b32 v189, v189, v105, s31 bitop3:0xf6
    v_bitop3_b32 v189, v189, v108, s3 bitop3:0xf6
    v_mfma_f32_32x32x16_bf16 v[4:19], a[16:19], v[72:75], v[4:19]
    v_bitop3_b32 v189, v189, v109, s31 bitop3:0xf6
    v_bitop3_b32 v189, v189, v112, s3 bitop3:0xf6
    v_bitop3_b32 v189, v189, v113, s31 bitop3:0xf6
    v_bitop3_b32 v189, v189, v116, s3 bitop3:0xf6
    v_bitop3_b32 v189, v189, v117, s31 bitop3:0xf6
    v_and_b32 v189, 0x00010001, v189
    v_mfma_f32_32x32x16_bf16 v[20:35], a[144:147], v[72:75], v[20:35]
    s_add_u32 s47, s38, s22
    buffer_load_dwordx4 a[108:111], v182, s[4:7], s47 offen sc1
    v_cmp_ne_u32 vcc, 0, v189
    s_nop 0
    s_cbranch_vccnz LF_hcr_59
LF_hcb_61:
    v_mfma_f32_32x32x16_bf16 v[4:19], a[20:23], v[76:79], v[4:19]
    v_mfma_f32_32x32x16_bf16 v[20:35], a[148:151], v[76:79], v[20:35]
    s_add_u32 s47, s39, s22
    buffer_load_dwordx4 a[112:115], v182, s[4:7], s47 offen sc1
    v_mfma_f32_32x32x16_bf16 v[4:19], a[24:27], v[80:83], v[4:19]
    v_mfma_f32_32x32x16_bf16 v[20:35], a[152:155], v[80:83], v[20:35]
    s_add_u32 s47, s40, s22
    buffer_load_dwordx4 a[116:119], v182, s[4:7], s47 offen sc1
    ds_read_b64_tr_b16 a[32:33], v246 offset:6144
    ds_read_b64_tr_b16 a[34:35], v246 offset:6656
    ds_read_b64_tr_b16 a[160:161], v247 offset:6144
    ds_read_b64_tr_b16 a[162:163], v247 offset:6656
    v_mfma_f32_32x32x16_bf16 v[4:19], a[28:31], v[84:87], v[4:19]
    v_mfma_f32_32x32x16_bf16 v[20:35], a[156:159], v[84:87], v[20:35]
    s_waitcnt lgkmcnt(0)
    s_add_u32 s47, s41, s22
    buffer_load_dwordx4 a[120:123], v182, s[4:7], s47 offen sc1
    ds_read_b64_tr_b16 a[36:37], v246 offset:32768
    ds_read_b64_tr_b16 a[38:39], v246 offset:33280
    ds_read_b64_tr_b16 a[164:165], v247 offset:32768
    ds_read_b64_tr_b16 a[166:167], v247 offset:33280
    v_mfma_f32_32x32x16_bf16 v[4:19], a[32:35], v[88:91], v[4:19]
    v_mfma_f32_32x32x16_bf16 v[20:35], a[160:163], v[88:91], v[20:35]
    s_add_u32 s47, s42, s22
    buffer_load_dwordx4 a[124:127], v182, s[4:7], s47 offen sc1
    ds_read_b64_tr_b16 a[40:41], v246 offset:34816
    ds_read_b64_tr_b16 a[42:43], v246 offset:35328
    ds_read_b64_tr_b16 a[168:169], v247 offset:34816
    ds_read_b64_tr_b16 a[170:171], v247 offset:35328
    s_waitcnt lgkmcnt(4)
    v_mfma_f32_32x32x16_bf16 v[4:19], a[36:39], v[92:95], v[4:19]
    v_mfma_f32_32x32x16_bf16 v[20:35], a[164:167], v[92:95], v[20:35]
    s_add_u32 s47, s36, s23
    buffer_load_dwordx4 a[220:223], v182, s[4:7], s47 offen sc1
    ds_read_b64_tr_b16 a[44:45], v244 offset:32768
    ds_read_b64_tr_b16 a[46:47], v244 offset:33280
    ds_read_b64_tr_b16 a[172:173], v245 offset:32768
    ds_read_b64_tr_b16 a[174:175], v245 offset:33280
    s_waitcnt lgkmcnt(4)
    v_mfma_f32_32x32x16_bf16 v[4:19], a[40:43], v[96:99], v[4:19]
    v_mfma_f32_32x32x16_bf16 v[20:35], a[168:171], v[96:99], v[20:35]
    s_add_u32 s47, s37, s23
    buffer_load_dwordx4 a[224:227], v182, s[4:7], s47 offen sc1
    ds_read_b64_tr_b16 a[48:49], v244 offset:34816
    ds_read_b64_tr_b16 a[50:51], v244 offset:35328
    ds_read_b64_tr_b16 a[176:177], v245 offset:34816
    ds_read_b64_tr_b16 a[178:179], v245 offset:35328
    s_waitcnt lgkmcnt(4)
    v_mfma_f32_32x32x16_bf16 v[4:19], a[44:47], v[100:103], v[4:19]
    v_mfma_f32_32x32x16_bf16 v[20:35], a[172:175], v[100:103], v[20:35]
    s_add_u32 s47, s38, s23
    buffer_load_dwordx4 a[228:231], v182, s[4:7], s47 offen sc1
    ds_read_b64_tr_b16 a[52:53], v244 offset:36864
    ds_read_b64_tr_b16 a[54:55], v244 offset:37376
    ds_read_b64_tr_b16 a[180:181], v245 offset:36864
    ds_read_b64_tr_b16 a[182:183], v245 offset:37376
    s_waitcnt lgkmcnt(4)
    v_mfma_f32_32x32x16_bf16 v[4:19], a[48:51], v[104:107], v[4:19]
    v_mfma_f32_32x32x16_bf16 v[20:35], a[176:179], v[104:107], v[20:35]
    s_add_u32 s47, s39, s23
    buffer_load_dwordx4 a[232:235], v182, s[4:7], s47 offen sc1
    ds_read_b64_tr_b16 a[56:57], v244 offset:38912
    ds_read_b64_tr_b16 a[58:59], v244 offset:39424
    ds_read_b64_tr_b16 a[184:185], v245 offset:38912
    ds_read_b64_tr_b16 a[186:187], v245 offset:39424
    s_waitcnt lgkmcnt(4)
    v_mfma_f32_32x32x16_bf16 v[4:19], a[52:55], v[108:111], v[4:19]
    v_xor_b32 v189, s3, v120
    v_bitop3_b32 v189, v189, v121, s31 bitop3:0xf6
    v_bitop3_b32 v189, v189, v124, s3 bitop3:0xf6
    v_bitop3_b32 v189, v189, v125, s31 bitop3:0xf6
    v_bitop3_b32 v189, v189, v128, s3 bitop3:0xf6
    v_bitop3_b32 v189, v189, v129, s31 bitop3:0xf6
    v_mfma_f32_32x32x16_bf16 v[20:35], a[180:183], v[108:111], v[20:35]
    s_waitcnt lgkmcnt(0)
    s_add_u32 s47, s40, s23
    buffer_load_dwordx4 a[236:239], v182, s[4:7], s47 offen sc1
    ds_read_b64_tr_b16 a[60:61], v246 offset:36864
    ds_read_b64_tr_b16 a[62:63], v246 offset:37376
    ds_read_b64_tr_b16 a[188:189], v247 offset:36864
    ds_read_b64_tr_b16 a[190:191], v247 offset:37376
    v_mfma_f32_32x32x16_bf16 v[4:19], a[56:59], v[112:115], v[4:19]
    v_bitop3_b32 v189, v189, v132, s3 bitop3:0xf6
    v_bitop3_b32 v189, v189, v133, s31 bitop3:0xf6
    v_bitop3_b32 v189, v189, v136, s3 bitop3:0xf6
    v_bitop3_b32 v189, v189, v137, s31 bitop3:0xf6
    v_accvgpr_read_b32 v190, a92
    v_accvgpr_read_b32 v191, a93
    v_mfma_f32_32x32x16_bf16 v[20:35], a[184:187], v[112:115], v[20:35]
    s_waitcnt lgkmcnt(0)
    s_add_u32 s47, s41, s23
    buffer_load_dwordx4 a[240:243], v182, s[4:7], s47 offen sc1
    ds_read_b64_tr_b16 a[64:65], v246 offset:38912
    ds_read_b64_tr_b16 a[66:67], v246 offset:39424
    ds_read_b64_tr_b16 a[192:193], v247 offset:38912
    ds_read_b64_tr_b16 a[194:195], v247 offset:39424
    v_mfma_f32_32x32x16_bf16 v[4:19], a[60:63], v[116:119], v[4:19]
    v_bitop3_b32 v189, v189, v190, s3 bitop3:0xf6
    v_bitop3_b32 v189, v189, v191, s31 bitop3:0xf6
    v_accvgpr_read_b32 v190, a96
    v_accvgpr_read_b32 v191, a97
    v_bitop3_b32 v189, v189, v190, s3 bitop3:0xf6
    v_bitop3_b32 v189, v189, v191, s31 bitop3:0xf6
    v_mfma_f32_32x32x16_bf16 v[20:35], a[188:191], v[116:119], v[20:35]
    v_and_b32 v189, 0x00010001, v189
    v_cmp_ne_u32 vcc, 0, v189
    s_nop 0
    s_cbranch_vccnz LF_hcr_62
LF_hcb_64:
    s_add_u32 s47, s42, s23
    buffer_load_dwordx4 a[244:247], v182, s[4:7], s47 offen sc1
    ds_read_b64_tr_b16 a[68:69], v242 offset:0
    ds_read_b64_tr_b16 a[70:71], v242 offset:512
    ds_read_b64_tr_b16 a[196:197], v243 offset:0
    ds_read_b64_tr_b16 a[198:199], v243 offset:512
    s_waitcnt lgkmcnt(4)
    v_mfma_f32_32x32x16_bf16 v[4:19], a[64:67], v[120:123], v[4:19]
    v_mfma_f32_32x32x16_bf16 v[20:35], a[192:195], v[120:123], v[20:35]
    s_add_u32 s47, s36, s24
    buffer_load_dwordx4 a[248:251], v182, s[4:7], s47 offen sc1
    ds_read_b64_tr_b16 a[72:73], v242 offset:2048
    ds_read_b64_tr_b16 a[74:75], v242 offset:2560
    ds_read_b64_tr_b16 a[200:201], v243 offset:2048
    ds_read_b64_tr_b16 a[202:203], v243 offset:2560
    s_waitcnt lgkmcnt(4)
    v_mfma_f32_32x32x16_bf16 v[4:19], a[68:71], v[124:127], v[4:19]
    v_mfma_f32_32x32x16_bf16 v[20:35], a[196:199], v[124:127], v[20:35]
    s_add_u32 s47, s37, s24
    buffer_load_dwordx4 a[252:255], v182, s[4:7], s47 offen sc1
    ds_read_b64_tr_b16 a[76:77], v242 offset:4096
    ds_read_b64_tr_b16 a[78:79], v242 offset:4608
    ds_read_b64_tr_b16 a[204:205], v243 offset:4096
    ds_read_b64_tr_b16 a[206:207], v243 offset:4608
    s_waitcnt lgkmcnt(4)
    v_mfma_f32_32x32x16_bf16 v[4:19], a[72:75], v[128:131], v[4:19]
    v_mfma_f32_32x32x16_bf16 v[20:35], a[200:203], v[128:131], v[20:35]
    s_add_u32 s47, s38, s24
    buffer_load_dwordx4 v[68:71], v182, s[4:7], s47 offen sc1
    ds_read_b64_tr_b16 a[80:81], v246 offset:0
    ds_read_b64_tr_b16 a[82:83], v246 offset:512
    ds_read_b64_tr_b16 a[208:209], v247 offset:0
    ds_read_b64_tr_b16 a[210:211], v247 offset:512
    s_waitcnt lgkmcnt(4)
    v_mfma_f32_32x32x16_bf16 v[4:19], a[76:79], v[132:135], v[4:19]
    v_mfma_f32_32x32x16_bf16 v[20:35], a[204:207], v[132:135], v[20:35]
    s_add_u32 s47, s39, s24
    buffer_load_dwordx4 v[72:75], v182, s[4:7], s47 offen sc1
    ds_read_b64_tr_b16 a[84:85], v246 offset:2048
    ds_read_b64_tr_b16 a[86:87], v246 offset:2560
    ds_read_b64_tr_b16 a[212:213], v247 offset:2048
    ds_read_b64_tr_b16 a[214:215], v247 offset:2560
    s_waitcnt lgkmcnt(4)
    v_mfma_f32_32x32x16_bf16 v[4:19], a[80:83], v[136:139], v[4:19]
    s_waitcnt vmcnt(11)
    v_accvgpr_read_b32 v190, a100
    v_accvgpr_read_b32 v191, a101
    v_xor_b32 v189, s3, v190
    v_bitop3_b32 v189, v189, v191, s31 bitop3:0xf6
    v_accvgpr_read_b32 v190, a104
    v_accvgpr_read_b32 v191, a105
    v_mfma_f32_32x32x16_bf16 v[20:35], a[208:211], v[136:139], v[20:35]
    s_waitcnt lgkmcnt(0)
    s_add_u32 s47, s40, s24
    buffer_load_dwordx4 v[76:79], v182, s[4:7], s47 offen sc1
    ds_read_b64_tr_b16 a[88:89], v246 offset:4096
    ds_read_b64_tr_b16 a[90:91], v246 offset:4608
    ds_read_b64_tr_b16 a[216:217], v247 offset:4096
    ds_read_b64_tr_b16 a[218:219], v247 offset:4608
    v_mfma_f32_32x32x16_bf16 v[4:19], a[84:87], a[92:95], v[4:19]
    v_bitop3_b32 v189, v189, v190, s3 bitop3:0xf6
    v_bitop3_b32 v189, v189, v191, s31 bitop3:0xf6
    v_accvgpr_read_b32 v190, a108
    v_accvgpr_read_b32 v191, a109
    v_bitop3_b32 v189, v189, v190, s3 bitop3:0xf6
    v_bitop3_b32 v189, v189, v191, s31 bitop3:0xf6
    v_mfma_f32_32x32x16_bf16 v[20:35], a[212:215], a[92:95], v[20:35]
    s_waitcnt lgkmcnt(0)
    s_add_u32 s47, s41, s24
    buffer_load_dwordx4 v[80:83], v182, s[4:7], s47 offen sc1
    v_accvgpr_read_b32 v190, a112
    v_accvgpr_read_b32 v191, a113
    v_bitop3_b32 v189, v189, v190, s3 bitop3:0xf6
    v_mfma_f32_32x32x16_bf16 v[4:19], a[88:91], a[96:99], v[4:19]
    v_bitop3_b32 v189, v189, v191, s31 bitop3:0xf6
    v_accvgpr_read_b32 v190, a116
    v_accvgpr_read_b32 v191, a117
    v_bitop3_b32 v189, v189, v190, s3 bitop3:0xf6
    v_bitop3_b32 v189, v189, v191, s31 bitop3:0xf6
    v_accvgpr_read_b32 v190, a120
    v_mfma_f32_32x32x16_bf16 v[20:35], a[216:219], a[96:99], v[20:35]
    v_accvgpr_read_b32 v191, a121
    v_bitop3_b32 v189, v189, v190, s3 bitop3:0xf6
    v_bitop3_b32 v189, v189, v191, s31 bitop3:0xf6
    v_accvgpr_read_b32 v190, a124
    v_accvgpr_read_b32 v191, a125
    v_bitop3_b32 v189, v189, v190, s3 bitop3:0xf6
    v_bitop3_b32 v189, v189, v191, s31 bitop3:0xf6
    v_and_b32 v189, 0x00010001, v189
    v_cmp_ne_u32 vcc, 0, v189
    s_nop 0
    s_cbranch_vccnz LF_hcr_65
LF_hcb_67:
LF_g2j_58:
    s_add_u32 s47, s42, s24
    buffer_load_dwordx4 v[84:87], v182, s[4:7], s47 offen sc1
    v_mfma_f32_32x32x16_bf16 v[36:51], v[200:203], a[100:103], 0
    v_add_u32 v186, s91, v182
    v_add_u32 v187, 0x10000, v186
    s_sub_u32 s44, s70, 1
    s_and_b32 s44, s44, 3
    s_lshl_b32 s44, s44, 13
    v_add_u32 v192, s44, v182
    v_mfma_f32_32x32x16_bf16 v[52:67], v[204:207], a[100:103], 0
    s_add_u32 s47, s36, s25
    buffer_load_dwordx4 v[88:91], v182, s[4:7], s47 offen sc1
    s_sub_u32 s44, s70, 2
    s_and_b32 s44, s44, 3
    s_lshl_b32 s44, s44, 13
    v_add_u32 v193, s44, v182
    v_mfma_f32_32x32x16_bf16 v[36:51], v[208:211], a[104:107], v[36:51]
    s_sub_u32 s44, s70, 3
    s_and_b32 s44, s44, 3
    s_lshl_b32 s44, s44, 13
    v_add_u32 v194, s44, v182
    v_lshrrev_b32 v248, 5, v1
    v_lshlrev_b32 v248, 10, v248
    v_bfe_u32 v249, v1, 2, 2
    v_mfma_f32_32x32x16_bf16 v[52:67], v[212:215], a[104:107], v[52:67]
    s_add_u32 s47, s37, s25
    buffer_load_dwordx4 v[92:95], v182, s[4:7], s47 offen sc1
    v_lshl_add_u32 v248, v249, 6, v248
    v_bfe_u32 v249, v1, 4, 1
    v_lshl_add_u32 v248, v249, 5, v248
    v_and_b32 v249, 3, v1
    v_mfma_f32_32x32x16_bf16 v[36:51], v[216:219], a[108:111], v[36:51]
    v_lshl_add_u32 v248, v249, 3, v248
    s_lshl_b32 s44, s70, 8
    s_add_u32 s44, s44, 155648
    v_add_u32 v248, s44, v248
    v_and_b32 v249, 31, v1
    v_lshl_add_u32 v249, v249, 10, v250
    v_mfma_f32_32x32x16_bf16 v[52:67], v[220:223], a[108:111], v[52:67]
    s_add_u32 s47, s38, s25
    buffer_load_dwordx4 v[96:99], v182, s[4:7], s47 offen sc1
    s_lshl_b32 s74, s100, 7
    s_lshl_b32 s44, s70, 3
    s_add_u32 s74, s74, s44
    v_mfma_f32_32x32x16_bf16 v[36:51], v[224:227], a[112:115], v[36:51]
    s_lshl_b32 s44, s99, 15
    s_add_u32 s75, s74, s44
    s_lshl_b32 s44, s98, 15
    s_add_u32 s74, s74, s44
    v_mfma_f32_32x32x16_bf16 v[52:67], v[228:231], a[112:115], v[52:67]
    ds_write_b128 v186, v[8:11] offset:1024
    s_add_u32 s47, s39, s25
    buffer_load_dwordx4 v[100:103], v182, s[4:7], s47 offen sc1
    v_mfma_f32_32x32x16_bf16 v[36:51], v[232:235], a[116:119], v[36:51]
    s_waitcnt vmcnt(11)
    v_accvgpr_read_b32 v190, a220
    v_accvgpr_read_b32 v191, a221
    v_xor_b32 v189, s3, v190
    v_bitop3_b32 v189, v189, v191, s31 bitop3:0xf6
    v_accvgpr_read_b32 v190, a224
    v_accvgpr_read_b32 v191, a225
    v_mfma_f32_32x32x16_bf16 v[52:67], v[236:239], a[116:119], v[52:67]
    s_add_u32 s47, s40, s25
    buffer_load_dwordx4 v[104:107], v182, s[4:7], s47 offen sc1
    v_bitop3_b32 v189, v189, v190, s3 bitop3:0xf6
    v_bitop3_b32 v189, v189, v191, s31 bitop3:0xf6
    v_accvgpr_read_b32 v190, a228
    v_accvgpr_read_b32 v191, a229
    v_mfma_f32_32x32x16_bf16 v[36:51], a[0:3], a[120:123], v[36:51]
    v_bitop3_b32 v189, v189, v190, s3 bitop3:0xf6
    v_bitop3_b32 v189, v189, v191, s31 bitop3:0xf6
    v_accvgpr_read_b32 v190, a232
    v_accvgpr_read_b32 v191, a233
    v_bitop3_b32 v189, v189, v190, s3 bitop3:0xf6
    v_bitop3_b32 v189, v189, v191, s31 bitop3:0xf6
    v_mfma_f32_32x32x16_bf16 v[52:67], a[128:131], a[120:123], v[52:67]
    s_add_u32 s47, s41, s25
    buffer_load_dwordx4 v[108:111], v182, s[4:7], s47 offen sc1
    v_accvgpr_read_b32 v190, a236
    v_accvgpr_read_b32 v191, a237
    v_bitop3_b32 v189, v189, v190, s3 bitop3:0xf6
    v_bitop3_b32 v189, v189, v191, s31 bitop3:0xf6
    v_mfma_f32_32x32x16_bf16 v[36:51], a[4:7], a[124:127], v[36:51]
    v_accvgpr_read_b32 v190, a240
    v_accvgpr_read_b32 v191, a241
    v_bitop3_b32 v189, v189, v190, s3 bitop3:0xf6
    v_bitop3_b32 v189, v189, v191, s31 bitop3:0xf6
    v_accvgpr_read_b32 v190, a244
    v_accvgpr_read_b32 v191, a245
    v_mfma_f32_32x32x16_bf16 v[52:67], a[132:135], a[124:127], v[52:67]
    v_bitop3_b32 v189, v189, v190, s3 bitop3:0xf6
    v_bitop3_b32 v189, v189, v191, s31 bitop3:0xf6
    v_and_b32 v189, 0x00010001, v189
    v_cmp_ne_u32 vcc, 0, v189
    s_nop 0
    s_cbranch_vccnz LF_hcr_82
LF_hcb_84:
    s_add_u32 s47, s42, s25
    buffer_load_dwordx4 v[112:115], v182, s[4:7], s47 offen sc1
    v_mfma_f32_32x32x16_bf16 v[36:51], a[8:11], a[220:223], v[36:51]
    ds_write_b128 v186, v[12:15] offset:2048
    v_mfma_f32_32x32x16_bf16 v[52:67], a[136:139], a[220:223], v[52:67]
    ds_write_b128 v186, v[16:19] offset:3072
    v_mfma_f32_32x32x16_bf16 v[36:51], a[12:15], a[224:227], v[36:51]
    ds_write_b128 v186, v[24:27] offset:33792
    v_mfma_f32_32x32x16_bf16 v[52:67], a[140:143], a[224:227], v[52:67]
    ds_write_b128 v186, v[28:31] offset:34816
    v_mfma_f32_32x32x16_bf16 v[36:51], a[16:19], a[228:231], v[36:51]
    ds_write_b128 v186, v[32:35] offset:35840
    v_mfma_f32_32x32x16_bf16 v[52:67], a[144:147], a[228:231], v[52:67]
    v_add_u32 v195, s83, v182
    v_mfma_f32_32x32x16_bf16 v[36:51], a[20:23], a[232:235], v[36:51]
    ds_read_b128 v[160:163], v195 offset:0
    ds_read_b128 v[164:167], v195 offset:1024
    s_waitcnt lgkmcnt(0)
    v_bitop3_b32 v160, v160, v162, s3 bitop3:0x7e
    v_bitop3_b32 v161, v161, v163, s31 bitop3:0x7e
    v_bitop3_b32 v164, v164, v166, s3 bitop3:0x7e
    v_mfma_f32_32x32x16_bf16 v[52:67], a[148:151], a[232:235], v[52:67]
    v_bitop3_b32 v165, v165, v167, s31 bitop3:0x7e
    v_or3_b32 v160, v160, v161, v164
    v_or_b32 v160, v160, v165
    v_and_b32 v160, 0x00010001, v160
    v_cmp_ne_u32 vcc, 0, v160
    v_mfma_f32_32x32x16_bf16 v[36:51], a[24:27], a[236:239], v[36:51]
    s_waitcnt vmcnt(7)
    v_accvgpr_read_b32 v190, a248
    v_accvgpr_read_b32 v191, a249
    v_xor_b32 v189, s3, v190
    v_bitop3_b32 v189, v189, v191, s31 bitop3:0xf6
    v_accvgpr_read_b32 v190, a252
    v_accvgpr_read_b32 v191, a253
    v_mfma_f32_32x32x16_bf16 v[52:67], a[152:155], a[236:239], v[52:67]
    v_bitop3_b32 v189, v189, v190, s3 bitop3:0xf6
    v_bitop3_b32 v189, v189, v191, s31 bitop3:0xf6
    v_bitop3_b32 v189, v189, v68, s3 bitop3:0xf6
    v_bitop3_b32 v189, v189, v69, s31 bitop3:0xf6
    v_bitop3_b32 v189, v189, v72, s3 bitop3:0xf6
    v_bitop3_b32 v189, v189, v73, s31 bitop3:0xf6
    v_mfma_f32_32x32x16_bf16 v[36:51], a[28:31], a[240:243], v[36:51]
    v_bitop3_b32 v189, v189, v76, s3 bitop3:0xf6
    v_bitop3_b32 v189, v189, v77, s31 bitop3:0xf6
    v_bitop3_b32 v189, v189, v80, s3 bitop3:0xf6
    v_bitop3_b32 v189, v189, v81, s31 bitop3:0xf6
    v_bitop3_b32 v189, v189, v84, s3 bitop3:0xf6
    v_bitop3_b32 v189, v189, v85, s31 bitop3:0xf6
    v_mfma_f32_32x32x16_bf16 v[52:67], a[156:159], a[240:243], v[52:67]
    v_and_b32 v189, 0x00010001, v189
    v_cmp_ne_u32 vcc, 0, v189
    s_nop 0
    s_cbranch_vccnz LF_hcr_85
LF_hcb_87:
    s_cbranch_vccnz LF_rsr_79
LF_rsb_81:
    v_mfma_f32_32x32x16_bf16 v[36:51], a[32:35], a[244:247], v[36:51]
    s_barrier
    ds_read_b64_tr_b16 v[148:149], v248 offset:0
    ds_read_b64_tr_b16 v[150:151], v248 offset:2048
    ds_read_b64_tr_b16 v[152:153], v248 offset:4096
    ds_read_b64_tr_b16 v[154:155], v248 offset:6144
    s_waitcnt lgkmcnt(0)
    ds_read_b128 v[160:163], v192 offset:1024
    v_mfma_f32_32x32x16_bf16 v[52:67], a[160:163], a[244:247], v[52:67]
    ds_read_b128 v[164:167], v193 offset:2048
    ds_read_b128 v[168:171], v194 offset:3072
    ds_read_b128 v[172:175], v192 offset:33792
    ds_read_b128 v[176:179], v193 offset:34816
    ds_read_b128 v[180:183], v194 offset:35840
    v_lshlrev_b32 v156, 16, v148
    v_mfma_f32_32x32x16_bf16 v[36:51], a[36:39], a[248:251], v[36:51]
    v_and_b32 v157, 0xffff0000, v148
    v_lshlrev_b32 v158, 16, v149
    v_and_b32 v159, 0xffff0000, v149
    s_waitcnt lgkmcnt(3)
    v_add_f32 v4, v4, v160
    v_add_f32 v164, v164, v168
    v_mfma_f32_32x32x16_bf16 v[52:67], a[164:167], a[248:251], v[52:67]
    v_add_f32 v5, v5, v161
    v_add_f32 v165, v165, v169
    v_add_f32 v6, v6, v162
    v_add_f32 v166, v166, v170
    v_add_f32 v7, v7, v163
    v_add_f32 v167, v167, v171
    v_mfma_f32_32x32x16_bf16 v[36:51], a[40:43], a[252:255], v[36:51]
    v_add_f32 v4, v4, v164
    v_add_f32 v5, v5, v165
    v_add_f32 v6, v6, v166
    v_add_f32 v7, v7, v167
    v_fma_f32 v4, v4, v140, v156
    v_fma_f32 v5, v5, v141, v157
    v_mfma_f32_32x32x16_bf16 v[52:67], a[168:171], a[252:255], v[52:67]
    v_fma_f32 v6, v6, v142, v158
    v_fma_f32 v7, v7, v143, v159
    v_cvt_pk_bf16_f32 v8, v4, v5
    v_cvt_pk_bf16_f32 v9, v6, v7
    v_lshlrev_b32 v156, 16, v150
    v_and_b32 v157, 0xffff0000, v150
    v_mfma_f32_32x32x16_bf16 v[36:51], a[44:47], v[68:71], v[36:51]
    buffer_store_dwordx2 v[8:9], v249, s[64:67], s74 offen offset:0
    v_lshlrev_b32 v158, 16, v151
    v_and_b32 v159, 0xffff0000, v151
    s_waitcnt lgkmcnt(0)
    v_add_f32 v20, v20, v172
    v_mfma_f32_32x32x16_bf16 v[52:67], a[172:175], v[68:71], v[52:67]
    v_add_f32 v176, v176, v180
    v_add_f32 v21, v21, v173
    v_add_f32 v177, v177, v181
    v_add_f32 v22, v22, v174
    v_add_f32 v178, v178, v182
    v_add_f32 v23, v23, v175
    v_mfma_f32_32x32x16_bf16 v[36:51], a[48:51], v[72:75], v[36:51]
    v_add_f32 v179, v179, v183
    v_add_f32 v20, v20, v176
    v_add_f32 v21, v21, v177
    v_add_f32 v22, v22, v178
    v_add_f32 v23, v23, v179
    v_fma_f32 v20, v20, v144, v156
    v_mfma_f32_32x32x16_bf16 v[52:67], a[176:179], v[72:75], v[52:67]
    v_fma_f32 v21, v21, v145, v157
    v_fma_f32 v22, v22, v146, v158
    v_fma_f32 v23, v23, v147, v159
    v_cvt_pk_bf16_f32 v24, v20, v21
    v_cvt_pk_bf16_f32 v25, v22, v23
    v_mfma_f32_32x32x16_bf16 v[36:51], a[52:55], v[76:79], v[36:51]
    s_waitcnt vmcnt(1)
    v_xor_b32 v189, s3, v88
    v_bitop3_b32 v189, v189, v89, s31 bitop3:0xf6
    v_bitop3_b32 v189, v189, v92, s3 bitop3:0xf6
    v_bitop3_b32 v189, v189, v93, s31 bitop3:0xf6
    v_bitop3_b32 v189, v189, v96, s3 bitop3:0xf6
    v_bitop3_b32 v189, v189, v97, s31 bitop3:0xf6
    v_mfma_f32_32x32x16_bf16 v[52:67], a[180:183], v[76:79], v[52:67]
    v_bitop3_b32 v189, v189, v100, s3 bitop3:0xf6
    v_bitop3_b32 v189, v189, v101, s31 bitop3:0xf6
    v_bitop3_b32 v189, v189, v104, s3 bitop3:0xf6
    v_bitop3_b32 v189, v189, v105, s31 bitop3:0xf6
    v_bitop3_b32 v189, v189, v108, s3 bitop3:0xf6
    v_bitop3_b32 v189, v189, v109, s31 bitop3:0xf6
    v_mfma_f32_32x32x16_bf16 v[36:51], a[56:59], v[80:83], v[36:51]
    v_bitop3_b32 v189, v189, v112, s3 bitop3:0xf6
    v_bitop3_b32 v189, v189, v113, s31 bitop3:0xf6
    v_and_b32 v189, 0x00010001, v189
    v_cmp_ne_u32 vcc, 0, v189
    s_nop 0
    s_cbranch_vccnz LF_hcr_88
LF_hcb_90:
    v_mfma_f32_32x32x16_bf16 v[52:67], a[184:187], v[80:83], v[52:67]
    buffer_store_dwordx2 v[24:25], v249, s[64:67], s74 offen offset:64
    v_mfma_f32_32x32x16_bf16 v[36:51], a[60:63], v[84:87], v[36:51]
    v_mfma_f32_32x32x16_bf16 v[52:67], a[188:191], v[84:87], v[52:67]
    v_mfma_f32_32x32x16_bf16 v[36:51], a[64:67], v[88:91], v[36:51]
    v_mfma_f32_32x32x16_bf16 v[52:67], a[192:195], v[88:91], v[52:67]
    v_mfma_f32_32x32x16_bf16 v[36:51], a[68:71], v[92:95], v[36:51]
    v_mfma_f32_32x32x16_bf16 v[52:67], a[196:199], v[92:95], v[52:67]
    v_mfma_f32_32x32x16_bf16 v[36:51], a[72:75], v[96:99], v[36:51]
    v_mfma_f32_32x32x16_bf16 v[52:67], a[200:203], v[96:99], v[52:67]
    v_mfma_f32_32x32x16_bf16 v[36:51], a[76:79], v[100:103], v[36:51]
    v_mfma_f32_32x32x16_bf16 v[52:67], a[204:207], v[100:103], v[52:67]
    v_mfma_f32_32x32x16_bf16 v[36:51], a[80:83], v[104:107], v[36:51]
    v_mfma_f32_32x32x16_bf16 v[52:67], a[208:211], v[104:107], v[52:67]
    v_mfma_f32_32x32x16_bf16 v[36:51], a[84:87], v[108:111], v[36:51]
    v_mfma_f32_32x32x16_bf16 v[52:67], a[212:215], v[108:111], v[52:67]
    v_mfma_f32_32x32x16_bf16 v[36:51], a[88:91], v[112:115], v[36:51]
    v_mfma_f32_32x32x16_bf16 v[52:67], a[216:219], v[112:115], v[52:67]
    v_add_u32 v192, 0x10000, v192
    v_add_u32 v193, 0x10000, v193
    v_add_u32 v194, 0x10000, v194
    s_nop 7
    ds_write_b128 v187, v[40:43] offset:1024
    ds_write_b128 v187, v[44:47] offset:2048
    ds_write_b128 v187, v[48:51] offset:3072
    ds_write_b128 v187, v[56:59] offset:33792
    ds_write_b128 v187, v[60:63] offset:34816
    ds_write_b128 v187, v[64:67] offset:35840
    s_waitcnt lgkmcnt(0)
    s_barrier
    ds_read_b128 v[160:163], v192 offset:1024
    ds_read_b128 v[164:167], v193 offset:2048
    ds_read_b128 v[168:171], v194 offset:3072
    ds_read_b128 v[172:175], v192 offset:33792
    ds_read_b128 v[176:179], v193 offset:34816
    ds_read_b128 v[180:183], v194 offset:35840
    v_lshlrev_b32 v156, 16, v152
    v_and_b32 v157, 0xffff0000, v152
    v_lshlrev_b32 v158, 16, v153
    v_and_b32 v159, 0xffff0000, v153
    s_waitcnt lgkmcnt(3)
    v_pk_add_f32 v[36:37], v[36:37], v[160:161]
    v_pk_add_f32 v[164:165], v[164:165], v[168:169]
    v_pk_add_f32 v[38:39], v[38:39], v[162:163]
    v_pk_add_f32 v[166:167], v[166:167], v[170:171]
    v_pk_add_f32 v[36:37], v[36:37], v[164:165]
    v_pk_add_f32 v[38:39], v[38:39], v[166:167]
    v_pk_fma_f32 v[36:37], v[36:37], v[140:141], v[156:157]
    v_pk_fma_f32 v[38:39], v[38:39], v[142:143], v[158:159]
    v_cvt_pk_bf16_f32 v40, v36, v37
    v_cvt_pk_bf16_f32 v41, v38, v39
    buffer_store_dwordx2 v[40:41], v249, s[64:67], s75 offen offset:0
    v_lshlrev_b32 v156, 16, v154
    v_and_b32 v157, 0xffff0000, v154
    v_lshlrev_b32 v158, 16, v155
    v_and_b32 v159, 0xffff0000, v155
    s_waitcnt lgkmcnt(0)
    v_pk_add_f32 v[52:53], v[52:53], v[172:173]
    v_pk_add_f32 v[176:177], v[176:177], v[180:181]
    v_pk_add_f32 v[54:55], v[54:55], v[174:175]
    v_pk_add_f32 v[178:179], v[178:179], v[182:183]
    v_pk_add_f32 v[52:53], v[52:53], v[176:177]
    v_pk_add_f32 v[54:55], v[54:55], v[178:179]
    v_pk_fma_f32 v[52:53], v[52:53], v[144:145], v[156:157]
    v_pk_fma_f32 v[54:55], v[54:55], v[146:147], v[158:159]
    v_cvt_pk_bf16_f32 v56, v52, v53
    v_cvt_pk_bf16_f32 v57, v54, v55
    buffer_store_dwordx2 v[56:57], v249, s[64:67], s75 offen offset:64
    s_cmp_lg_u32 s2, 0
    s_cbranch_scc1 LF_ep_91
    s_add_u32 s74, s69, 1
    v_mov_b32 v3, s74
    v_mov_b32 v4, 0
    s_mov_b64 exec, 1
    buffer_store_dword v3, v4, s[4:7], 0 offen sc1
    s_mov_b64 exec, -1
LF_ep_91:
F_end:
    s_endpgm
LF_wm_1:
    global_load_dword v32, v9, s[42:43]
    global_load_dword v32, v9, s[42:43]
    global_load_dword v32, v9, s[42:43]
    global_load_dword v32, v9, s[42:43]
    s_branch LF_wmj_2
LF_h0_8:
    buffer_load_dwordx4 v[144:147], v190, s[4:7], s34 offen offset:0 sc1
    buffer_load_dwordx4 v[148:151], v190, s[4:7], s34 offen offset:1024 sc1
    buffer_load_dwordx4 v[152:155], v190, s[4:7], s34 offen offset:2048 sc1
    buffer_load_dwordx4 v[156:159], v190, s[4:7], s34 offen offset:3072 sc1
    buffer_load_dwordx4 v[20:23], v190, s[4:7], s35 offen offset:0 sc1
    buffer_load_dwordx4 v[24:27], v190, s[4:7], s35 offen offset:1024 sc1
    buffer_load_dwordx4 v[28:31], v190, s[4:7], s35 offen offset:2048 sc1
    buffer_load_dwordx4 v[32:35], v190, s[4:7], s35 offen offset:3072 sc1
    buffer_load_dwordx2 v[160:161], v191, s[4:7], s33 offen sc1
    s_waitcnt vmcnt(0)
    s_branch LF_h0ck_10
LF_xr_16:
    s_mov_b32 s78, 200000
    s_mov_b32 s9, m0
LF_xl_17:
    s_add_u32 m0, s75, 98304
    s_add_u32 s13, s74, 0
    buffer_load_dwordx4 v147, s[4:7], s13 offen offset:0 sc1 lds
    buffer_load_dwordx4 v147, s[4:7], s13 offen offset:1024 sc1 lds
    buffer_load_dwordx4 v147, s[4:7], s13 offen offset:2048 sc1 lds
    buffer_load_dwordx4 v147, s[4:7], s13 offen offset:3072 sc1 lds
    s_add_u32 m0, s75, 102400
    s_add_u32 s13, s74, 4096
    buffer_load_dwordx4 v147, s[4:7], s13 offen offset:0 sc1 lds
    buffer_load_dwordx4 v147, s[4:7], s13 offen offset:1024 sc1 lds
    buffer_load_dwordx4 v147, s[4:7], s13 offen offset:2048 sc1 lds
    buffer_load_dwordx4 v147, s[4:7], s13 offen offset:3072 sc1 lds
    s_waitcnt vmcnt(0) lgkmcnt(0)
    s_mov_b32 m0, s9
    ds_read_b128 v[148:151], v143 offset:32768
    ds_read_b128 v[152:155], v143 offset:33792
    ds_read_b128 v[156:159], v143 offset:34816
    ds_read_b128 v[160:163], v143 offset:35840
    s_waitcnt lgkmcnt(3)
    v_bitop3_b32 v148, v148, v150, s3 bitop3:0x7e
    v_bitop3_b32 v149, v149, v151, s31 bitop3:0x7e
    v_or3_b32 v164, v148, v149, 0
    s_waitcnt lgkmcnt(2)
    v_bitop3_b32 v152, v152, v154, s3 bitop3:0x7e
    v_bitop3_b32 v153, v153, v155, s31 bitop3:0x7e
    v_or3_b32 v164, v152, v153, v164
    s_waitcnt lgkmcnt(1)
    v_bitop3_b32 v156, v156, v158, s3 bitop3:0x7e
    v_bitop3_b32 v157, v157, v159, s31 bitop3:0x7e
    v_or3_b32 v164, v156, v157, v164
    s_waitcnt lgkmcnt(0)
    v_bitop3_b32 v160, v160, v162, s3 bitop3:0x7e
    v_bitop3_b32 v161, v161, v163, s31 bitop3:0x7e
    v_or3_b32 v164, v160, v161, v164
    ds_read_b128 v[148:151], v143 offset:36864
    ds_read_b128 v[152:155], v143 offset:37888
    ds_read_b128 v[156:159], v143 offset:38912
    ds_read_b128 v[160:163], v143 offset:39936
    s_waitcnt lgkmcnt(3)
    v_bitop3_b32 v148, v148, v150, s3 bitop3:0x7e
    v_bitop3_b32 v149, v149, v151, s31 bitop3:0x7e
    v_or3_b32 v164, v148, v149, v164
    s_waitcnt lgkmcnt(2)
    v_bitop3_b32 v152, v152, v154, s3 bitop3:0x7e
    v_bitop3_b32 v153, v153, v155, s31 bitop3:0x7e
    v_or3_b32 v164, v152, v153, v164
    s_waitcnt lgkmcnt(1)
    v_bitop3_b32 v156, v156, v158, s3 bitop3:0x7e
    v_bitop3_b32 v157, v157, v159, s31 bitop3:0x7e
    v_or3_b32 v164, v156, v157, v164
    s_waitcnt lgkmcnt(0)
    v_bitop3_b32 v160, v160, v162, s3 bitop3:0x7e
    v_bitop3_b32 v161, v161, v163, s31 bitop3:0x7e
    v_or3_b32 v164, v160, v161, v164
    v_and_b32 v164, 0x00010001, v164
    v_cmp_ne_u32 vcc, 0, v164
    s_nop 1
    s_cbranch_vccz LF_xb_18
    s_sub_u32 s78, s78, 1
    s_cmp_lg_u32 s78, 0
    s_cbranch_scc1 LF_xl_17
    s_branch LF_xb_18
LF_xr_19:
    s_mov_b32 s78, 200000
    s_mov_b32 s9, m0
LF_xl_20:
    s_add_u32 m0, s75, 65536
    s_add_u32 s13, s74, 32768
    buffer_load_dwordx4 v147, s[4:7], s13 offen offset:0 sc1 lds
    buffer_load_dwordx4 v147, s[4:7], s13 offen offset:1024 sc1 lds
    buffer_load_dwordx4 v147, s[4:7], s13 offen offset:2048 sc1 lds
    buffer_load_dwordx4 v147, s[4:7], s13 offen offset:3072 sc1 lds
    s_add_u32 m0, s75, 69632
    s_add_u32 s13, s74, 36864
    buffer_load_dwordx4 v147, s[4:7], s13 offen offset:0 sc1 lds
    buffer_load_dwordx4 v147, s[4:7], s13 offen offset:1024 sc1 lds
    buffer_load_dwordx4 v147, s[4:7], s13 offen offset:2048 sc1 lds
    buffer_load_dwordx4 v147, s[4:7], s13 offen offset:3072 sc1 lds
    s_waitcnt vmcnt(0) lgkmcnt(0)
    s_mov_b32 m0, s9
    ds_read_b128 v[148:151], v143 offset:0
    ds_read_b128 v[152:155], v143 offset:1024
    ds_read_b128 v[156:159], v143 offset:2048
    ds_read_b128 v[160:163], v143 offset:3072
    s_waitcnt lgkmcnt(3)
    v_bitop3_b32 v148, v148, v150, s3 bitop3:0x7e
    v_bitop3_b32 v149, v149, v151, s31 bitop3:0x7e
    v_or3_b32 v164, v148, v149, 0
    s_waitcnt lgkmcnt(2)
    v_bitop3_b32 v152, v152, v154, s3 bitop3:0x7e
    v_bitop3_b32 v153, v153, v155, s31 bitop3:0x7e
    v_or3_b32 v164, v152, v153, v164
    s_waitcnt lgkmcnt(1)
    v_bitop3_b32 v156, v156, v158, s3 bitop3:0x7e
    v_bitop3_b32 v157, v157, v159, s31 bitop3:0x7e
    v_or3_b32 v164, v156, v157, v164
    s_waitcnt lgkmcnt(0)
    v_bitop3_b32 v160, v160, v162, s3 bitop3:0x7e
    v_bitop3_b32 v161, v161, v163, s31 bitop3:0x7e
    v_or3_b32 v164, v160, v161, v164
    ds_read_b128 v[148:151], v143 offset:4096
    ds_read_b128 v[152:155], v143 offset:5120
    ds_read_b128 v[156:159], v143 offset:6144
    ds_read_b128 v[160:163], v143 offset:7168
    s_waitcnt lgkmcnt(3)
    v_bitop3_b32 v148, v148, v150, s3 bitop3:0x7e
    v_bitop3_b32 v149, v149, v151, s31 bitop3:0x7e
    v_or3_b32 v164, v148, v149, v164
    s_waitcnt lgkmcnt(2)
    v_bitop3_b32 v152, v152, v154, s3 bitop3:0x7e
    v_bitop3_b32 v153, v153, v155, s31 bitop3:0x7e
    v_or3_b32 v164, v152, v153, v164
    s_waitcnt lgkmcnt(1)
    v_bitop3_b32 v156, v156, v158, s3 bitop3:0x7e
    v_bitop3_b32 v157, v157, v159, s31 bitop3:0x7e
    v_or3_b32 v164, v156, v157, v164
    s_waitcnt lgkmcnt(0)
    v_bitop3_b32 v160, v160, v162, s3 bitop3:0x7e
    v_bitop3_b32 v161, v161, v163, s31 bitop3:0x7e
    v_or3_b32 v164, v160, v161, v164
    v_and_b32 v164, 0x00010001, v164
    v_cmp_ne_u32 vcc, 0, v164
    s_nop 1
    s_cbranch_vccz LF_xb_21
    s_sub_u32 s78, s78, 1
    s_cmp_lg_u32 s78, 0
    s_cbranch_scc1 LF_xl_20
    s_branch LF_xb_21
LF_xr_22:
    s_mov_b32 s78, 200000
    s_mov_b32 s9, m0
LF_xl_23:
    s_add_u32 m0, s75, 32768
    s_add_u32 s13, s74, 65536
    buffer_load_dwordx4 v147, s[4:7], s13 offen offset:0 sc1 lds
    buffer_load_dwordx4 v147, s[4:7], s13 offen offset:1024 sc1 lds
    buffer_load_dwordx4 v147, s[4:7], s13 offen offset:2048 sc1 lds
    buffer_load_dwordx4 v147, s[4:7], s13 offen offset:3072 sc1 lds
    s_add_u32 m0, s75, 36864
    s_add_u32 s13, s74, 69632
    buffer_load_dwordx4 v147, s[4:7], s13 offen offset:0 sc1 lds
    buffer_load_dwordx4 v147, s[4:7], s13 offen offset:1024 sc1 lds
    buffer_load_dwordx4 v147, s[4:7], s13 offen offset:2048 sc1 lds
    buffer_load_dwordx4 v147, s[4:7], s13 offen offset:3072 sc1 lds
    s_waitcnt vmcnt(0) lgkmcnt(0)
    s_mov_b32 m0, s9
    ds_read_b32 v148, v146 offset:32768
    ds_read_b32 v149, v146 offset:33792
    ds_read_b32 v150, v146 offset:34816
    ds_read_b32 v151, v146 offset:35840
    ds_read_b32 v152, v146 offset:36864
    ds_read_b32 v153, v146 offset:37888
    ds_read_b32 v154, v146 offset:38912
    ds_read_b32 v155, v146 offset:39936
    s_waitcnt lgkmcnt(0)
    v_bitop3_b32 v148, v148, v149, s3 bitop3:0x7e
    v_bitop3_b32 v150, v150, v151, s3 bitop3:0x7e
    v_bitop3_b32 v152, v152, v153, s3 bitop3:0x7e
    v_bitop3_b32 v154, v154, v155, s3 bitop3:0x7e
    v_or3_b32 v148, v148, v150, v152
    v_or_b32 v148, v148, v154
    v_and_b32 v148, 0x00010001, v148
    v_cmp_ne_u32 vcc, 0, v148
    s_nop 1
    s_cbranch_vccz LF_xb_24
    s_sub_u32 s78, s78, 1
    s_cmp_lg_u32 s78, 0
    s_cbranch_scc1 LF_xl_23
    s_branch LF_xb_24
LF_mfr_25:
    s_mov_b32 s78, 200000
LF_mfl_26:
    buffer_load_dwordx4 v[200:203], v138, s[4:7], s35 offen offset:0 sc1
    buffer_load_dwordx4 v[204:207], v138, s[4:7], s34 offen offset:0 sc1
    buffer_load_dwordx4 v[208:211], v138, s[4:7], s35 offen offset:256 sc1
    buffer_load_dwordx4 v[212:215], v138, s[4:7], s34 offen offset:256 sc1
    s_waitcnt vmcnt(0)
    v_min3_u32 v136, v201, v203, v201
    v_max3_u32 v137, v201, v203, v201
    v_min3_u32 v136, v205, v207, v136
    v_max3_u32 v137, v205, v207, v137
    v_min3_u32 v136, v209, v211, v136
    v_max3_u32 v137, v209, v211, v137
    v_min3_u32 v136, v213, v215, v136
    v_max3_u32 v137, v213, v215, v137
    v_xor_b32 v136, s68, v136
    v_xor_b32 v137, s68, v137
    v_or_b32 v136, v136, v137
    v_cmp_ne_u32 vcc, 0, v136
    s_nop 1
    s_cbranch_vccz LF_mfb_27
    s_sub_u32 s78, s78, 1
    s_cmp_lg_u32 s78, 0
    s_cbranch_scc1 LF_mfl_26
    s_branch LF_mfb_27
LF_str_28:
    s_mov_b32 s78, 200000
LF_stl_29:
    buffer_load_dwordx2 v[128:129], v145, s[4:7], s33 offen offset:0 sc1
    buffer_load_dwordx2 v[130:131], v145, s[4:7], s33 offen offset:256 sc1
    s_waitcnt vmcnt(0)
    v_xor_b32 v136, s68, v129
    v_xor_b32 v137, s68, v131
    v_or_b32 v136, v136, v137
    v_cmp_ne_u32 vcc, 0, v136
    s_nop 1
    s_cbranch_vccz LF_stb_30
    s_sub_u32 s78, s78, 1
    s_cmp_lg_u32 s78, 0
    s_cbranch_scc1 LF_stl_29
    s_branch LF_stb_30
LF_xr_31:
    s_mov_b32 s78, 200000
    s_mov_b32 s9, m0
LF_xl_32:
    s_add_u32 m0, s75, 0
    s_add_u32 s13, s74, 98304
    buffer_load_dwordx4 v147, s[4:7], s13 offen offset:0 sc1 lds
    buffer_load_dwordx4 v147, s[4:7], s13 offen offset:1024 sc1 lds
    buffer_load_dwordx4 v147, s[4:7], s13 offen offset:2048 sc1 lds
    buffer_load_dwordx4 v147, s[4:7], s13 offen offset:3072 sc1 lds
    s_add_u32 m0, s75, 4096
    s_add_u32 s13, s74, 102400
    buffer_load_dwordx4 v147, s[4:7], s13 offen offset:0 sc1 lds
    buffer_load_dwordx4 v147, s[4:7], s13 offen offset:1024 sc1 lds
    buffer_load_dwordx4 v147, s[4:7], s13 offen offset:2048 sc1 lds
    buffer_load_dwordx4 v147, s[4:7], s13 offen offset:3072 sc1 lds
    s_waitcnt vmcnt(0) lgkmcnt(0)
    s_mov_b32 m0, s9
    ds_read_b32 v164, v146 offset:0
    ds_read_b32 v165, v146 offset:1024
    ds_read_b32 v166, v146 offset:2048
    ds_read_b32 v167, v146 offset:3072
    ds_read_b32 v168, v146 offset:4096
    ds_read_b32 v169, v146 offset:5120
    ds_read_b32 v170, v146 offset:6144
    ds_read_b32 v171, v146 offset:7168
    s_waitcnt lgkmcnt(0)
    v_bitop3_b32 v164, v164, v165, s3 bitop3:0x7e
    v_bitop3_b32 v166, v166, v167, s3 bitop3:0x7e
    v_bitop3_b32 v168, v168, v169, s3 bitop3:0x7e
    v_bitop3_b32 v170, v170, v171, s3 bitop3:0x7e
    v_or3_b32 v164, v164, v166, v168
    v_or_b32 v164, v164, v170
    v_and_b32 v164, 0x00010001, v164
    v_cmp_ne_u32 vcc, 0, v164
    s_nop 1
    s_cbranch_vccz LF_xb_33
    s_sub_u32 s78, s78, 1
    s_cmp_lg_u32 s78, 0
    s_cbranch_scc1 LF_xl_32
    s_branch LF_xb_33
LF_str_34:
    s_mov_b32 s78, 200000
LF_stl_35:
    buffer_load_dwordx2 v[132:133], v145, s[4:7], s33 offen offset:512 sc1
    buffer_load_dwordx2 v[134:135], v145, s[4:7], s33 offen offset:768 sc1
    s_waitcnt vmcnt(0)
    v_xor_b32 v136, s68, v133
    v_xor_b32 v137, s68, v135
    v_or_b32 v136, v136, v137
    v_cmp_ne_u32 vcc, 0, v136
    s_nop 1
    s_cbranch_vccz LF_stb_36
    s_sub_u32 s78, s78, 1
    s_cmp_lg_u32 s78, 0
    s_cbranch_scc1 LF_stl_35
    s_branch LF_stb_36
LF_mfr_37:
    s_mov_b32 s78, 200000
LF_mfl_38:
    s_mov_b32 s47, 45056
    buffer_load_dwordx4 v[200:203], v236, s[4:7], s47 offen sc1
    s_mov_b32 s47, 69632
    buffer_load_dwordx4 v[204:207], v236, s[4:7], s47 offen sc1
    s_mov_b32 s47, 94208
    buffer_load_dwordx4 v[208:211], v236, s[4:7], s47 offen sc1
    s_mov_b32 s47, 118784
    buffer_load_dwordx4 v[212:215], v236, s[4:7], s47 offen sc1
    s_mov_b32 s47, 49152
    buffer_load_dwordx4 v[216:219], v236, s[4:7], s47 offen sc1
    s_mov_b32 s47, 73728
    buffer_load_dwordx4 v[220:223], v236, s[4:7], s47 offen sc1
    s_mov_b32 s47, 98304
    buffer_load_dwordx4 v[224:227], v236, s[4:7], s47 offen sc1
    s_mov_b32 s47, 122880
    buffer_load_dwordx4 v[228:231], v236, s[4:7], s47 offen sc1
    s_waitcnt vmcnt(0)
    v_min3_u32 v232, v201, v203, v201
    v_max3_u32 v233, v201, v203, v201
    v_min3_u32 v232, v205, v207, v232
    v_max3_u32 v233, v205, v207, v233
    v_min3_u32 v232, v209, v211, v232
    v_max3_u32 v233, v209, v211, v233
    v_min3_u32 v232, v213, v215, v232
    v_max3_u32 v233, v213, v215, v233
    v_min3_u32 v232, v217, v219, v232
    v_max3_u32 v233, v217, v219, v233
    v_min3_u32 v232, v221, v223, v232
    v_max3_u32 v233, v221, v223, v233
    v_min3_u32 v232, v225, v227, v232
    v_max3_u32 v233, v225, v227, v233
    v_min3_u32 v232, v229, v231, v232
    v_max3_u32 v233, v229, v231, v233
    v_xor_b32 v232, s68, v232
    v_xor_b32 v233, s68, v233
    v_or_b32 v232, v232, v233
    v_cmp_ne_u32 vcc, 0, v232
    s_nop 1
    s_cbranch_vccz LF_mfb_39
    s_sub_u32 s78, s78, 1
    s_cmp_lg_u32 s78, 0
    s_cbranch_scc1 LF_mfl_38
    s_branch LF_mfb_39
LF_g2r_42:
    s_mov_b32 s78, 200000
LF_g2l_43:
    s_add_u32 m0, s75, 0
    s_add_u32 s101, s74, 0
    buffer_load_dwordx4 v147, s[4:7], s101 offen offset:0 sc1 lds
    buffer_load_dwordx4 v147, s[4:7], s101 offen offset:1024 sc1 lds
    buffer_load_dwordx4 v147, s[4:7], s101 offen offset:2048 sc1 lds
    buffer_load_dwordx4 v147, s[4:7], s101 offen offset:3072 sc1 lds
    s_add_u32 m0, s75, 4096
    s_add_u32 s101, s74, 4096
    buffer_load_dwordx4 v147, s[4:7], s101 offen offset:0 sc1 lds
    buffer_load_dwordx4 v147, s[4:7], s101 offen offset:1024 sc1 lds
    buffer_load_dwordx4 v147, s[4:7], s101 offen offset:2048 sc1 lds
    buffer_load_dwordx4 v147, s[4:7], s101 offen offset:3072 sc1 lds
    s_waitcnt vmcnt(0)
    ds_read_b64_tr_b16 v[68:69], v144 offset:0
    ds_read_b64_tr_b16 v[70:71], v144 offset:256
    ds_read_b64_tr_b16 v[72:73], v144 offset:1024
    ds_read_b64_tr_b16 v[74:75], v144 offset:1280
    ds_read_b64_tr_b16 v[76:77], v144 offset:2048
    ds_read_b64_tr_b16 v[78:79], v144 offset:2304
    ds_read_b64_tr_b16 v[80:81], v144 offset:3072
    ds_read_b64_tr_b16 v[82:83], v144 offset:3328
    ds_read_b64_tr_b16 v[84:85], v144 offset:4096
    ds_read_b64_tr_b16 v[86:87], v144 offset:4352
    ds_read_b64_tr_b16 v[88:89], v144 offset:5120
    ds_read_b64_tr_b16 v[90:91], v144 offset:5376
    ds_read_b64_tr_b16 v[92:93], v144 offset:6144
    ds_read_b64_tr_b16 v[94:95], v144 offset:6400
    ds_read_b64_tr_b16 v[96:97], v144 offset:7168
    ds_read_b64_tr_b16 v[98:99], v144 offset:7424
    s_waitcnt lgkmcnt(12)
    v_dot2_f32_bf16 v64, v68, v60, 0
    v_dot2_f32_bf16 v65, v68, v68, 0
    v_dot2_f32_bf16 v64, v69, v60, v64
    v_dot2_f32_bf16 v65, v69, v69, v65
    v_bitop3_b32 v59, v68, v69, v58 bitop3:0x7e
    v_or_b32 v57, v59, v59
    v_dot2_f32_bf16 v64, v70, v60, v64
    v_dot2_f32_bf16 v65, v70, v70, v65
    v_dot2_f32_bf16 v64, v71, v60, v64
    v_dot2_f32_bf16 v65, v71, v71, v65
    v_bitop3_b32 v59, v70, v71, v58 bitop3:0x7e
    v_or_b32 v57, v59, v57
    v_dot2_f32_bf16 v64, v72, v60, v64
    v_dot2_f32_bf16 v65, v72, v72, v65
    v_dot2_f32_bf16 v64, v73, v60, v64
    v_dot2_f32_bf16 v65, v73, v73, v65
    v_bitop3_b32 v59, v72, v73, v58 bitop3:0x7e
    v_or_b32 v57, v59, v57
    v_dot2_f32_bf16 v64, v74, v60, v64
    v_dot2_f32_bf16 v65, v74, v74, v65
    v_dot2_f32_bf16 v64, v75, v60, v64
    v_dot2_f32_bf16 v65, v75, v75, v65
    v_bitop3_b32 v59, v74, v75, v58 bitop3:0x7e
    v_or_b32 v57, v59, v57
    s_waitcnt lgkmcnt(8)
    v_dot2_f32_bf16 v64, v76, v60, v64
    v_dot2_f32_bf16 v65, v76, v76, v65
    v_dot2_f32_bf16 v64, v77, v60, v64
    v_dot2_f32_bf16 v65, v77, v77, v65
    v_bitop3_b32 v59, v76, v77, v58 bitop3:0x7e
    v_or_b32 v57, v59, v57
    v_dot2_f32_bf16 v64, v78, v60, v64
    v_dot2_f32_bf16 v65, v78, v78, v65
    v_dot2_f32_bf16 v64, v79, v60, v64
    v_dot2_f32_bf16 v65, v79, v79, v65
    v_bitop3_b32 v59, v78, v79, v58 bitop3:0x7e
    v_or_b32 v57, v59, v57
    v_dot2_f32_bf16 v64, v80, v60, v64
    v_dot2_f32_bf16 v65, v80, v80, v65
    v_dot2_f32_bf16 v64, v81, v60, v64
    v_dot2_f32_bf16 v65, v81, v81, v65
    v_bitop3_b32 v59, v80, v81, v58 bitop3:0x7e
    v_or_b32 v57, v59, v57
    v_dot2_f32_bf16 v64, v82, v60, v64
    v_dot2_f32_bf16 v65, v82, v82, v65
    v_dot2_f32_bf16 v64, v83, v60, v64
    v_dot2_f32_bf16 v65, v83, v83, v65
    v_bitop3_b32 v59, v82, v83, v58 bitop3:0x7e
    v_or_b32 v57, v59, v57
    s_waitcnt lgkmcnt(4)
    v_dot2_f32_bf16 v64, v84, v60, v64
    v_dot2_f32_bf16 v65, v84, v84, v65
    v_dot2_f32_bf16 v64, v85, v60, v64
    v_dot2_f32_bf16 v65, v85, v85, v65
    v_bitop3_b32 v59, v84, v85, v58 bitop3:0x7e
    v_or_b32 v57, v59, v57
    v_dot2_f32_bf16 v64, v86, v60, v64
    v_dot2_f32_bf16 v65, v86, v86, v65
    v_dot2_f32_bf16 v64, v87, v60, v64
    v_dot2_f32_bf16 v65, v87, v87, v65
    v_bitop3_b32 v59, v86, v87, v58 bitop3:0x7e
    v_or_b32 v57, v59, v57
    v_dot2_f32_bf16 v64, v88, v60, v64
    v_dot2_f32_bf16 v65, v88, v88, v65
    v_dot2_f32_bf16 v64, v89, v60, v64
    v_dot2_f32_bf16 v65, v89, v89, v65
    v_bitop3_b32 v59, v88, v89, v58 bitop3:0x7e
    v_or_b32 v57, v59, v57
    v_dot2_f32_bf16 v64, v90, v60, v64
    v_dot2_f32_bf16 v65, v90, v90, v65
    v_dot2_f32_bf16 v64, v91, v60, v64
    v_dot2_f32_bf16 v65, v91, v91, v65
    v_bitop3_b32 v59, v90, v91, v58 bitop3:0x7e
    v_or_b32 v57, v59, v57
    s_waitcnt lgkmcnt(0)
    v_dot2_f32_bf16 v64, v92, v60, v64
    v_dot2_f32_bf16 v65, v92, v92, v65
    v_dot2_f32_bf16 v64, v93, v60, v64
    v_dot2_f32_bf16 v65, v93, v93, v65
    v_bitop3_b32 v59, v92, v93, v58 bitop3:0x7e
    v_or_b32 v57, v59, v57
    v_dot2_f32_bf16 v64, v94, v60, v64
    v_dot2_f32_bf16 v65, v94, v94, v65
    v_dot2_f32_bf16 v64, v95, v60, v64
    v_dot2_f32_bf16 v65, v95, v95, v65
    v_bitop3_b32 v59, v94, v95, v58 bitop3:0x7e
    v_or_b32 v57, v59, v57
    v_dot2_f32_bf16 v64, v96, v60, v64
    v_dot2_f32_bf16 v65, v96, v96, v65
    v_dot2_f32_bf16 v64, v97, v60, v64
    v_dot2_f32_bf16 v65, v97, v97, v65
    v_bitop3_b32 v59, v96, v97, v58 bitop3:0x7e
    v_or_b32 v57, v59, v57
    v_dot2_f32_bf16 v64, v98, v60, v64
    v_dot2_f32_bf16 v65, v98, v98, v65
    v_dot2_f32_bf16 v64, v99, v60, v64
    v_dot2_f32_bf16 v65, v99, v99, v65
    v_bitop3_b32 v59, v98, v99, v58 bitop3:0x7e
    v_or_b32 v57, v59, v57
    v_and_b32 v57, 0x00010001, v57
    v_cmp_ne_u32 vcc, 0, v57
    s_nop 1
    s_cbranch_vccz LF_g2b_44
    s_sub_u32 s78, s78, 1
    s_cmp_lg_u32 s78, 0
    s_cbranch_scc1 LF_g2l_43
    s_branch LF_g2b_44
LF_g2r_45:
    s_mov_b32 s78, 200000
LF_g2l_46:
    s_add_u32 m0, s75, 8192
    s_add_u32 s101, s74, 65536
    buffer_load_dwordx4 v147, s[4:7], s101 offen offset:0 sc1 lds
    buffer_load_dwordx4 v147, s[4:7], s101 offen offset:1024 sc1 lds
    buffer_load_dwordx4 v147, s[4:7], s101 offen offset:2048 sc1 lds
    buffer_load_dwordx4 v147, s[4:7], s101 offen offset:3072 sc1 lds
    s_add_u32 m0, s75, 12288
    s_add_u32 s101, s74, 69632
    buffer_load_dwordx4 v147, s[4:7], s101 offen offset:0 sc1 lds
    buffer_load_dwordx4 v147, s[4:7], s101 offen offset:1024 sc1 lds
    buffer_load_dwordx4 v147, s[4:7], s101 offen offset:2048 sc1 lds
    buffer_load_dwordx4 v147, s[4:7], s101 offen offset:3072 sc1 lds
    s_waitcnt vmcnt(0)
    ds_read_b64_tr_b16 v[68:69], v144 offset:8192
    ds_read_b64_tr_b16 v[70:71], v144 offset:8448
    ds_read_b64_tr_b16 v[72:73], v144 offset:9216
    ds_read_b64_tr_b16 v[74:75], v144 offset:9472
    ds_read_b64_tr_b16 v[76:77], v144 offset:10240
    ds_read_b64_tr_b16 v[78:79], v144 offset:10496
    ds_read_b64_tr_b16 v[80:81], v144 offset:11264
    ds_read_b64_tr_b16 v[82:83], v144 offset:11520
    ds_read_b64_tr_b16 v[84:85], v144 offset:12288
    ds_read_b64_tr_b16 v[86:87], v144 offset:12544
    ds_read_b64_tr_b16 v[88:89], v144 offset:13312
    ds_read_b64_tr_b16 v[90:91], v144 offset:13568
    ds_read_b64_tr_b16 v[92:93], v144 offset:14336
    ds_read_b64_tr_b16 v[94:95], v144 offset:14592
    ds_read_b64_tr_b16 v[96:97], v144 offset:15360
    ds_read_b64_tr_b16 v[98:99], v144 offset:15616
    s_waitcnt lgkmcnt(12)
    v_dot2_f32_bf16 v64, v68, v60, 0
    v_dot2_f32_bf16 v65, v68, v68, 0
    v_dot2_f32_bf16 v64, v69, v60, v64
    v_dot2_f32_bf16 v65, v69, v69, v65
    v_bitop3_b32 v59, v68, v69, v58 bitop3:0x7e
    v_or_b32 v57, v59, v59
    v_dot2_f32_bf16 v64, v70, v60, v64
    v_dot2_f32_bf16 v65, v70, v70, v65
    v_dot2_f32_bf16 v64, v71, v60, v64
    v_dot2_f32_bf16 v65, v71, v71, v65
    v_bitop3_b32 v59, v70, v71, v58 bitop3:0x7e
    v_or_b32 v57, v59, v57
    v_dot2_f32_bf16 v64, v72, v60, v64
    v_dot2_f32_bf16 v65, v72, v72, v65
    v_dot2_f32_bf16 v64, v73, v60, v64
    v_dot2_f32_bf16 v65, v73, v73, v65
    v_bitop3_b32 v59, v72, v73, v58 bitop3:0x7e
    v_or_b32 v57, v59, v57
    v_dot2_f32_bf16 v64, v74, v60, v64
    v_dot2_f32_bf16 v65, v74, v74, v65
    v_dot2_f32_bf16 v64, v75, v60, v64
    v_dot2_f32_bf16 v65, v75, v75, v65
    v_bitop3_b32 v59, v74, v75, v58 bitop3:0x7e
    v_or_b32 v57, v59, v57
    s_waitcnt lgkmcnt(8)
    v_dot2_f32_bf16 v64, v76, v60, v64
    v_dot2_f32_bf16 v65, v76, v76, v65
    v_dot2_f32_bf16 v64, v77, v60, v64
    v_dot2_f32_bf16 v65, v77, v77, v65
    v_bitop3_b32 v59, v76, v77, v58 bitop3:0x7e
    v_or_b32 v57, v59, v57
    v_dot2_f32_bf16 v64, v78, v60, v64
    v_dot2_f32_bf16 v65, v78, v78, v65
    v_dot2_f32_bf16 v64, v79, v60, v64
    v_dot2_f32_bf16 v65, v79, v79, v65
    v_bitop3_b32 v59, v78, v79, v58 bitop3:0x7e
    v_or_b32 v57, v59, v57
    v_dot2_f32_bf16 v64, v80, v60, v64
    v_dot2_f32_bf16 v65, v80, v80, v65
    v_dot2_f32_bf16 v64, v81, v60, v64
    v_dot2_f32_bf16 v65, v81, v81, v65
    v_bitop3_b32 v59, v80, v81, v58 bitop3:0x7e
    v_or_b32 v57, v59, v57
    v_dot2_f32_bf16 v64, v82, v60, v64
    v_dot2_f32_bf16 v65, v82, v82, v65
    v_dot2_f32_bf16 v64, v83, v60, v64
    v_dot2_f32_bf16 v65, v83, v83, v65
    v_bitop3_b32 v59, v82, v83, v58 bitop3:0x7e
    v_or_b32 v57, v59, v57
    s_waitcnt lgkmcnt(4)
    v_dot2_f32_bf16 v64, v84, v60, v64
    v_dot2_f32_bf16 v65, v84, v84, v65
    v_dot2_f32_bf16 v64, v85, v60, v64
    v_dot2_f32_bf16 v65, v85, v85, v65
    v_bitop3_b32 v59, v84, v85, v58 bitop3:0x7e
    v_or_b32 v57, v59, v57
    v_dot2_f32_bf16 v64, v86, v60, v64
    v_dot2_f32_bf16 v65, v86, v86, v65
    v_dot2_f32_bf16 v64, v87, v60, v64
    v_dot2_f32_bf16 v65, v87, v87, v65
    v_bitop3_b32 v59, v86, v87, v58 bitop3:0x7e
    v_or_b32 v57, v59, v57
    v_dot2_f32_bf16 v64, v88, v60, v64
    v_dot2_f32_bf16 v65, v88, v88, v65
    v_dot2_f32_bf16 v64, v89, v60, v64
    v_dot2_f32_bf16 v65, v89, v89, v65
    v_bitop3_b32 v59, v88, v89, v58 bitop3:0x7e
    v_or_b32 v57, v59, v57
    v_dot2_f32_bf16 v64, v90, v60, v64
    v_dot2_f32_bf16 v65, v90, v90, v65
    v_dot2_f32_bf16 v64, v91, v60, v64
    v_dot2_f32_bf16 v65, v91, v91, v65
    v_bitop3_b32 v59, v90, v91, v58 bitop3:0x7e
    v_or_b32 v57, v59, v57
    s_waitcnt lgkmcnt(0)
    v_dot2_f32_bf16 v64, v92, v60, v64
    v_dot2_f32_bf16 v65, v92, v92, v65
    v_dot2_f32_bf16 v64, v93, v60, v64
    v_dot2_f32_bf16 v65, v93, v93, v65
    v_bitop3_b32 v59, v92, v93, v58 bitop3:0x7e
    v_or_b32 v57, v59, v57
    v_dot2_f32_bf16 v64, v94, v60, v64
    v_dot2_f32_bf16 v65, v94, v94, v65
    v_dot2_f32_bf16 v64, v95, v60, v64
    v_dot2_f32_bf16 v65, v95, v95, v65
    v_bitop3_b32 v59, v94, v95, v58 bitop3:0x7e
    v_or_b32 v57, v59, v57
    v_dot2_f32_bf16 v64, v96, v60, v64
    v_dot2_f32_bf16 v65, v96, v96, v65
    v_dot2_f32_bf16 v64, v97, v60, v64
    v_dot2_f32_bf16 v65, v97, v97, v65
    v_bitop3_b32 v59, v96, v97, v58 bitop3:0x7e
    v_or_b32 v57, v59, v57
    v_dot2_f32_bf16 v64, v98, v60, v64
    v_dot2_f32_bf16 v65, v98, v98, v65
    v_dot2_f32_bf16 v64, v99, v60, v64
    v_dot2_f32_bf16 v65, v99, v99, v65
    v_bitop3_b32 v59, v98, v99, v58 bitop3:0x7e
    v_or_b32 v57, v59, v57
    v_and_b32 v57, 0x00010001, v57
    v_cmp_ne_u32 vcc, 0, v57
    s_nop 1
    s_cbranch_vccz LF_g2b_47
    s_sub_u32 s78, s78, 1
    s_cmp_lg_u32 s78, 0
    s_cbranch_scc1 LF_g2l_46
    s_branch LF_g2b_47
LF_far_48:
    s_mov_b32 s78, 200000
LF_fal_49:
    buffer_load_dword v144, v140, s[4:7], s86 offen sc1
    s_waitcnt vmcnt(0)
    v_xor_b32 v144, s3, v144
    v_and_b32 v144, 0x00010001, v144
    v_cmp_ne_u32 vcc, 0, v144
    s_nop 1
    s_cbranch_vccz LF_fab_50
    s_sub_u32 s78, s78, 1
    s_cmp_lg_u32 s78, 0
    s_cbranch_scc1 LF_fal_49
    s_branch LF_fab_50
F_alt:
    v_min3_u32 v232, v201, v203, v201
    v_max3_u32 v233, v201, v203, v201
    v_min3_u32 v232, v205, v207, v232
    v_max3_u32 v233, v205, v207, v233
    v_min3_u32 v232, v209, v211, v232
    v_max3_u32 v233, v209, v211, v233
    v_min3_u32 v232, v213, v215, v232
    v_max3_u32 v233, v213, v215, v233
    v_min3_u32 v232, v217, v219, v232
    v_max3_u32 v233, v217, v219, v233
    v_min3_u32 v232, v221, v223, v232
    v_max3_u32 v233, v221, v223, v233
    v_min3_u32 v232, v225, v227, v232
    v_max3_u32 v233, v225, v227, v233
    v_min3_u32 v232, v229, v231, v232
    v_max3_u32 v233, v229, v231, v233
    v_xor_b32 v232, s68, v232
    v_xor_b32 v233, s68, v233
    v_or_b32 v232, v232, v233
    v_cmp_ne_u32 vcc, 0, v232
    s_nop 0
    s_cbranch_vccnz LF_mfr_37
LF_mfb_39:
    v_add_f32 v200, v200, v204
    v_add_f32 v208, v208, v212
    v_add_f32 v200, v200, v208
    v_add_f32 v202, v202, v206
    v_add_f32 v210, v210, v214
    v_add_f32 v202, v202, v210
    v_add_f32 v216, v216, v220
    v_add_f32 v224, v224, v228
    v_add_f32 v216, v216, v224
    v_add_f32 v218, v218, v222
    v_add_f32 v226, v226, v230
    v_add_f32 v218, v218, v226
    v_cvt_pk_bf16_f32 v7, v200, v202
    v_cvt_pk_bf16_f32 v5, v216, v218
    v_lshlrev_b32 v8, 16, v5
    v_and_b32 v9, 0xffff0000, v5
    v_add_f32 v8, 1.0, v8
    v_add_f32 v9, 1.0, v9
    v_cvt_pk_bf16_f32 v5, v8, v9
    v_lshlrev_b32 v3, 2, v0
    v_add_u32 v3, 155648, v3
    ds_write2st64_b32 v3, v5, v7 offset0:0 offset1:4
    v_and_b32 v2, 1, v1
    v_lshlrev_b32 v2, 10, v2
    v_lshrrev_b32 v4, 5, v1
    v_lshl_add_u32 v2, v4, 4, v2
    s_lshl_b32 s101, s100, 9
    s_add_u32 s101, s101, 155648
    v_add_u32 v2, s101, v2
    s_waitcnt vmcnt(4) lgkmcnt(0)
    s_barrier
    ds_read_b64_tr_b16 a[32:33], v241 offset:24576
    ds_read_b64_tr_b16 a[34:35], v241 offset:25600
    ds_read_b64_tr_b16 a[160:161], v242 offset:24576
    ds_read_b64_tr_b16 a[162:163], v242 offset:25600
    ds_read_b64_tr_b16 a[36:37], v241 offset:32768
    ds_read_b64_tr_b16 a[38:39], v241 offset:33792
    ds_read_b64_tr_b16 a[164:165], v242 offset:32768
    ds_read_b64_tr_b16 a[166:167], v242 offset:33792
    ds_read_b64_tr_b16 a[40:41], v241 offset:40960
    ds_read_b64_tr_b16 a[42:43], v241 offset:41984
    ds_read_b64_tr_b16 a[168:169], v242 offset:40960
    ds_read_b64_tr_b16 a[170:171], v242 offset:41984
    ds_read_b64_tr_b16 a[44:45], v241 offset:49152
    ds_read_b64_tr_b16 a[46:47], v241 offset:50176
    ds_read_b64_tr_b16 a[172:173], v242 offset:49152
    ds_read_b64_tr_b16 a[174:175], v242 offset:50176
    ds_read_b64_tr_b16 a[48:49], v241 offset:57344
    ds_read_b64_tr_b16 a[50:51], v241 offset:58368
    ds_read_b64_tr_b16 a[176:177], v242 offset:57344
    ds_read_b64_tr_b16 a[178:179], v242 offset:58368
    ds_read_b64_tr_b16 a[52:53], v245 offset:0
    ds_read_b64_tr_b16 a[54:55], v245 offset:1024
    ds_read_b64_tr_b16 a[180:181], v246 offset:0
    ds_read_b64_tr_b16 a[182:183], v246 offset:1024
    ds_read_b64_tr_b16 a[56:57], v245 offset:8192
    ds_read_b64_tr_b16 a[58:59], v245 offset:9216
    ds_read_b64_tr_b16 a[184:185], v246 offset:8192
    ds_read_b64_tr_b16 a[186:187], v246 offset:9216
    ds_read_b64_tr_b16 a[60:61], v245 offset:16384
    ds_read_b64_tr_b16 a[62:63], v245 offset:17408
    ds_read_b64_tr_b16 a[188:189], v246 offset:16384
    ds_read_b64_tr_b16 a[190:191], v246 offset:17408
    ds_read_b128 v[100:103], v2 offset:0
    ds_read_b128 v[104:107], v2 offset:32
    ds_read_b128 v[108:111], v2 offset:64
    ds_read_b128 v[112:115], v2 offset:96
    ds_read_b128 v[116:119], v2 offset:128
    ds_read_b128 v[120:123], v2 offset:160
    ds_read_b128 v[124:127], v2 offset:192
    ds_read_b128 v[128:131], v2 offset:224
    ds_read_b128 v[132:135], v2 offset:256
    ds_read_b128 v[136:139], v2 offset:288
    ds_read_b128 v[140:143], v2 offset:320
    ds_read_b128 v[144:147], v2 offset:352
    ds_read_b128 v[148:151], v2 offset:384
    ds_read_b128 v[152:155], v2 offset:416
    ds_read_b128 v[156:159], v2 offset:448
    ds_read_b128 v[160:163], v2 offset:480
    v_bfe_u32 v40, v1, 4, 1
    v_mul_u32_u24 v40, 28672, v40
    v_bfe_u32 v41, v1, 2, 1
    v_lshl_add_u32 v40, v41, 7, v40
    v_bfe_u32 v41, v1, 3, 1
    v_lshl_add_u32 v40, v41, 6, v40
    v_and_b32 v41, 3, v1
    v_lshl_add_u32 v40, v41, 4, v40
    s_mul_i32 s101, s100, 57344
    s_lshl_b32 s44, s99, 4
    s_add_u32 s101, s101, s44
    s_add_u32 s101, s101, 524288
    s_cmp_eq_u32 s10, 0
    s_cselect_b32 s101, 0x7f000000, s101
    s_waitcnt lgkmcnt(0)
    v_mfma_f32_32x32x16_bf16 v[4:19], v[100:103], a[0:3], 0
    v_mfma_f32_32x32x16_bf16 v[20:35], v[100:103], a[128:131], 0
    v_mfma_f32_32x32x16_bf16 v[4:19], v[104:107], a[4:7], v[4:19]
    v_mfma_f32_32x32x16_bf16 v[20:35], v[104:107], a[132:135], v[20:35]
    v_mfma_f32_32x32x16_bf16 v[4:19], v[108:111], a[8:11], v[4:19]
    v_mfma_f32_32x32x16_bf16 v[20:35], v[108:111], a[136:139], v[20:35]
    v_mfma_f32_32x32x16_bf16 v[4:19], v[112:115], a[12:15], v[4:19]
    v_mfma_f32_32x32x16_bf16 v[20:35], v[112:115], a[140:143], v[20:35]
    v_mfma_f32_32x32x16_bf16 v[4:19], v[116:119], a[16:19], v[4:19]
    v_mfma_f32_32x32x16_bf16 v[20:35], v[116:119], a[144:147], v[20:35]
    v_mfma_f32_32x32x16_bf16 v[4:19], v[120:123], a[20:23], v[4:19]
    v_mfma_f32_32x32x16_bf16 v[20:35], v[120:123], a[148:151], v[20:35]
    v_mfma_f32_32x32x16_bf16 v[4:19], v[124:127], a[24:27], v[4:19]
    v_mfma_f32_32x32x16_bf16 v[20:35], v[124:127], a[152:155], v[20:35]
    v_mfma_f32_32x32x16_bf16 v[4:19], v[128:131], a[28:31], v[4:19]
    v_mfma_f32_32x32x16_bf16 v[20:35], v[128:131], a[156:159], v[20:35]
    v_mfma_f32_32x32x16_bf16 v[4:19], v[132:135], a[32:35], v[4:19]
    v_mfma_f32_32x32x16_bf16 v[20:35], v[132:135], a[160:163], v[20:35]
    v_mfma_f32_32x32x16_bf16 v[4:19], v[136:139], a[36:39], v[4:19]
    v_mfma_f32_32x32x16_bf16 v[20:35], v[136:139], a[164:167], v[20:35]
    v_mfma_f32_32x32x16_bf16 v[4:19], v[140:143], a[40:43], v[4:19]
    v_mfma_f32_32x32x16_bf16 v[20:35], v[140:143], a[168:171], v[20:35]
    v_mfma_f32_32x32x16_bf16 v[4:19], v[144:147], a[44:47], v[4:19]
    v_mfma_f32_32x32x16_bf16 v[20:35], v[144:147], a[172:175], v[20:35]
    v_mfma_f32_32x32x16_bf16 v[4:19], v[148:151], a[48:51], v[4:19]
    v_mfma_f32_32x32x16_bf16 v[20:35], v[148:151], a[176:179], v[20:35]
    v_mfma_f32_32x32x16_bf16 v[4:19], v[152:155], a[52:55], v[4:19]
    v_mfma_f32_32x32x16_bf16 v[20:35], v[152:155], a[180:183], v[20:35]
    v_mfma_f32_32x32x16_bf16 v[4:19], v[156:159], a[56:59], v[4:19]
    v_mfma_f32_32x32x16_bf16 v[20:35], v[156:159], a[184:187], v[20:35]
    v_mfma_f32_32x32x16_bf16 v[4:19], v[160:163], a[60:63], v[4:19]
    v_mfma_f32_32x32x16_bf16 v[20:35], v[160:163], a[188:191], v[20:35]
    s_nop 10
    v_mov_b32 v44, v4
    v_mov_b32 v45, s68
    v_mov_b32 v46, v5
    v_mov_b32 v47, s68
    v_mov_b32 v48, v20
    v_mov_b32 v49, s68
    v_mov_b32 v50, v21
    v_mov_b32 v51, s68
    s_mov_b32 s47, s101
    s_lshl_b32 s76, s80, 2
    s_add_u32 s76, s76, s79
    s_sub_u32 s76, s76, 28
    s_lshr_b32 s101, s76, 1
    s_lshl_b32 s101, s101, 2
    s_and_b32 s76, s76, 1
    s_add_u32 s76, s76, s101
    s_lshl_b32 s75, s70, 13
    s_lshl_b32 s74, s76, 15
    s_add_u32 s74, s74, s75
    s_add_u32 s74, s74, 0x00100000
    v_lshlrev_b32 v147, 4, v1
    v_lshlrev_b32 v146, 7, v1
    v_lshrrev_b32 v144, 5, v1
    v_lshlrev_b32 v144, 9, v144
    v_bfe_u32 v145, v1, 2, 2
    v_lshl_add_u32 v144, v145, 6, v144
    v_bfe_u32 v145, v1, 4, 1
    v_lshl_add_u32 v144, v145, 5, v144
    v_and_b32 v145, 3, v1
    v_lshl_add_u32 v144, v145, 3, v144
    s_lshl_b32 s75, s70, 14
    v_add_u32 v144, s75, v144
    v_mov_b32 v60, 0x3f803f80
    v_and_b32 v61, 31, v1
    v_lshlrev_b32 v62, 3, v61
    s_lshl_b32 s101, s70, 8
    s_add_u32 s101, s101, 155648
    v_add_u32 v63, s101, v62
    v_add_u32 v61, 155648, v62
    s_lshl_b32 s77, s76, 8
    s_add_u32 s77, s77, 147456
    s_cmp_lg_u32 s70, 0
    s_cselect_b32 s77, 0x7f000000, s77
    s_barrier
    v_mov_b32 v58, s3
    v_bfe_u32 v59, v1, 1, 1
    v_mul_u32_u24 v59, 0x10001, v59
    v_xor_b32 v58, v58, v59
    v_and_b32 v59, 1, v1
    v_lshlrev_b32 v59, 4, v59
    v_bfe_u32 v58, v58, v59, 1
    v_mul_u32_u24 v58, 0x10001, v58
    s_mov_b32 s78, 200000
LF_pj_40:
    buffer_load_dword v64, v146, s[4:7], s74 offen sc1
    buffer_load_dword v65, v146, s[4:7], s74 offen offset:64 sc1
    s_waitcnt vmcnt(0)
    v_bitop3_b32 v64, v64, v65, s3 bitop3:0x7e
    v_and_b32 v64, 0x00010001, v64
    v_cmp_ne_u32 vcc, 0, v64
    s_nop 1
    s_cbranch_vccz LF_pg_41
    s_sub_u32 s78, s78, 1
    s_cmp_lg_u32 s78, 0
    s_cbranch_scc1 LF_pj_40
LF_pg_41:
    s_add_u32 m0, s75, 0
    s_add_u32 s101, s74, 0
    buffer_load_dwordx4 v147, s[4:7], s101 offen offset:0 sc1 lds
    buffer_load_dwordx4 v147, s[4:7], s101 offen offset:1024 sc1 lds
    buffer_load_dwordx4 v147, s[4:7], s101 offen offset:2048 sc1 lds
    buffer_load_dwordx4 v147, s[4:7], s101 offen offset:3072 sc1 lds
    s_add_u32 m0, s75, 4096
    s_add_u32 s101, s74, 4096
    buffer_load_dwordx4 v147, s[4:7], s101 offen offset:0 sc1 lds
    buffer_load_dwordx4 v147, s[4:7], s101 offen offset:1024 sc1 lds
    buffer_load_dwordx4 v147, s[4:7], s101 offen offset:2048 sc1 lds
    buffer_load_dwordx4 v147, s[4:7], s101 offen offset:3072 sc1 lds
    s_add_u32 m0, s75, 8192
    s_add_u32 s101, s74, 65536
    buffer_load_dwordx4 v147, s[4:7], s101 offen offset:0 sc1 lds
    buffer_load_dwordx4 v147, s[4:7], s101 offen offset:1024 sc1 lds
    buffer_load_dwordx4 v147, s[4:7], s101 offen offset:2048 sc1 lds
    buffer_load_dwordx4 v147, s[4:7], s101 offen offset:3072 sc1 lds
    s_add_u32 m0, s75, 12288
    s_add_u32 s101, s74, 69632
    buffer_load_dwordx4 v147, s[4:7], s101 offen offset:0 sc1 lds
    buffer_load_dwordx4 v147, s[4:7], s101 offen offset:1024 sc1 lds
    buffer_load_dwordx4 v147, s[4:7], s101 offen offset:2048 sc1 lds
    buffer_load_dwordx4 v147, s[4:7], s101 offen offset:3072 sc1 lds
    s_mov_b32 exec_hi, 0
    buffer_store_dwordx4 v[44:47], v40, s[4:7], s47 offen offset:0 sc1
    buffer_store_dwordx4 v[48:51], v40, s[4:7], s47 offen offset:256 sc1
    s_mov_b32 exec_hi, -1
    s_waitcnt vmcnt(10)
    ds_read_b64_tr_b16 v[68:69], v144 offset:0
    ds_read_b64_tr_b16 v[70:71], v144 offset:256
    ds_read_b64_tr_b16 v[72:73], v144 offset:1024
    ds_read_b64_tr_b16 v[74:75], v144 offset:1280
    ds_read_b64_tr_b16 v[76:77], v144 offset:2048
    ds_read_b64_tr_b16 v[78:79], v144 offset:2304
    ds_read_b64_tr_b16 v[80:81], v144 offset:3072
    ds_read_b64_tr_b16 v[82:83], v144 offset:3328
    ds_read_b64_tr_b16 v[84:85], v144 offset:4096
    ds_read_b64_tr_b16 v[86:87], v144 offset:4352
    ds_read_b64_tr_b16 v[88:89], v144 offset:5120
    ds_read_b64_tr_b16 v[90:91], v144 offset:5376
    ds_read_b64_tr_b16 v[92:93], v144 offset:6144
    ds_read_b64_tr_b16 v[94:95], v144 offset:6400
    ds_read_b64_tr_b16 v[96:97], v144 offset:7168
    ds_read_b64_tr_b16 v[98:99], v144 offset:7424
    s_waitcnt lgkmcnt(12)
    v_dot2_f32_bf16 v64, v68, v60, 0
    v_dot2_f32_bf16 v65, v68, v68, 0
    v_dot2_f32_bf16 v64, v69, v60, v64
    v_dot2_f32_bf16 v65, v69, v69, v65
    v_bitop3_b32 v59, v68, v69, v58 bitop3:0x7e
    v_or_b32 v57, v59, v59
    v_dot2_f32_bf16 v64, v70, v60, v64
    v_dot2_f32_bf16 v65, v70, v70, v65
    v_dot2_f32_bf16 v64, v71, v60, v64
    v_dot2_f32_bf16 v65, v71, v71, v65
    v_bitop3_b32 v59, v70, v71, v58 bitop3:0x7e
    v_or_b32 v57, v59, v57
    v_dot2_f32_bf16 v64, v72, v60, v64
    v_dot2_f32_bf16 v65, v72, v72, v65
    v_dot2_f32_bf16 v64, v73, v60, v64
    v_dot2_f32_bf16 v65, v73, v73, v65
    v_bitop3_b32 v59, v72, v73, v58 bitop3:0x7e
    v_or_b32 v57, v59, v57
    v_dot2_f32_bf16 v64, v74, v60, v64
    v_dot2_f32_bf16 v65, v74, v74, v65
    v_dot2_f32_bf16 v64, v75, v60, v64
    v_dot2_f32_bf16 v65, v75, v75, v65
    v_bitop3_b32 v59, v74, v75, v58 bitop3:0x7e
    v_or_b32 v57, v59, v57
    s_waitcnt lgkmcnt(8)
    v_dot2_f32_bf16 v64, v76, v60, v64
    v_dot2_f32_bf16 v65, v76, v76, v65
    v_dot2_f32_bf16 v64, v77, v60, v64
    v_dot2_f32_bf16 v65, v77, v77, v65
    v_bitop3_b32 v59, v76, v77, v58 bitop3:0x7e
    v_or_b32 v57, v59, v57
    v_dot2_f32_bf16 v64, v78, v60, v64
    v_dot2_f32_bf16 v65, v78, v78, v65
    v_dot2_f32_bf16 v64, v79, v60, v64
    v_dot2_f32_bf16 v65, v79, v79, v65
    v_bitop3_b32 v59, v78, v79, v58 bitop3:0x7e
    v_or_b32 v57, v59, v57
    v_dot2_f32_bf16 v64, v80, v60, v64
    v_dot2_f32_bf16 v65, v80, v80, v65
    v_dot2_f32_bf16 v64, v81, v60, v64
    v_dot2_f32_bf16 v65, v81, v81, v65
    v_bitop3_b32 v59, v80, v81, v58 bitop3:0x7e
    v_or_b32 v57, v59, v57
    v_dot2_f32_bf16 v64, v82, v60, v64
    v_dot2_f32_bf16 v65, v82, v82, v65
    v_dot2_f32_bf16 v64, v83, v60, v64
    v_dot2_f32_bf16 v65, v83, v83, v65
    v_bitop3_b32 v59, v82, v83, v58 bitop3:0x7e
    v_or_b32 v57, v59, v57
    s_waitcnt lgkmcnt(4)
    v_dot2_f32_bf16 v64, v84, v60, v64
    v_dot2_f32_bf16 v65, v84, v84, v65
    v_dot2_f32_bf16 v64, v85, v60, v64
    v_dot2_f32_bf16 v65, v85, v85, v65
    v_bitop3_b32 v59, v84, v85, v58 bitop3:0x7e
    v_or_b32 v57, v59, v57
    v_dot2_f32_bf16 v64, v86, v60, v64
    v_dot2_f32_bf16 v65, v86, v86, v65
    v_dot2_f32_bf16 v64, v87, v60, v64
    v_dot2_f32_bf16 v65, v87, v87, v65
    v_bitop3_b32 v59, v86, v87, v58 bitop3:0x7e
    v_or_b32 v57, v59, v57
    v_dot2_f32_bf16 v64, v88, v60, v64
    v_dot2_f32_bf16 v65, v88, v88, v65
    v_dot2_f32_bf16 v64, v89, v60, v64
    v_dot2_f32_bf16 v65, v89, v89, v65
    v_bitop3_b32 v59, v88, v89, v58 bitop3:0x7e
    v_or_b32 v57, v59, v57
    v_dot2_f32_bf16 v64, v90, v60, v64
    v_dot2_f32_bf16 v65, v90, v90, v65
    v_dot2_f32_bf16 v64, v91, v60, v64
    v_dot2_f32_bf16 v65, v91, v91, v65
    v_bitop3_b32 v59, v90, v91, v58 bitop3:0x7e
    v_or_b32 v57, v59, v57
    s_waitcnt lgkmcnt(0)
    v_dot2_f32_bf16 v64, v92, v60, v64
    v_dot2_f32_bf16 v65, v92, v92, v65
    v_dot2_f32_bf16 v64, v93, v60, v64
    v_dot2_f32_bf16 v65, v93, v93, v65
    v_bitop3_b32 v59, v92, v93, v58 bitop3:0x7e
    v_or_b32 v57, v59, v57
    v_dot2_f32_bf16 v64, v94, v60, v64
    v_dot2_f32_bf16 v65, v94, v94, v65
    v_dot2_f32_bf16 v64, v95, v60, v64
    v_dot2_f32_bf16 v65, v95, v95, v65
    v_bitop3_b32 v59, v94, v95, v58 bitop3:0x7e
    v_or_b32 v57, v59, v57
    v_dot2_f32_bf16 v64, v96, v60, v64
    v_dot2_f32_bf16 v65, v96, v96, v65
    v_dot2_f32_bf16 v64, v97, v60, v64
    v_dot2_f32_bf16 v65, v97, v97, v65
    v_bitop3_b32 v59, v96, v97, v58 bitop3:0x7e
    v_or_b32 v57, v59, v57
    v_dot2_f32_bf16 v64, v98, v60, v64
    v_dot2_f32_bf16 v65, v98, v98, v65
    v_dot2_f32_bf16 v64, v99, v60, v64
    v_dot2_f32_bf16 v65, v99, v99, v65
    v_bitop3_b32 v59, v98, v99, v58 bitop3:0x7e
    v_or_b32 v57, v59, v57
    v_and_b32 v57, 0x00010001, v57
    v_cmp_ne_u32 vcc, 0, v57
    s_nop 0
    s_cbranch_vccnz LF_g2r_42
LF_g2b_44:
    v_mov_b32 v66, v64
    v_mov_b32 v67, v65
    s_nop 0
    v_permlane32_swap_b32 v64, v66
    v_permlane32_swap_b32 v65, v67
    v_add_f32 v64, v64, v66
    v_add_f32 v65, v65, v67
    ds_write_b64 v63, v[64:65] offset:0
    s_waitcnt lgkmcnt(0)
    s_barrier
    ds_read_b64 v[68:69], v61 offset:0
    ds_read_b64 v[70:71], v61 offset:256
    ds_read_b64 v[72:73], v61 offset:512
    ds_read_b64 v[74:75], v61 offset:768
    s_waitcnt lgkmcnt(0)
    v_pk_add_f32 v[68:69], v[68:69], v[70:71]
    v_pk_add_f32 v[72:73], v[72:73], v[74:75]
    v_pk_add_f32 v[68:69], v[68:69], v[72:73]
    v_mul_f32 v68, 0x3b000000, v68
    v_mul_f32 v70, v68, v68
    v_mul_f32 v69, 0x3b000000, v69
    v_sub_f32 v69, v69, v70
    v_max_f32 v69, 0, v69
    v_cvt_pk_bf16_f32 v70, v69, v69
    v_and_b32 v70, 0xffff0000, v70
    v_add_f32 v70, 0x3727c5ac, v70
    v_cvt_pk_bf16_f32 v70, v70, v70
    v_and_b32 v70, 0xffff0000, v70
    v_sqrt_f32 v70, v70
    s_nop 0
    v_cvt_pk_bf16_f32 v68, v70, v68
    v_mov_b32 v69, s68
    buffer_store_dwordx2 v[68:69], v62, s[4:7], s77 offen offset:0 sc1
    s_waitcnt vmcnt(3)
    ds_read_b64_tr_b16 v[68:69], v144 offset:8192
    ds_read_b64_tr_b16 v[70:71], v144 offset:8448
    ds_read_b64_tr_b16 v[72:73], v144 offset:9216
    ds_read_b64_tr_b16 v[74:75], v144 offset:9472
    ds_read_b64_tr_b16 v[76:77], v144 offset:10240
    ds_read_b64_tr_b16 v[78:79], v144 offset:10496
    ds_read_b64_tr_b16 v[80:81], v144 offset:11264
    ds_read_b64_tr_b16 v[82:83], v144 offset:11520
    ds_read_b64_tr_b16 v[84:85], v144 offset:12288
    ds_read_b64_tr_b16 v[86:87], v144 offset:12544
    ds_read_b64_tr_b16 v[88:89], v144 offset:13312
    ds_read_b64_tr_b16 v[90:91], v144 offset:13568
    ds_read_b64_tr_b16 v[92:93], v144 offset:14336
    ds_read_b64_tr_b16 v[94:95], v144 offset:14592
    ds_read_b64_tr_b16 v[96:97], v144 offset:15360
    ds_read_b64_tr_b16 v[98:99], v144 offset:15616
    s_waitcnt lgkmcnt(12)
    v_dot2_f32_bf16 v64, v68, v60, 0
    v_dot2_f32_bf16 v65, v68, v68, 0
    v_dot2_f32_bf16 v64, v69, v60, v64
    v_dot2_f32_bf16 v65, v69, v69, v65
    v_bitop3_b32 v59, v68, v69, v58 bitop3:0x7e
    v_or_b32 v57, v59, v59
    v_dot2_f32_bf16 v64, v70, v60, v64
    v_dot2_f32_bf16 v65, v70, v70, v65
    v_dot2_f32_bf16 v64, v71, v60, v64
    v_dot2_f32_bf16 v65, v71, v71, v65
    v_bitop3_b32 v59, v70, v71, v58 bitop3:0x7e
    v_or_b32 v57, v59, v57
    v_dot2_f32_bf16 v64, v72, v60, v64
    v_dot2_f32_bf16 v65, v72, v72, v65
    v_dot2_f32_bf16 v64, v73, v60, v64
    v_dot2_f32_bf16 v65, v73, v73, v65
    v_bitop3_b32 v59, v72, v73, v58 bitop3:0x7e
    v_or_b32 v57, v59, v57
    v_dot2_f32_bf16 v64, v74, v60, v64
    v_dot2_f32_bf16 v65, v74, v74, v65
    v_dot2_f32_bf16 v64, v75, v60, v64
    v_dot2_f32_bf16 v65, v75, v75, v65
    v_bitop3_b32 v59, v74, v75, v58 bitop3:0x7e
    v_or_b32 v57, v59, v57
    s_waitcnt lgkmcnt(8)
    v_dot2_f32_bf16 v64, v76, v60, v64
    v_dot2_f32_bf16 v65, v76, v76, v65
    v_dot2_f32_bf16 v64, v77, v60, v64
    v_dot2_f32_bf16 v65, v77, v77, v65
    v_bitop3_b32 v59, v76, v77, v58 bitop3:0x7e
    v_or_b32 v57, v59, v57
    v_dot2_f32_bf16 v64, v78, v60, v64
    v_dot2_f32_bf16 v65, v78, v78, v65
    v_dot2_f32_bf16 v64, v79, v60, v64
    v_dot2_f32_bf16 v65, v79, v79, v65
    v_bitop3_b32 v59, v78, v79, v58 bitop3:0x7e
    v_or_b32 v57, v59, v57
    v_dot2_f32_bf16 v64, v80, v60, v64
    v_dot2_f32_bf16 v65, v80, v80, v65
    v_dot2_f32_bf16 v64, v81, v60, v64
    v_dot2_f32_bf16 v65, v81, v81, v65
    v_bitop3_b32 v59, v80, v81, v58 bitop3:0x7e
    v_or_b32 v57, v59, v57
    v_dot2_f32_bf16 v64, v82, v60, v64
    v_dot2_f32_bf16 v65, v82, v82, v65
    v_dot2_f32_bf16 v64, v83, v60, v64
    v_dot2_f32_bf16 v65, v83, v83, v65
    v_bitop3_b32 v59, v82, v83, v58 bitop3:0x7e
    v_or_b32 v57, v59, v57
    s_waitcnt lgkmcnt(4)
    v_dot2_f32_bf16 v64, v84, v60, v64
    v_dot2_f32_bf16 v65, v84, v84, v65
    v_dot2_f32_bf16 v64, v85, v60, v64
    v_dot2_f32_bf16 v65, v85, v85, v65
    v_bitop3_b32 v59, v84, v85, v58 bitop3:0x7e
    v_or_b32 v57, v59, v57
    v_dot2_f32_bf16 v64, v86, v60, v64
    v_dot2_f32_bf16 v65, v86, v86, v65
    v_dot2_f32_bf16 v64, v87, v60, v64
    v_dot2_f32_bf16 v65, v87, v87, v65
    v_bitop3_b32 v59, v86, v87, v58 bitop3:0x7e
    v_or_b32 v57, v59, v57
    v_dot2_f32_bf16 v64, v88, v60, v64
    v_dot2_f32_bf16 v65, v88, v88, v65
    v_dot2_f32_bf16 v64, v89, v60, v64
    v_dot2_f32_bf16 v65, v89, v89, v65
    v_bitop3_b32 v59, v88, v89, v58 bitop3:0x7e
    v_or_b32 v57, v59, v57
    v_dot2_f32_bf16 v64, v90, v60, v64
    v_dot2_f32_bf16 v65, v90, v90, v65
    v_dot2_f32_bf16 v64, v91, v60, v64
    v_dot2_f32_bf16 v65, v91, v91, v65
    v_bitop3_b32 v59, v90, v91, v58 bitop3:0x7e
    v_or_b32 v57, v59, v57
    s_waitcnt lgkmcnt(0)
    v_dot2_f32_bf16 v64, v92, v60, v64
    v_dot2_f32_bf16 v65, v92, v92, v65
    v_dot2_f32_bf16 v64, v93, v60, v64
    v_dot2_f32_bf16 v65, v93, v93, v65
    v_bitop3_b32 v59, v92, v93, v58 bitop3:0x7e
    v_or_b32 v57, v59, v57
    v_dot2_f32_bf16 v64, v94, v60, v64
    v_dot2_f32_bf16 v65, v94, v94, v65
    v_dot2_f32_bf16 v64, v95, v60, v64
    v_dot2_f32_bf16 v65, v95, v95, v65
    v_bitop3_b32 v59, v94, v95, v58 bitop3:0x7e
    v_or_b32 v57, v59, v57
    v_dot2_f32_bf16 v64, v96, v60, v64
    v_dot2_f32_bf16 v65, v96, v96, v65
    v_dot2_f32_bf16 v64, v97, v60, v64
    v_dot2_f32_bf16 v65, v97, v97, v65
    v_bitop3_b32 v59, v96, v97, v58 bitop3:0x7e
    v_or_b32 v57, v59, v57
    v_dot2_f32_bf16 v64, v98, v60, v64
    v_dot2_f32_bf16 v65, v98, v98, v65
    v_dot2_f32_bf16 v64, v99, v60, v64
    v_dot2_f32_bf16 v65, v99, v99, v65
    v_bitop3_b32 v59, v98, v99, v58 bitop3:0x7e
    v_or_b32 v57, v59, v57
    v_and_b32 v57, 0x00010001, v57
    v_cmp_ne_u32 vcc, 0, v57
    s_nop 0
    s_cbranch_vccnz LF_g2r_45
LF_g2b_47:
    v_mov_b32 v66, v64
    v_mov_b32 v67, v65
    s_nop 0
    v_permlane32_swap_b32 v64, v66
    v_permlane32_swap_b32 v65, v67
    v_add_f32 v64, v64, v66
    v_add_f32 v65, v65, v67
    ds_write_b64 v63, v[64:65] offset:1024
    s_waitcnt lgkmcnt(0)
    s_barrier
    ds_read_b64 v[68:69], v61 offset:1024
    ds_read_b64 v[70:71], v61 offset:1280
    ds_read_b64 v[72:73], v61 offset:1536
    ds_read_b64 v[74:75], v61 offset:1792
    s_waitcnt lgkmcnt(0)
    v_pk_add_f32 v[68:69], v[68:69], v[70:71]
    v_pk_add_f32 v[72:73], v[72:73], v[74:75]
    v_pk_add_f32 v[68:69], v[68:69], v[72:73]
    v_mul_f32 v68, 0x3b000000, v68
    v_mul_f32 v70, v68, v68
    v_mul_f32 v69, 0x3b000000, v69
    v_sub_f32 v69, v69, v70
    v_max_f32 v69, 0, v69
    v_cvt_pk_bf16_f32 v70, v69, v69
    v_and_b32 v70, 0xffff0000, v70
    v_add_f32 v70, 0x3727c5ac, v70
    v_cvt_pk_bf16_f32 v70, v70, v70
    v_and_b32 v70, 0xffff0000, v70
    v_sqrt_f32 v70, v70
    s_nop 0
    v_cvt_pk_bf16_f32 v68, v70, v68
    v_mov_b32 v69, s68
    buffer_store_dwordx2 v[68:69], v62, s[4:7], s77 offen offset:512 sc1
    s_barrier
    v_mov_b32 v20, s92
    v_mov_b32 v21, s93
    s_lshr_b32 s101, s32, 3
    s_cmp_lg_u32 s70, 0
    s_cselect_b32 s101, 0x7f000000, s101
    s_add_u32 s101, s101, 131072
    buffer_store_dwordx2 v[20:21], v199, s[4:7], s101 offen sc1
    s_mul_i32 s72, s70, 458752
    s_and_b32 s101, s79, 7
    s_lshl_b32 s101, s101, 7
    s_add_u32 s72, s72, s101
    s_lshr_b32 s36, s79, 3
    s_lshl_b32 s36, s36, 1
    s_add_u32 s36, s36, s79
    s_and_b32 s36, s36, 7
    s_cmp_eq_u32 s36, 7
    s_cselect_b32 s36, 0, s36
    s_lshl_b32 s36, s36, 10
    s_add_u32 s37, s36, 1024
    s_cmp_eq_u32 s37, 7168
    s_cselect_b32 s37, 0, s37
    s_add_u32 s38, s37, 1024
    s_cmp_eq_u32 s38, 7168
    s_cselect_b32 s38, 0, s38
    s_add_u32 s39, s38, 1024
    s_cmp_eq_u32 s39, 7168
    s_cselect_b32 s39, 0, s39
    s_add_u32 s40, s39, 1024
    s_cmp_eq_u32 s40, 7168
    s_cselect_b32 s40, 0, s40
    s_add_u32 s41, s40, 1024
    s_cmp_eq_u32 s41, 7168
    s_cselect_b32 s41, 0, s41
    s_add_u32 s42, s41, 1024
    s_cmp_eq_u32 s42, 7168
    s_cselect_b32 s42, 0, s42
    s_add_u32 s28, s72, 114688
    s_add_u32 s29, s72, 229376
    s_add_u32 s30, s72, 344064
    s_mul_i32 s90, s70, 6144
    s_add_u32 s90, s90, 131072
    s_lshl_b32 s91, s70, 13
    v_lshrrev_b32 v240, 3, v1
    v_bfe_u32 v241, v1, 4, 1
    v_lshlrev_b32 v241, 2, v241
    v_and_b32 v242, 7, v1
    v_xor_b32 v241, v241, v242
    v_lshlrev_b32 v240, 10, v240
    v_lshl_add_u32 v240, v241, 4, v240
    v_add_u32 v241, 7168, v240
    v_lshrrev_b32 v242, 5, v1
    v_lshlrev_b32 v242, 10, v242
    v_bfe_u32 v243, v1, 2, 2
    v_lshl_add_u32 v242, v243, 7, v242
    v_bfe_u32 v243, v1, 3, 1
    v_lshl_add_u32 v242, v243, 6, v242
    v_and_b32 v243, 1, v1
    v_lshl_add_u32 v242, v243, 5, v242
    v_bfe_u32 v243, v1, 1, 1
    v_bfe_u32 v244, v1, 4, 1
    v_lshl_add_u32 v243, v244, 1, v243
    v_add_u32 v243, s70, v243
    v_and_b32 v243, 3, v243
    v_lshl_add_u32 v242, v243, 3, v242
    v_add_u32 v244, s91, v242
    v_xor_b32 v245, 64, v244
    v_add_u32 v246, 0x10000, v244
    v_add_u32 v247, 0x10000, v245
    v_add_u32 v242, s90, v242
    v_xor_b32 v243, 64, v242
    s_lshl_b32 s98, s80, 1
    s_bfe_u32 s44, s79, 0x10004
    s_add_u32 s98, s98, s44
    s_lshl_b32 s98, s98, 2
    s_bfe_u32 s44, s79, 0x10003
    s_sub_u32 s99, s98, s44
    s_add_u32 s99, s99, 3
    s_add_u32 s98, s98, s44
    s_and_b32 s100, s79, 7
    s_mul_i32 s86, s98, 114688
    s_mul_i32 s87, s99, 114688
    s_mul_i32 s88, s70, 28672
    s_add_u32 s88, s88, 0x00500000
    s_add_u32 s86, s86, s88
    s_add_u32 s87, s87, s88
    s_add_u32 s18, s86, 0
    s_add_u32 s22, s87, 0
    s_add_u32 s19, s86, 7168
    s_add_u32 s23, s87, 7168
    s_add_u32 s20, s86, 14336
    s_add_u32 s24, s87, 14336
    s_add_u32 s21, s86, 21504
    s_add_u32 s25, s87, 21504
    s_lshr_b32 s45, s70, 1
    s_sub_u32 s44, s99, s98
    s_mul_i32 s45, s45, s44
    s_add_u32 s45, s45, s98
    s_and_b32 s46, s70, 1
    s_lshl_b32 s46, s46, 5
    s_lshl_b32 s44, s100, 6
    s_add_u32 s46, s46, s44
    s_lshl_b32 s82, s45, 15
    s_lshl_b32 s83, s46, 6
    s_add_u32 s82, s82, s83
    s_add_u32 s82, s82, 0x00100000
    s_lshl_b32 s83, s70, 11
    s_add_u32 s83, s83, 155648
    s_add_u32 m0, s90, 0
    s_lshl4_add_u32 s15, s36, s72
    buffer_load_dwordx4 v240, s[60:63], s15 offen lds
    buffer_load_dwordx4 v241, s[60:63], s15 offen offset:1024 lds
    s_add_u32 m0, s90, 2048
    s_lshl4_add_u32 s15, s37, s72
    buffer_load_dwordx4 v240, s[60:63], s15 offen lds
    buffer_load_dwordx4 v241, s[60:63], s15 offen offset:1024 lds
    s_add_u32 m0, s90, 4096
    s_lshl4_add_u32 s15, s38, s72
    buffer_load_dwordx4 v240, s[60:63], s15 offen lds
    buffer_load_dwordx4 v241, s[60:63], s15 offen offset:1024 lds
    s_add_u32 m0, s91, 98304
    s_lshl4_add_u32 s15, s39, s72
    buffer_load_dwordx4 v240, s[60:63], s15 offen lds
    buffer_load_dwordx4 v241, s[60:63], s15 offen offset:1024 lds
    s_add_u32 m0, s91, 100352
    s_lshl4_add_u32 s15, s40, s72
    buffer_load_dwordx4 v240, s[60:63], s15 offen lds
    buffer_load_dwordx4 v241, s[60:63], s15 offen offset:1024 lds
    s_add_u32 m0, s91, 102400
    s_lshl4_add_u32 s15, s41, s72
    buffer_load_dwordx4 v240, s[60:63], s15 offen lds
    buffer_load_dwordx4 v241, s[60:63], s15 offen offset:1024 lds
    s_add_u32 m0, s91, 104448
    s_lshl4_add_u32 s15, s42, s72
    buffer_load_dwordx4 v240, s[60:63], s15 offen lds
    buffer_load_dwordx4 v241, s[60:63], s15 offen offset:1024 lds
    s_add_u32 m0, s91, 65536
    s_lshl4_add_u32 s15, s39, s28
    buffer_load_dwordx4 v240, s[60:63], s15 offen lds
    buffer_load_dwordx4 v241, s[60:63], s15 offen offset:1024 lds
    s_add_u32 m0, s91, 67584
    s_lshl4_add_u32 s15, s40, s28
    buffer_load_dwordx4 v240, s[60:63], s15 offen lds
    buffer_load_dwordx4 v241, s[60:63], s15 offen offset:1024 lds
    s_add_u32 m0, s91, 69632
    s_lshl4_add_u32 s15, s41, s28
    buffer_load_dwordx4 v240, s[60:63], s15 offen lds
    buffer_load_dwordx4 v241, s[60:63], s15 offen offset:1024 lds
    s_add_u32 m0, s91, 71680
    s_lshl4_add_u32 s15, s42, s28
    buffer_load_dwordx4 v240, s[60:63], s15 offen lds
    buffer_load_dwordx4 v241, s[60:63], s15 offen offset:1024 lds
    s_add_u32 m0, s91, 32768
    s_lshl4_add_u32 s15, s38, s29
    buffer_load_dwordx4 v240, s[60:63], s15 offen lds
    buffer_load_dwordx4 v241, s[60:63], s15 offen offset:1024 lds
    s_add_u32 m0, s91, 34816
    s_lshl4_add_u32 s15, s39, s29
    buffer_load_dwordx4 v240, s[60:63], s15 offen lds
    buffer_load_dwordx4 v241, s[60:63], s15 offen offset:1024 lds
    s_add_u32 m0, s91, 36864
    s_lshl4_add_u32 s15, s40, s29
    buffer_load_dwordx4 v240, s[60:63], s15 offen lds
    buffer_load_dwordx4 v241, s[60:63], s15 offen offset:1024 lds
    s_add_u32 m0, s91, 38912
    s_lshl4_add_u32 s15, s41, s29
    buffer_load_dwordx4 v240, s[60:63], s15 offen lds
    buffer_load_dwordx4 v241, s[60:63], s15 offen offset:1024 lds
    s_waitcnt vmcnt(0)
    ds_read_b64_tr_b16 v[200:201], v242 offset:0
    ds_read_b64_tr_b16 v[202:203], v242 offset:512
    ds_read_b64_tr_b16 v[204:205], v243 offset:0
    ds_read_b64_tr_b16 v[206:207], v243 offset:512
    ds_read_b64_tr_b16 v[208:209], v242 offset:2048
    ds_read_b64_tr_b16 v[210:211], v242 offset:2560
    ds_read_b64_tr_b16 v[212:213], v243 offset:2048
    ds_read_b64_tr_b16 v[214:215], v243 offset:2560
    ds_read_b64_tr_b16 v[216:217], v242 offset:4096
    ds_read_b64_tr_b16 v[218:219], v242 offset:4608
    ds_read_b64_tr_b16 v[220:221], v243 offset:4096
    ds_read_b64_tr_b16 v[222:223], v243 offset:4608
    ds_read_b64_tr_b16 v[224:225], v246 offset:32768
    ds_read_b64_tr_b16 v[226:227], v246 offset:33280
    ds_read_b64_tr_b16 v[228:229], v247 offset:32768
    ds_read_b64_tr_b16 v[230:231], v247 offset:33280
    ds_read_b64_tr_b16 v[232:233], v246 offset:34816
    ds_read_b64_tr_b16 v[234:235], v246 offset:35328
    ds_read_b64_tr_b16 v[236:237], v247 offset:34816
    ds_read_b64_tr_b16 v[238:239], v247 offset:35328
    ds_read_b64_tr_b16 a[0:1], v246 offset:36864
    ds_read_b64_tr_b16 a[2:3], v246 offset:37376
    ds_read_b64_tr_b16 a[128:129], v247 offset:36864
    ds_read_b64_tr_b16 a[130:131], v247 offset:37376
    ds_read_b64_tr_b16 a[4:5], v246 offset:38912
    ds_read_b64_tr_b16 a[6:7], v246 offset:39424
    ds_read_b64_tr_b16 a[132:133], v247 offset:38912
    ds_read_b64_tr_b16 a[134:135], v247 offset:39424
    ds_read_b64_tr_b16 a[20:21], v246 offset:0
    ds_read_b64_tr_b16 a[22:23], v246 offset:512
    ds_read_b64_tr_b16 a[148:149], v247 offset:0
    ds_read_b64_tr_b16 a[150:151], v247 offset:512
    ds_read_b64_tr_b16 a[24:25], v246 offset:2048
    ds_read_b64_tr_b16 a[26:27], v246 offset:2560
    ds_read_b64_tr_b16 a[152:153], v247 offset:2048
    ds_read_b64_tr_b16 a[154:155], v247 offset:2560
    ds_read_b64_tr_b16 a[28:29], v246 offset:4096
    ds_read_b64_tr_b16 a[30:31], v246 offset:4608
    ds_read_b64_tr_b16 a[156:157], v247 offset:4096
    ds_read_b64_tr_b16 a[158:159], v247 offset:4608
    s_waitcnt lgkmcnt(0)
    s_add_u32 m0, s90, 0
    s_lshl4_add_u32 s15, s36, s28
    buffer_load_dwordx4 v240, s[60:63], s15 offen lds
    buffer_load_dwordx4 v241, s[60:63], s15 offen offset:1024 lds
    s_add_u32 m0, s90, 2048
    s_lshl4_add_u32 s15, s37, s28
    buffer_load_dwordx4 v240, s[60:63], s15 offen lds
    buffer_load_dwordx4 v241, s[60:63], s15 offen offset:1024 lds
    s_add_u32 m0, s90, 4096
    s_lshl4_add_u32 s15, s38, s28
    buffer_load_dwordx4 v240, s[60:63], s15 offen lds
    buffer_load_dwordx4 v241, s[60:63], s15 offen offset:1024 lds
    s_add_u32 m0, s91, 98304
    s_lshl4_add_u32 s15, s36, s29
    buffer_load_dwordx4 v240, s[60:63], s15 offen lds
    buffer_load_dwordx4 v241, s[60:63], s15 offen offset:1024 lds
    s_add_u32 m0, s91, 100352
    s_lshl4_add_u32 s15, s37, s29
    buffer_load_dwordx4 v240, s[60:63], s15 offen lds
    buffer_load_dwordx4 v241, s[60:63], s15 offen offset:1024 lds
    s_add_u32 m0, s91, 102400
    s_lshl4_add_u32 s15, s42, s29
    buffer_load_dwordx4 v240, s[60:63], s15 offen lds
    buffer_load_dwordx4 v241, s[60:63], s15 offen offset:1024 lds
    s_add_u32 m0, s91, 104448
    s_lshl4_add_u32 s15, s36, s30
    buffer_load_dwordx4 v240, s[60:63], s15 offen lds
    buffer_load_dwordx4 v241, s[60:63], s15 offen offset:1024 lds
    s_add_u32 m0, s91, 65536
    s_lshl4_add_u32 s15, s40, s30
    buffer_load_dwordx4 v240, s[60:63], s15 offen lds
    buffer_load_dwordx4 v241, s[60:63], s15 offen offset:1024 lds
    s_add_u32 m0, s91, 67584
    s_lshl4_add_u32 s15, s41, s30
    buffer_load_dwordx4 v240, s[60:63], s15 offen lds
    buffer_load_dwordx4 v241, s[60:63], s15 offen offset:1024 lds
    s_add_u32 m0, s91, 69632
    s_lshl4_add_u32 s15, s42, s30
    buffer_load_dwordx4 v240, s[60:63], s15 offen lds
    buffer_load_dwordx4 v241, s[60:63], s15 offen offset:1024 lds
    s_waitcnt vmcnt(0)
    ds_read_b64_tr_b16 a[8:9], v242 offset:0
    ds_read_b64_tr_b16 a[10:11], v242 offset:512
    ds_read_b64_tr_b16 a[136:137], v243 offset:0
    ds_read_b64_tr_b16 a[138:139], v243 offset:512
    ds_read_b64_tr_b16 a[12:13], v242 offset:2048
    ds_read_b64_tr_b16 a[14:15], v242 offset:2560
    ds_read_b64_tr_b16 a[140:141], v243 offset:2048
    ds_read_b64_tr_b16 a[142:143], v243 offset:2560
    ds_read_b64_tr_b16 a[16:17], v242 offset:4096
    ds_read_b64_tr_b16 a[18:19], v242 offset:4608
    ds_read_b64_tr_b16 a[144:145], v243 offset:4096
    ds_read_b64_tr_b16 a[146:147], v243 offset:4608
    s_waitcnt lgkmcnt(0)
    s_add_u32 m0, s90, 0
    s_lshl4_add_u32 s15, s37, s30
    buffer_load_dwordx4 v240, s[60:63], s15 offen lds
    buffer_load_dwordx4 v241, s[60:63], s15 offen offset:1024 lds
    s_add_u32 m0, s90, 2048
    s_lshl4_add_u32 s15, s38, s30
    buffer_load_dwordx4 v240, s[60:63], s15 offen lds
    buffer_load_dwordx4 v241, s[60:63], s15 offen offset:1024 lds
    s_add_u32 m0, s90, 4096
    s_lshl4_add_u32 s15, s39, s30
    buffer_load_dwordx4 v240, s[60:63], s15 offen lds
    buffer_load_dwordx4 v241, s[60:63], s15 offen offset:1024 lds
    s_waitcnt vmcnt(0)
    s_waitcnt lgkmcnt(0)
    v_min_u32 v140, 27, v1
    v_lshlrev_b32 v140, 10, v140
    buffer_load_dword v144, v140, s[4:7], s86 offen sc1
    s_waitcnt vmcnt(0)
    v_xor_b32 v144, s3, v144
    v_and_b32 v144, 0x00010001, v144
    v_cmp_ne_u32 vcc, 0, v144
    s_nop 0
    s_cbranch_vccnz LF_far_48
LF_fab_50:
    s_add_u32 s47, s36, s18
    buffer_load_dwordx4 v[36:39], v147, s[4:7], s47 offen sc1
    s_add_u32 s47, s37, s18
    buffer_load_dwordx4 v[40:43], v147, s[4:7], s47 offen sc1
    s_add_u32 s47, s38, s18
    buffer_load_dwordx4 v[44:47], v147, s[4:7], s47 offen sc1
    s_add_u32 s47, s39, s18
    buffer_load_dwordx4 v[48:51], v147, s[4:7], s47 offen sc1
    s_add_u32 s47, s40, s18
    buffer_load_dwordx4 v[52:55], v147, s[4:7], s47 offen sc1
    s_add_u32 s47, s41, s18
    buffer_load_dwordx4 v[56:59], v147, s[4:7], s47 offen sc1
    s_add_u32 s47, s42, s18
    buffer_load_dwordx4 v[60:63], v147, s[4:7], s47 offen sc1
    s_add_u32 s47, s36, s19
    buffer_load_dwordx4 v[64:67], v147, s[4:7], s47 offen sc1
    s_add_u32 s47, s37, s19
    buffer_load_dwordx4 v[68:71], v147, s[4:7], s47 offen sc1
    s_add_u32 s47, s38, s19
    buffer_load_dwordx4 v[72:75], v147, s[4:7], s47 offen sc1
    s_add_u32 s47, s39, s19
    buffer_load_dwordx4 v[76:79], v147, s[4:7], s47 offen sc1
    s_add_u32 s47, s40, s19
    buffer_load_dwordx4 v[80:83], v147, s[4:7], s47 offen sc1
    s_add_u32 s47, s41, s19
    buffer_load_dwordx4 v[84:87], v147, s[4:7], s47 offen sc1
    s_add_u32 s47, s42, s19
    buffer_load_dwordx4 v[88:91], v147, s[4:7], s47 offen sc1
    s_add_u32 s47, s36, s20
    buffer_load_dwordx4 v[92:95], v147, s[4:7], s47 offen sc1
    s_add_u32 s47, s37, s20
    buffer_load_dwordx4 v[96:99], v147, s[4:7], s47 offen sc1
    s_waitcnt vmcnt(0)
    s_branch F_g2
LF_hcr_51:
    s_mov_b32 s78, 200000
LF_hcl_52:
    s_add_u32 s47, s36, s18
    buffer_load_dwordx4 v[36:39], v182, s[4:7], s47 offen sc1
    s_add_u32 s47, s37, s18
    buffer_load_dwordx4 v[40:43], v182, s[4:7], s47 offen sc1
    s_add_u32 s47, s38, s18
    buffer_load_dwordx4 v[44:47], v182, s[4:7], s47 offen sc1
    s_add_u32 s47, s39, s18
    buffer_load_dwordx4 v[48:51], v182, s[4:7], s47 offen sc1
    s_add_u32 s47, s40, s18
    buffer_load_dwordx4 v[52:55], v182, s[4:7], s47 offen sc1
    s_add_u32 s47, s41, s18
    buffer_load_dwordx4 v[56:59], v182, s[4:7], s47 offen sc1
    s_add_u32 s47, s42, s18
    buffer_load_dwordx4 v[60:63], v182, s[4:7], s47 offen sc1
    s_waitcnt vmcnt(0)
    v_xor_b32 v189, s3, v36
    v_bitop3_b32 v189, v189, v37, s31 bitop3:0xf6
    v_bitop3_b32 v189, v189, v40, s3 bitop3:0xf6
    v_bitop3_b32 v189, v189, v41, s31 bitop3:0xf6
    v_bitop3_b32 v189, v189, v44, s3 bitop3:0xf6
    v_bitop3_b32 v189, v189, v45, s31 bitop3:0xf6
    v_bitop3_b32 v189, v189, v48, s3 bitop3:0xf6
    v_bitop3_b32 v189, v189, v49, s31 bitop3:0xf6
    v_bitop3_b32 v189, v189, v52, s3 bitop3:0xf6
    v_bitop3_b32 v189, v189, v53, s31 bitop3:0xf6
    v_bitop3_b32 v189, v189, v56, s3 bitop3:0xf6
    v_bitop3_b32 v189, v189, v57, s31 bitop3:0xf6
    v_bitop3_b32 v189, v189, v60, s3 bitop3:0xf6
    v_bitop3_b32 v189, v189, v61, s31 bitop3:0xf6
    v_and_b32 v189, 0x00010001, v189
    v_cmp_ne_u32 vcc, 0, v189
    s_nop 1
    s_cbranch_vccz LF_hcb_53
    s_sub_u32 s78, s78, 1
    s_cmp_lg_u32 s78, 0
    s_cbranch_scc1 LF_hcl_52
    s_branch LF_hcb_53
LF_hcr_54:
    s_mov_b32 s78, 200000
LF_hcl_55:
    s_add_u32 s47, s36, s19
    buffer_load_dwordx4 v[64:67], v182, s[4:7], s47 offen sc1
    s_add_u32 s47, s37, s19
    buffer_load_dwordx4 v[68:71], v182, s[4:7], s47 offen sc1
    s_add_u32 s47, s38, s19
    buffer_load_dwordx4 v[72:75], v182, s[4:7], s47 offen sc1
    s_add_u32 s47, s39, s19
    buffer_load_dwordx4 v[76:79], v182, s[4:7], s47 offen sc1
    s_add_u32 s47, s40, s19
    buffer_load_dwordx4 v[80:83], v182, s[4:7], s47 offen sc1
    s_add_u32 s47, s41, s19
    buffer_load_dwordx4 v[84:87], v182, s[4:7], s47 offen sc1
    s_add_u32 s47, s42, s19
    buffer_load_dwordx4 v[88:91], v182, s[4:7], s47 offen sc1
    s_waitcnt vmcnt(0)
    v_xor_b32 v189, s3, v64
    v_bitop3_b32 v189, v189, v65, s31 bitop3:0xf6
    v_bitop3_b32 v189, v189, v68, s3 bitop3:0xf6
    v_bitop3_b32 v189, v189, v69, s31 bitop3:0xf6
    v_bitop3_b32 v189, v189, v72, s3 bitop3:0xf6
    v_bitop3_b32 v189, v189, v73, s31 bitop3:0xf6
    v_bitop3_b32 v189, v189, v76, s3 bitop3:0xf6
    v_bitop3_b32 v189, v189, v77, s31 bitop3:0xf6
    v_bitop3_b32 v189, v189, v80, s3 bitop3:0xf6
    v_bitop3_b32 v189, v189, v81, s31 bitop3:0xf6
    v_bitop3_b32 v189, v189, v84, s3 bitop3:0xf6
    v_bitop3_b32 v189, v189, v85, s31 bitop3:0xf6
    v_bitop3_b32 v189, v189, v88, s3 bitop3:0xf6
    v_bitop3_b32 v189, v189, v89, s31 bitop3:0xf6
    v_and_b32 v189, 0x00010001, v189
    v_cmp_ne_u32 vcc, 0, v189
    s_nop 1
    s_cbranch_vccz LF_hcb_56
    s_sub_u32 s78, s78, 1
    s_cmp_lg_u32 s78, 0
    s_cbranch_scc1 LF_hcl_55
    s_branch LF_hcb_56
LF_hcr_59:
    s_mov_b32 s78, 200000
LF_hcl_60:
    s_add_u32 s47, s36, s20
    buffer_load_dwordx4 v[92:95], v182, s[4:7], s47 offen sc1
    s_add_u32 s47, s37, s20
    buffer_load_dwordx4 v[96:99], v182, s[4:7], s47 offen sc1
    s_add_u32 s47, s38, s20
    buffer_load_dwordx4 v[100:103], v182, s[4:7], s47 offen sc1
    s_add_u32 s47, s39, s20
    buffer_load_dwordx4 v[104:107], v182, s[4:7], s47 offen sc1
    s_add_u32 s47, s40, s20
    buffer_load_dwordx4 v[108:111], v182, s[4:7], s47 offen sc1
    s_add_u32 s47, s41, s20
    buffer_load_dwordx4 v[112:115], v182, s[4:7], s47 offen sc1
    s_add_u32 s47, s42, s20
    buffer_load_dwordx4 v[116:119], v182, s[4:7], s47 offen sc1
    s_waitcnt vmcnt(0)
    v_xor_b32 v189, s3, v92
    v_bitop3_b32 v189, v189, v93, s31 bitop3:0xf6
    v_bitop3_b32 v189, v189, v96, s3 bitop3:0xf6
    v_bitop3_b32 v189, v189, v97, s31 bitop3:0xf6
    v_bitop3_b32 v189, v189, v100, s3 bitop3:0xf6
    v_bitop3_b32 v189, v189, v101, s31 bitop3:0xf6
    v_bitop3_b32 v189, v189, v104, s3 bitop3:0xf6
    v_bitop3_b32 v189, v189, v105, s31 bitop3:0xf6
    v_bitop3_b32 v189, v189, v108, s3 bitop3:0xf6
    v_bitop3_b32 v189, v189, v109, s31 bitop3:0xf6
    v_bitop3_b32 v189, v189, v112, s3 bitop3:0xf6
    v_bitop3_b32 v189, v189, v113, s31 bitop3:0xf6
    v_bitop3_b32 v189, v189, v116, s3 bitop3:0xf6
    v_bitop3_b32 v189, v189, v117, s31 bitop3:0xf6
    v_and_b32 v189, 0x00010001, v189
    v_cmp_ne_u32 vcc, 0, v189
    s_nop 1
    s_cbranch_vccz LF_hcb_61
    s_sub_u32 s78, s78, 1
    s_cmp_lg_u32 s78, 0
    s_cbranch_scc1 LF_hcl_60
    s_branch LF_hcb_61
LF_hcr_62:
    s_mov_b32 s78, 200000
LF_hcl_63:
    s_add_u32 s47, s36, s21
    buffer_load_dwordx4 v[120:123], v182, s[4:7], s47 offen sc1
    s_add_u32 s47, s37, s21
    buffer_load_dwordx4 v[124:127], v182, s[4:7], s47 offen sc1
    s_add_u32 s47, s38, s21
    buffer_load_dwordx4 v[128:131], v182, s[4:7], s47 offen sc1
    s_add_u32 s47, s39, s21
    buffer_load_dwordx4 v[132:135], v182, s[4:7], s47 offen sc1
    s_add_u32 s47, s40, s21
    buffer_load_dwordx4 v[136:139], v182, s[4:7], s47 offen sc1
    s_add_u32 s47, s41, s21
    buffer_load_dwordx4 a[92:95], v182, s[4:7], s47 offen sc1
    s_add_u32 s47, s42, s21
    buffer_load_dwordx4 a[96:99], v182, s[4:7], s47 offen sc1
    s_waitcnt vmcnt(0)
    v_xor_b32 v189, s3, v120
    v_bitop3_b32 v189, v189, v121, s31 bitop3:0xf6
    v_bitop3_b32 v189, v189, v124, s3 bitop3:0xf6
    v_bitop3_b32 v189, v189, v125, s31 bitop3:0xf6
    v_bitop3_b32 v189, v189, v128, s3 bitop3:0xf6
    v_bitop3_b32 v189, v189, v129, s31 bitop3:0xf6
    v_bitop3_b32 v189, v189, v132, s3 bitop3:0xf6
    v_bitop3_b32 v189, v189, v133, s31 bitop3:0xf6
    v_bitop3_b32 v189, v189, v136, s3 bitop3:0xf6
    v_bitop3_b32 v189, v189, v137, s31 bitop3:0xf6
    v_accvgpr_read_b32 v190, a92
    v_accvgpr_read_b32 v191, a93
    v_bitop3_b32 v189, v189, v190, s3 bitop3:0xf6
    v_bitop3_b32 v189, v189, v191, s31 bitop3:0xf6
    v_accvgpr_read_b32 v190, a96
    v_accvgpr_read_b32 v191, a97
    v_bitop3_b32 v189, v189, v190, s3 bitop3:0xf6
    v_bitop3_b32 v189, v189, v191, s31 bitop3:0xf6
    v_and_b32 v189, 0x00010001, v189
    v_cmp_ne_u32 vcc, 0, v189
    s_nop 1
    s_cbranch_vccz LF_hcb_64
    s_sub_u32 s78, s78, 1
    s_cmp_lg_u32 s78, 0
    s_cbranch_scc1 LF_hcl_63
    s_branch LF_hcb_64
LF_hcr_65:
    s_mov_b32 s78, 200000
LF_hcl_66:
    s_add_u32 s47, s36, s22
    buffer_load_dwordx4 a[100:103], v182, s[4:7], s47 offen sc1
    s_add_u32 s47, s37, s22
    buffer_load_dwordx4 a[104:107], v182, s[4:7], s47 offen sc1
    s_add_u32 s47, s38, s22
    buffer_load_dwordx4 a[108:111], v182, s[4:7], s47 offen sc1
    s_add_u32 s47, s39, s22
    buffer_load_dwordx4 a[112:115], v182, s[4:7], s47 offen sc1
    s_add_u32 s47, s40, s22
    buffer_load_dwordx4 a[116:119], v182, s[4:7], s47 offen sc1
    s_add_u32 s47, s41, s22
    buffer_load_dwordx4 a[120:123], v182, s[4:7], s47 offen sc1
    s_add_u32 s47, s42, s22
    buffer_load_dwordx4 a[124:127], v182, s[4:7], s47 offen sc1
    s_waitcnt vmcnt(0)
    v_accvgpr_read_b32 v190, a100
    v_accvgpr_read_b32 v191, a101
    v_xor_b32 v189, s3, v190
    v_bitop3_b32 v189, v189, v191, s31 bitop3:0xf6
    v_accvgpr_read_b32 v190, a104
    v_accvgpr_read_b32 v191, a105
    v_bitop3_b32 v189, v189, v190, s3 bitop3:0xf6
    v_bitop3_b32 v189, v189, v191, s31 bitop3:0xf6
    v_accvgpr_read_b32 v190, a108
    v_accvgpr_read_b32 v191, a109
    v_bitop3_b32 v189, v189, v190, s3 bitop3:0xf6
    v_bitop3_b32 v189, v189, v191, s31 bitop3:0xf6
    v_accvgpr_read_b32 v190, a112
    v_accvgpr_read_b32 v191, a113
    v_bitop3_b32 v189, v189, v190, s3 bitop3:0xf6
    v_bitop3_b32 v189, v189, v191, s31 bitop3:0xf6
    v_accvgpr_read_b32 v190, a116
    v_accvgpr_read_b32 v191, a117
    v_bitop3_b32 v189, v189, v190, s3 bitop3:0xf6
    v_bitop3_b32 v189, v189, v191, s31 bitop3:0xf6
    v_accvgpr_read_b32 v190, a120
    v_accvgpr_read_b32 v191, a121
    v_bitop3_b32 v189, v189, v190, s3 bitop3:0xf6
    v_bitop3_b32 v189, v189, v191, s31 bitop3:0xf6
    v_accvgpr_read_b32 v190, a124
    v_accvgpr_read_b32 v191, a125
    v_bitop3_b32 v189, v189, v190, s3 bitop3:0xf6
    v_bitop3_b32 v189, v189, v191, s31 bitop3:0xf6
    v_and_b32 v189, 0x00010001, v189
    v_cmp_ne_u32 vcc, 0, v189
    s_nop 1
    s_cbranch_vccz LF_hcb_67
    s_sub_u32 s78, s78, 1
    s_cmp_lg_u32 s78, 0
    s_cbranch_scc1 LF_hcl_66
    s_branch LF_hcb_67
LF_hcr_70:
    s_mov_b32 s78, 200000
LF_hcl_71:
    s_add_u32 s47, s36, s20
    buffer_load_dwordx4 v[92:95], v182, s[4:7], s47 offen sc1
    s_add_u32 s47, s37, s20
    buffer_load_dwordx4 v[96:99], v182, s[4:7], s47 offen sc1
    s_add_u32 s47, s38, s20
    buffer_load_dwordx4 v[100:103], v182, s[4:7], s47 offen sc1
    s_add_u32 s47, s39, s20
    buffer_load_dwordx4 v[104:107], v182, s[4:7], s47 offen sc1
    s_add_u32 s47, s40, s20
    buffer_load_dwordx4 v[108:111], v182, s[4:7], s47 offen sc1
    s_add_u32 s47, s41, s20
    buffer_load_dwordx4 v[112:115], v182, s[4:7], s47 offen sc1
    s_add_u32 s47, s42, s20
    buffer_load_dwordx4 v[116:119], v182, s[4:7], s47 offen sc1
    s_waitcnt vmcnt(0)
    v_xor_b32 v189, s3, v92
    v_bitop3_b32 v189, v189, v93, s31 bitop3:0xf6
    v_bitop3_b32 v189, v189, v96, s3 bitop3:0xf6
    v_bitop3_b32 v189, v189, v97, s31 bitop3:0xf6
    v_bitop3_b32 v189, v189, v100, s3 bitop3:0xf6
    v_bitop3_b32 v189, v189, v101, s31 bitop3:0xf6
    v_bitop3_b32 v189, v189, v104, s3 bitop3:0xf6
    v_bitop3_b32 v189, v189, v105, s31 bitop3:0xf6
    v_bitop3_b32 v189, v189, v108, s3 bitop3:0xf6
    v_bitop3_b32 v189, v189, v109, s31 bitop3:0xf6
    v_bitop3_b32 v189, v189, v112, s3 bitop3:0xf6
    v_bitop3_b32 v189, v189, v113, s31 bitop3:0xf6
    v_bitop3_b32 v189, v189, v116, s3 bitop3:0xf6
    v_bitop3_b32 v189, v189, v117, s31 bitop3:0xf6
    v_and_b32 v189, 0x00010001, v189
    v_cmp_ne_u32 vcc, 0, v189
    s_nop 1
    s_cbranch_vccz LF_hcb_72
    s_sub_u32 s78, s78, 1
    s_cmp_lg_u32 s78, 0
    s_cbranch_scc1 LF_hcl_71
    s_branch LF_hcb_72
LF_hcr_73:
    s_mov_b32 s78, 200000
LF_hcl_74:
    s_add_u32 s47, s36, s21
    buffer_load_dwordx4 v[120:123], v182, s[4:7], s47 offen sc1
    s_add_u32 s47, s37, s21
    buffer_load_dwordx4 v[124:127], v182, s[4:7], s47 offen sc1
    s_add_u32 s47, s38, s21
    buffer_load_dwordx4 v[128:131], v182, s[4:7], s47 offen sc1
    s_add_u32 s47, s39, s21
    buffer_load_dwordx4 v[132:135], v182, s[4:7], s47 offen sc1
    s_add_u32 s47, s40, s21
    buffer_load_dwordx4 v[136:139], v182, s[4:7], s47 offen sc1
    s_add_u32 s47, s41, s21
    buffer_load_dwordx4 a[92:95], v182, s[4:7], s47 offen sc1
    s_add_u32 s47, s42, s21
    buffer_load_dwordx4 a[96:99], v182, s[4:7], s47 offen sc1
    s_waitcnt vmcnt(0)
    v_xor_b32 v189, s3, v120
    v_bitop3_b32 v189, v189, v121, s31 bitop3:0xf6
    v_bitop3_b32 v189, v189, v124, s3 bitop3:0xf6
    v_bitop3_b32 v189, v189, v125, s31 bitop3:0xf6
    v_bitop3_b32 v189, v189, v128, s3 bitop3:0xf6
    v_bitop3_b32 v189, v189, v129, s31 bitop3:0xf6
    v_bitop3_b32 v189, v189, v132, s3 bitop3:0xf6
    v_bitop3_b32 v189, v189, v133, s31 bitop3:0xf6
    v_bitop3_b32 v189, v189, v136, s3 bitop3:0xf6
    v_bitop3_b32 v189, v189, v137, s31 bitop3:0xf6
    v_accvgpr_read_b32 v190, a92
    v_accvgpr_read_b32 v191, a93
    v_bitop3_b32 v189, v189, v190, s3 bitop3:0xf6
    v_bitop3_b32 v189, v189, v191, s31 bitop3:0xf6
    v_accvgpr_read_b32 v190, a96
    v_accvgpr_read_b32 v191, a97
    v_bitop3_b32 v189, v189, v190, s3 bitop3:0xf6
    v_bitop3_b32 v189, v189, v191, s31 bitop3:0xf6
    v_and_b32 v189, 0x00010001, v189
    v_cmp_ne_u32 vcc, 0, v189
    s_nop 1
    s_cbranch_vccz LF_hcb_75
    s_sub_u32 s78, s78, 1
    s_cmp_lg_u32 s78, 0
    s_cbranch_scc1 LF_hcl_74
    s_branch LF_hcb_75
LF_hcr_76:
    s_mov_b32 s78, 200000
LF_hcl_77:
    s_add_u32 s47, s36, s22
    buffer_load_dwordx4 a[100:103], v182, s[4:7], s47 offen sc1
    s_add_u32 s47, s37, s22
    buffer_load_dwordx4 a[104:107], v182, s[4:7], s47 offen sc1
    s_add_u32 s47, s38, s22
    buffer_load_dwordx4 a[108:111], v182, s[4:7], s47 offen sc1
    s_add_u32 s47, s39, s22
    buffer_load_dwordx4 a[112:115], v182, s[4:7], s47 offen sc1
    s_add_u32 s47, s40, s22
    buffer_load_dwordx4 a[116:119], v182, s[4:7], s47 offen sc1
    s_add_u32 s47, s41, s22
    buffer_load_dwordx4 a[120:123], v182, s[4:7], s47 offen sc1
    s_add_u32 s47, s42, s22
    buffer_load_dwordx4 a[124:127], v182, s[4:7], s47 offen sc1
    s_waitcnt vmcnt(0)
    v_accvgpr_read_b32 v190, a100
    v_accvgpr_read_b32 v191, a101
    v_xor_b32 v189, s3, v190
    v_bitop3_b32 v189, v189, v191, s31 bitop3:0xf6
    v_accvgpr_read_b32 v190, a104
    v_accvgpr_read_b32 v191, a105
    v_bitop3_b32 v189, v189, v190, s3 bitop3:0xf6
    v_bitop3_b32 v189, v189, v191, s31 bitop3:0xf6
    v_accvgpr_read_b32 v190, a108
    v_accvgpr_read_b32 v191, a109
    v_bitop3_b32 v189, v189, v190, s3 bitop3:0xf6
    v_bitop3_b32 v189, v189, v191, s31 bitop3:0xf6
    v_accvgpr_read_b32 v190, a112
    v_accvgpr_read_b32 v191, a113
    v_bitop3_b32 v189, v189, v190, s3 bitop3:0xf6
    v_bitop3_b32 v189, v189, v191, s31 bitop3:0xf6
    v_accvgpr_read_b32 v190, a116
    v_accvgpr_read_b32 v191, a117
    v_bitop3_b32 v189, v189, v190, s3 bitop3:0xf6
    v_bitop3_b32 v189, v189, v191, s31 bitop3:0xf6
    v_accvgpr_read_b32 v190, a120
    v_accvgpr_read_b32 v191, a121
    v_bitop3_b32 v189, v189, v190, s3 bitop3:0xf6
    v_bitop3_b32 v189, v189, v191, s31 bitop3:0xf6
    v_accvgpr_read_b32 v190, a124
    v_accvgpr_read_b32 v191, a125
    v_bitop3_b32 v189, v189, v190, s3 bitop3:0xf6
    v_bitop3_b32 v189, v189, v191, s31 bitop3:0xf6
    v_and_b32 v189, 0x00010001, v189
    v_cmp_ne_u32 vcc, 0, v189
    s_nop 1
    s_cbranch_vccz LF_hcb_78
    s_sub_u32 s78, s78, 1
    s_cmp_lg_u32 s78, 0
    s_cbranch_scc1 LF_hcl_77
    s_branch LF_hcb_78
LF_g2slow_57:
    s_waitcnt vmcnt(0)
    ds_read_b64_tr_b16 a[32:33], v246 offset:6144
    ds_read_b64_tr_b16 a[34:35], v246 offset:6656
    ds_read_b64_tr_b16 a[160:161], v247 offset:6144
    ds_read_b64_tr_b16 a[162:163], v247 offset:6656
    ds_read_b64_tr_b16 a[36:37], v246 offset:32768
    ds_read_b64_tr_b16 a[38:39], v246 offset:33280
    ds_read_b64_tr_b16 a[164:165], v247 offset:32768
    ds_read_b64_tr_b16 a[166:167], v247 offset:33280
    ds_read_b64_tr_b16 a[40:41], v246 offset:34816
    ds_read_b64_tr_b16 a[42:43], v246 offset:35328
    ds_read_b64_tr_b16 a[168:169], v247 offset:34816
    ds_read_b64_tr_b16 a[170:171], v247 offset:35328
    ds_read_b64_tr_b16 a[44:45], v244 offset:32768
    ds_read_b64_tr_b16 a[46:47], v244 offset:33280
    ds_read_b64_tr_b16 a[172:173], v245 offset:32768
    ds_read_b64_tr_b16 a[174:175], v245 offset:33280
    ds_read_b64_tr_b16 a[48:49], v244 offset:34816
    ds_read_b64_tr_b16 a[50:51], v244 offset:35328
    ds_read_b64_tr_b16 a[176:177], v245 offset:34816
    ds_read_b64_tr_b16 a[178:179], v245 offset:35328
    ds_read_b64_tr_b16 a[52:53], v244 offset:36864
    ds_read_b64_tr_b16 a[54:55], v244 offset:37376
    ds_read_b64_tr_b16 a[180:181], v245 offset:36864
    ds_read_b64_tr_b16 a[182:183], v245 offset:37376
    ds_read_b64_tr_b16 a[56:57], v244 offset:38912
    ds_read_b64_tr_b16 a[58:59], v244 offset:39424
    ds_read_b64_tr_b16 a[184:185], v245 offset:38912
    ds_read_b64_tr_b16 a[186:187], v245 offset:39424
    ds_read_b64_tr_b16 a[60:61], v246 offset:36864
    ds_read_b64_tr_b16 a[62:63], v246 offset:37376
    ds_read_b64_tr_b16 a[188:189], v247 offset:36864
    ds_read_b64_tr_b16 a[190:191], v247 offset:37376
    ds_read_b64_tr_b16 a[64:65], v246 offset:38912
    ds_read_b64_tr_b16 a[66:67], v246 offset:39424
    ds_read_b64_tr_b16 a[192:193], v247 offset:38912
    ds_read_b64_tr_b16 a[194:195], v247 offset:39424
    ds_read_b64_tr_b16 a[68:69], v242 offset:0
    ds_read_b64_tr_b16 a[70:71], v242 offset:512
    ds_read_b64_tr_b16 a[196:197], v243 offset:0
    ds_read_b64_tr_b16 a[198:199], v243 offset:512
    ds_read_b64_tr_b16 a[72:73], v242 offset:2048
    ds_read_b64_tr_b16 a[74:75], v242 offset:2560
    ds_read_b64_tr_b16 a[200:201], v243 offset:2048
    ds_read_b64_tr_b16 a[202:203], v243 offset:2560
    ds_read_b64_tr_b16 a[76:77], v242 offset:4096
    ds_read_b64_tr_b16 a[78:79], v242 offset:4608
    ds_read_b64_tr_b16 a[204:205], v243 offset:4096
    ds_read_b64_tr_b16 a[206:207], v243 offset:4608
    ds_read_b64_tr_b16 a[80:81], v246 offset:0
    ds_read_b64_tr_b16 a[82:83], v246 offset:512
    ds_read_b64_tr_b16 a[208:209], v247 offset:0
    ds_read_b64_tr_b16 a[210:211], v247 offset:512
    ds_read_b64_tr_b16 a[84:85], v246 offset:2048
    ds_read_b64_tr_b16 a[86:87], v246 offset:2560
    ds_read_b64_tr_b16 a[212:213], v247 offset:2048
    ds_read_b64_tr_b16 a[214:215], v247 offset:2560
    ds_read_b64_tr_b16 a[88:89], v246 offset:4096
    ds_read_b64_tr_b16 a[90:91], v246 offset:4608
    ds_read_b64_tr_b16 a[216:217], v247 offset:4096
    ds_read_b64_tr_b16 a[218:219], v247 offset:4608
    buffer_load_dword v184, v183, s[4:7], s87 offen sc1
    s_waitcnt lgkmcnt(0)
    v_mfma_f32_32x32x16_bf16 v[4:19], a[12:15], v[68:71], v[4:19]
    v_mfma_f32_32x32x16_bf16 v[20:35], a[140:143], v[68:71], v[20:35]
    v_mfma_f32_32x32x16_bf16 v[4:19], a[16:19], v[72:75], v[4:19]
    v_mfma_f32_32x32x16_bf16 v[20:35], a[144:147], v[72:75], v[20:35]
    v_mfma_f32_32x32x16_bf16 v[4:19], a[20:23], v[76:79], v[4:19]
    v_mfma_f32_32x32x16_bf16 v[20:35], a[148:151], v[76:79], v[20:35]
    v_mfma_f32_32x32x16_bf16 v[4:19], a[24:27], v[80:83], v[4:19]
    v_mfma_f32_32x32x16_bf16 v[20:35], a[152:155], v[80:83], v[20:35]
    v_mfma_f32_32x32x16_bf16 v[4:19], a[28:31], v[84:87], v[4:19]
    v_mfma_f32_32x32x16_bf16 v[20:35], a[156:159], v[84:87], v[20:35]
    v_mfma_f32_32x32x16_bf16 v[4:19], a[32:35], v[88:91], v[4:19]
    v_mfma_f32_32x32x16_bf16 v[20:35], a[160:163], v[88:91], v[20:35]
    v_xor_b32 v189, s3, v92
    v_bitop3_b32 v189, v189, v93, s31 bitop3:0xf6
    v_bitop3_b32 v189, v189, v96, s3 bitop3:0xf6
    v_bitop3_b32 v189, v189, v97, s31 bitop3:0xf6
    v_bitop3_b32 v189, v189, v100, s3 bitop3:0xf6
    v_bitop3_b32 v189, v189, v101, s31 bitop3:0xf6
    v_bitop3_b32 v189, v189, v104, s3 bitop3:0xf6
    v_bitop3_b32 v189, v189, v105, s31 bitop3:0xf6
    v_bitop3_b32 v189, v189, v108, s3 bitop3:0xf6
    v_bitop3_b32 v189, v189, v109, s31 bitop3:0xf6
    v_bitop3_b32 v189, v189, v112, s3 bitop3:0xf6
    v_bitop3_b32 v189, v189, v113, s31 bitop3:0xf6
    v_bitop3_b32 v189, v189, v116, s3 bitop3:0xf6
    v_bitop3_b32 v189, v189, v117, s31 bitop3:0xf6
    v_and_b32 v189, 0x00010001, v189
    v_cmp_ne_u32 vcc, 0, v189
    s_nop 0
    s_cbranch_vccnz LF_hcr_70
LF_hcb_72:
    v_mfma_f32_32x32x16_bf16 v[4:19], a[36:39], v[92:95], v[4:19]
    v_mfma_f32_32x32x16_bf16 v[20:35], a[164:167], v[92:95], v[20:35]
    v_mfma_f32_32x32x16_bf16 v[4:19], a[40:43], v[96:99], v[4:19]
    v_mfma_f32_32x32x16_bf16 v[20:35], a[168:171], v[96:99], v[20:35]
    v_mfma_f32_32x32x16_bf16 v[4:19], a[44:47], v[100:103], v[4:19]
    v_mfma_f32_32x32x16_bf16 v[20:35], a[172:175], v[100:103], v[20:35]
    v_mfma_f32_32x32x16_bf16 v[4:19], a[48:51], v[104:107], v[4:19]
    v_mfma_f32_32x32x16_bf16 v[20:35], a[176:179], v[104:107], v[20:35]
    v_mfma_f32_32x32x16_bf16 v[4:19], a[52:55], v[108:111], v[4:19]
    v_mfma_f32_32x32x16_bf16 v[20:35], a[180:183], v[108:111], v[20:35]
    v_mfma_f32_32x32x16_bf16 v[4:19], a[56:59], v[112:115], v[4:19]
    v_mfma_f32_32x32x16_bf16 v[20:35], a[184:187], v[112:115], v[20:35]
    v_mfma_f32_32x32x16_bf16 v[4:19], a[60:63], v[116:119], v[4:19]
    v_mfma_f32_32x32x16_bf16 v[20:35], a[188:191], v[116:119], v[20:35]
    v_xor_b32 v189, s3, v120
    v_bitop3_b32 v189, v189, v121, s31 bitop3:0xf6
    v_bitop3_b32 v189, v189, v124, s3 bitop3:0xf6
    v_bitop3_b32 v189, v189, v125, s31 bitop3:0xf6
    v_bitop3_b32 v189, v189, v128, s3 bitop3:0xf6
    v_bitop3_b32 v189, v189, v129, s31 bitop3:0xf6
    v_bitop3_b32 v189, v189, v132, s3 bitop3:0xf6
    v_bitop3_b32 v189, v189, v133, s31 bitop3:0xf6
    v_bitop3_b32 v189, v189, v136, s3 bitop3:0xf6
    v_bitop3_b32 v189, v189, v137, s31 bitop3:0xf6
    v_accvgpr_read_b32 v190, a92
    v_accvgpr_read_b32 v191, a93
    v_bitop3_b32 v189, v189, v190, s3 bitop3:0xf6
    v_bitop3_b32 v189, v189, v191, s31 bitop3:0xf6
    v_accvgpr_read_b32 v190, a96
    v_accvgpr_read_b32 v191, a97
    v_bitop3_b32 v189, v189, v190, s3 bitop3:0xf6
    v_bitop3_b32 v189, v189, v191, s31 bitop3:0xf6
    v_and_b32 v189, 0x00010001, v189
    v_cmp_ne_u32 vcc, 0, v189
    s_nop 0
    s_cbranch_vccnz LF_hcr_73
LF_hcb_75:
    v_mfma_f32_32x32x16_bf16 v[4:19], a[64:67], v[120:123], v[4:19]
    v_mfma_f32_32x32x16_bf16 v[20:35], a[192:195], v[120:123], v[20:35]
    v_mfma_f32_32x32x16_bf16 v[4:19], a[68:71], v[124:127], v[4:19]
    v_mfma_f32_32x32x16_bf16 v[20:35], a[196:199], v[124:127], v[20:35]
    v_mfma_f32_32x32x16_bf16 v[4:19], a[72:75], v[128:131], v[4:19]
    v_mfma_f32_32x32x16_bf16 v[20:35], a[200:203], v[128:131], v[20:35]
    v_mfma_f32_32x32x16_bf16 v[4:19], a[76:79], v[132:135], v[4:19]
    v_mfma_f32_32x32x16_bf16 v[20:35], a[204:207], v[132:135], v[20:35]
    v_mfma_f32_32x32x16_bf16 v[4:19], a[80:83], v[136:139], v[4:19]
    v_mfma_f32_32x32x16_bf16 v[20:35], a[208:211], v[136:139], v[20:35]
    v_mfma_f32_32x32x16_bf16 v[4:19], a[84:87], a[92:95], v[4:19]
    v_mfma_f32_32x32x16_bf16 v[20:35], a[212:215], a[92:95], v[20:35]
    v_mfma_f32_32x32x16_bf16 v[4:19], a[88:91], a[96:99], v[4:19]
    v_mfma_f32_32x32x16_bf16 v[20:35], a[216:219], a[96:99], v[20:35]
    s_mov_b32 s78, 200000
LF_g2l_68:
    s_waitcnt vmcnt(0)
    v_xor_b32 v184, s3, v184
    v_and_b32 v184, 0x00010001, v184
    v_cmp_ne_u32 vcc, 0, v184
    s_nop 1
    s_cbranch_vccz LF_g2ok_69
    buffer_load_dword v184, v183, s[4:7], s87 offen sc1
    s_sub_u32 s78, s78, 1
    s_cmp_lg_u32 s78, 0
    s_cbranch_scc1 LF_g2l_68
    s_waitcnt vmcnt(0)
LF_g2ok_69:
    s_add_u32 s47, s36, s22
    buffer_load_dwordx4 a[100:103], v182, s[4:7], s47 offen sc1
    s_add_u32 s47, s37, s22
    buffer_load_dwordx4 a[104:107], v182, s[4:7], s47 offen sc1
    s_add_u32 s47, s38, s22
    buffer_load_dwordx4 a[108:111], v182, s[4:7], s47 offen sc1
    s_add_u32 s47, s39, s22
    buffer_load_dwordx4 a[112:115], v182, s[4:7], s47 offen sc1
    s_add_u32 s47, s40, s22
    buffer_load_dwordx4 a[116:119], v182, s[4:7], s47 offen sc1
    s_add_u32 s47, s41, s22
    buffer_load_dwordx4 a[120:123], v182, s[4:7], s47 offen sc1
    s_add_u32 s47, s42, s22
    buffer_load_dwordx4 a[124:127], v182, s[4:7], s47 offen sc1
    s_add_u32 s47, s36, s23
    buffer_load_dwordx4 a[220:223], v182, s[4:7], s47 offen sc1
    s_add_u32 s47, s37, s23
    buffer_load_dwordx4 a[224:227], v182, s[4:7], s47 offen sc1
    s_add_u32 s47, s38, s23
    buffer_load_dwordx4 a[228:231], v182, s[4:7], s47 offen sc1
    s_add_u32 s47, s39, s23
    buffer_load_dwordx4 a[232:235], v182, s[4:7], s47 offen sc1
    s_add_u32 s47, s40, s23
    buffer_load_dwordx4 a[236:239], v182, s[4:7], s47 offen sc1
    s_add_u32 s47, s41, s23
    buffer_load_dwordx4 a[240:243], v182, s[4:7], s47 offen sc1
    s_add_u32 s47, s42, s23
    buffer_load_dwordx4 a[244:247], v182, s[4:7], s47 offen sc1
    s_add_u32 s47, s36, s24
    buffer_load_dwordx4 a[248:251], v182, s[4:7], s47 offen sc1
    s_add_u32 s47, s37, s24
    buffer_load_dwordx4 a[252:255], v182, s[4:7], s47 offen sc1
    s_add_u32 s47, s38, s24
    buffer_load_dwordx4 v[68:71], v182, s[4:7], s47 offen sc1
    s_add_u32 s47, s39, s24
    buffer_load_dwordx4 v[72:75], v182, s[4:7], s47 offen sc1
    s_add_u32 s47, s40, s24
    buffer_load_dwordx4 v[76:79], v182, s[4:7], s47 offen sc1
    s_add_u32 s47, s41, s24
    buffer_load_dwordx4 v[80:83], v182, s[4:7], s47 offen sc1
    s_waitcnt vmcnt(13)
    v_accvgpr_read_b32 v190, a100
    v_accvgpr_read_b32 v191, a101
    v_xor_b32 v189, s3, v190
    v_bitop3_b32 v189, v189, v191, s31 bitop3:0xf6
    v_accvgpr_read_b32 v190, a104
    v_accvgpr_read_b32 v191, a105
    v_bitop3_b32 v189, v189, v190, s3 bitop3:0xf6
    v_bitop3_b32 v189, v189, v191, s31 bitop3:0xf6
    v_accvgpr_read_b32 v190, a108
    v_accvgpr_read_b32 v191, a109
    v_bitop3_b32 v189, v189, v190, s3 bitop3:0xf6
    v_bitop3_b32 v189, v189, v191, s31 bitop3:0xf6
    v_accvgpr_read_b32 v190, a112
    v_accvgpr_read_b32 v191, a113
    v_bitop3_b32 v189, v189, v190, s3 bitop3:0xf6
    v_bitop3_b32 v189, v189, v191, s31 bitop3:0xf6
    v_accvgpr_read_b32 v190, a116
    v_accvgpr_read_b32 v191, a117
    v_bitop3_b32 v189, v189, v190, s3 bitop3:0xf6
    v_bitop3_b32 v189, v189, v191, s31 bitop3:0xf6
    v_accvgpr_read_b32 v190, a120
    v_accvgpr_read_b32 v191, a121
    v_bitop3_b32 v189, v189, v190, s3 bitop3:0xf6
    v_bitop3_b32 v189, v189, v191, s31 bitop3:0xf6
    v_accvgpr_read_b32 v190, a124
    v_accvgpr_read_b32 v191, a125
    v_bitop3_b32 v189, v189, v190, s3 bitop3:0xf6
    v_bitop3_b32 v189, v189, v191, s31 bitop3:0xf6
    v_and_b32 v189, 0x00010001, v189
    v_cmp_ne_u32 vcc, 0, v189
    s_nop 0
    s_cbranch_vccnz LF_hcr_76
LF_hcb_78:
    s_branch LF_g2j_58
LF_rsr_79:
    s_mov_b32 s78, 200000
LF_rsl_80:
    s_mov_b32 m0, s83
    s_nop 0
    buffer_load_dwordx4 v182, s[4:7], s82 offen sc1 lds
    buffer_load_dwordx4 v182, s[4:7], s82 offen offset:1024 sc1 lds
    s_waitcnt vmcnt(0)
    ds_read_b128 v[160:163], v195 offset:0
    ds_read_b128 v[164:167], v195 offset:1024
    s_waitcnt lgkmcnt(0)
    v_bitop3_b32 v160, v160, v162, s3 bitop3:0x7e
    v_bitop3_b32 v161, v161, v163, s31 bitop3:0x7e
    v_bitop3_b32 v164, v164, v166, s3 bitop3:0x7e
    v_bitop3_b32 v165, v165, v167, s31 bitop3:0x7e
    v_or3_b32 v160, v160, v161, v164
    v_or_b32 v160, v160, v165
    v_and_b32 v160, 0x00010001, v160
    v_cmp_ne_u32 vcc, 0, v160
    s_nop 1
    s_cbranch_vccz LF_rsb_81
    s_sub_u32 s78, s78, 1
    s_cmp_lg_u32 s78, 0
    s_cbranch_scc1 LF_rsl_80
    s_branch LF_rsb_81
LF_hcr_82:
    s_mov_b32 s78, 200000
LF_hcl_83:
    s_add_u32 s47, s36, s23
    buffer_load_dwordx4 a[220:223], v182, s[4:7], s47 offen sc1
    s_add_u32 s47, s37, s23
    buffer_load_dwordx4 a[224:227], v182, s[4:7], s47 offen sc1
    s_add_u32 s47, s38, s23
    buffer_load_dwordx4 a[228:231], v182, s[4:7], s47 offen sc1
    s_add_u32 s47, s39, s23
    buffer_load_dwordx4 a[232:235], v182, s[4:7], s47 offen sc1
    s_add_u32 s47, s40, s23
    buffer_load_dwordx4 a[236:239], v182, s[4:7], s47 offen sc1
    s_add_u32 s47, s41, s23
    buffer_load_dwordx4 a[240:243], v182, s[4:7], s47 offen sc1
    s_add_u32 s47, s42, s23
    buffer_load_dwordx4 a[244:247], v182, s[4:7], s47 offen sc1
    s_waitcnt vmcnt(0)
    v_accvgpr_read_b32 v190, a220
    v_accvgpr_read_b32 v191, a221
    v_xor_b32 v189, s3, v190
    v_bitop3_b32 v189, v189, v191, s31 bitop3:0xf6
    v_accvgpr_read_b32 v190, a224
    v_accvgpr_read_b32 v191, a225
    v_bitop3_b32 v189, v189, v190, s3 bitop3:0xf6
    v_bitop3_b32 v189, v189, v191, s31 bitop3:0xf6
    v_accvgpr_read_b32 v190, a228
    v_accvgpr_read_b32 v191, a229
    v_bitop3_b32 v189, v189, v190, s3 bitop3:0xf6
    v_bitop3_b32 v189, v189, v191, s31 bitop3:0xf6
    v_accvgpr_read_b32 v190, a232
    v_accvgpr_read_b32 v191, a233
    v_bitop3_b32 v189, v189, v190, s3 bitop3:0xf6
    v_bitop3_b32 v189, v189, v191, s31 bitop3:0xf6
    v_accvgpr_read_b32 v190, a236
    v_accvgpr_read_b32 v191, a237
    v_bitop3_b32 v189, v189, v190, s3 bitop3:0xf6
    v_bitop3_b32 v189, v189, v191, s31 bitop3:0xf6
    v_accvgpr_read_b32 v190, a240
    v_accvgpr_read_b32 v191, a241
    v_bitop3_b32 v189, v189, v190, s3 bitop3:0xf6
    v_bitop3_b32 v189, v189, v191, s31 bitop3:0xf6
    v_accvgpr_read_b32 v190, a244
    v_accvgpr_read_b32 v191, a245
    v_bitop3_b32 v189, v189, v190, s3 bitop3:0xf6
    v_bitop3_b32 v189, v189, v191, s31 bitop3:0xf6
    v_and_b32 v189, 0x00010001, v189
    v_cmp_ne_u32 vcc, 0, v189
    s_nop 1
    s_cbranch_vccz LF_hcb_84
    s_sub_u32 s78, s78, 1
    s_cmp_lg_u32 s78, 0
    s_cbranch_scc1 LF_hcl_83
    s_branch LF_hcb_84
LF_hcr_85:
    s_mov_b32 s78, 200000
LF_hcl_86:
    s_add_u32 s47, s36, s24
    buffer_load_dwordx4 a[248:251], v182, s[4:7], s47 offen sc1
    s_add_u32 s47, s37, s24
    buffer_load_dwordx4 a[252:255], v182, s[4:7], s47 offen sc1
    s_add_u32 s47, s38, s24
    buffer_load_dwordx4 v[68:71], v182, s[4:7], s47 offen sc1
    s_add_u32 s47, s39, s24
    buffer_load_dwordx4 v[72:75], v182, s[4:7], s47 offen sc1
    s_add_u32 s47, s40, s24
    buffer_load_dwordx4 v[76:79], v182, s[4:7], s47 offen sc1
    s_add_u32 s47, s41, s24
    buffer_load_dwordx4 v[80:83], v182, s[4:7], s47 offen sc1
    s_add_u32 s47, s42, s24
    buffer_load_dwordx4 v[84:87], v182, s[4:7], s47 offen sc1
    s_waitcnt vmcnt(0)
    v_accvgpr_read_b32 v190, a248
    v_accvgpr_read_b32 v191, a249
    v_xor_b32 v189, s3, v190
    v_bitop3_b32 v189, v189, v191, s31 bitop3:0xf6
    v_accvgpr_read_b32 v190, a252
    v_accvgpr_read_b32 v191, a253
    v_bitop3_b32 v189, v189, v190, s3 bitop3:0xf6
    v_bitop3_b32 v189, v189, v191, s31 bitop3:0xf6
    v_bitop3_b32 v189, v189, v68, s3 bitop3:0xf6
    v_bitop3_b32 v189, v189, v69, s31 bitop3:0xf6
    v_bitop3_b32 v189, v189, v72, s3 bitop3:0xf6
    v_bitop3_b32 v189, v189, v73, s31 bitop3:0xf6
    v_bitop3_b32 v189, v189, v76, s3 bitop3:0xf6
    v_bitop3_b32 v189, v189, v77, s31 bitop3:0xf6
    v_bitop3_b32 v189, v189, v80, s3 bitop3:0xf6
    v_bitop3_b32 v189, v189, v81, s31 bitop3:0xf6
    v_bitop3_b32 v189, v189, v84, s3 bitop3:0xf6
    v_bitop3_b32 v189, v189, v85, s31 bitop3:0xf6
    v_and_b32 v189, 0x00010001, v189
    v_cmp_ne_u32 vcc, 0, v189
    s_nop 1
    s_cbranch_vccz LF_hcb_87
    s_sub_u32 s78, s78, 1
    s_cmp_lg_u32 s78, 0
    s_cbranch_scc1 LF_hcl_86
    s_branch LF_hcb_87
LF_hcr_88:
    s_mov_b32 s78, 200000
LF_hcl_89:
    s_add_u32 s47, s36, s25
    buffer_load_dwordx4 v[88:91], v182, s[4:7], s47 offen sc1
    s_add_u32 s47, s37, s25
    buffer_load_dwordx4 v[92:95], v182, s[4:7], s47 offen sc1
    s_add_u32 s47, s38, s25
    buffer_load_dwordx4 v[96:99], v182, s[4:7], s47 offen sc1
    s_add_u32 s47, s39, s25
    buffer_load_dwordx4 v[100:103], v182, s[4:7], s47 offen sc1
    s_add_u32 s47, s40, s25
    buffer_load_dwordx4 v[104:107], v182, s[4:7], s47 offen sc1
    s_add_u32 s47, s41, s25
    buffer_load_dwordx4 v[108:111], v182, s[4:7], s47 offen sc1
    s_add_u32 s47, s42, s25
    buffer_load_dwordx4 v[112:115], v182, s[4:7], s47 offen sc1
    s_waitcnt vmcnt(0)
    v_xor_b32 v189, s3, v88
    v_bitop3_b32 v189, v189, v89, s31 bitop3:0xf6
    v_bitop3_b32 v189, v189, v92, s3 bitop3:0xf6
    v_bitop3_b32 v189, v189, v93, s31 bitop3:0xf6
    v_bitop3_b32 v189, v189, v96, s3 bitop3:0xf6
    v_bitop3_b32 v189, v189, v97, s31 bitop3:0xf6
    v_bitop3_b32 v189, v189, v100, s3 bitop3:0xf6
    v_bitop3_b32 v189, v189, v101, s31 bitop3:0xf6
    v_bitop3_b32 v189, v189, v104, s3 bitop3:0xf6
    v_bitop3_b32 v189, v189, v105, s31 bitop3:0xf6
    v_bitop3_b32 v189, v189, v108, s3 bitop3:0xf6
    v_bitop3_b32 v189, v189, v109, s31 bitop3:0xf6
    v_bitop3_b32 v189, v189, v112, s3 bitop3:0xf6
    v_bitop3_b32 v189, v189, v113, s31 bitop3:0xf6
    v_and_b32 v189, 0x00010001, v189
    v_cmp_ne_u32 vcc, 0, v189
    s_nop 1
    s_cbranch_vccz LF_hcb_90
    s_sub_u32 s78, s78, 1
    s_cmp_lg_u32 s78, 0
    s_cbranch_scc1 LF_hcl_89
F_last:
    s_branch LF_hcb_90
.section .rodata,"a"
.p2align 6
.amdhsa_kernel adaLN_cond__ssm_conv_s4__glu_gated_geglu__prompt_kernel
  .amdhsa_next_free_vgpr 512
  .amdhsa_next_free_sgpr 102
  .amdhsa_accum_offset 256
  .amdhsa_group_segment_fixed_size 0
  .amdhsa_kernarg_size 144
  .amdhsa_user_sgpr_count 2
  .amdhsa_user_sgpr_kernarg_segment_ptr 1
  .amdhsa_system_sgpr_workgroup_id_x 1
.end_amdhsa_kernel
```
